```python
import torch

def _softmax(x, axis=-1):
    return torch.softmax(x, dim=axis)
def _gelu(x):
    return torch.nn.functional.gelu(x, approximate="tanh")
def _silu(x):
    return torch.nn.functional.silu(x)
def _sigmoid(x):
    return torch.sigmoid(x)
def _layernorm(x, axis=-1, eps=1e-5):
    m = x.mean(dim=axis, keepdim=True)
    v = x.var(dim=axis, keepdim=True, unbiased=False)
    return (x - m) / torch.sqrt(v + eps)
def _scatter_add(tgt, idx, src, axis=0):
    return tgt.clone().index_add_(axis, idx, src)
def _segment_sum(src, seg, n):
    out = torch.zeros((n,) + src.shape[1:], dtype=src.dtype)
    return out.index_add_(0, seg, src)
def _pad(x, pw):
    flat = tuple(v for pair in reversed(pw) for v in pair)
    return torch.nn.functional.pad(x, flat)

kernel_name = 'concat_heads__mha_block_cached__gqa_block_cached__near_ridge'

def setup_inputs():

    _w = (lambda a: (lambda t: t.to(torch.bfloat16) if t.is_floating_point() else t)(torch.as_tensor(a)))
    def _A_setup():
        B, Sq, D = 16, 160, 448
        H, Sk, Dh = 16, 512, 256
        return {
            "x": _w((lambda *s: torch.randn(*s, dtype=torch.bfloat16) * 0.8)(B, Sq, D)),
            "k_cache": _w((lambda *s: torch.randn(*s, dtype=torch.bfloat16) * 0.8)(B, H, Sk, Dh)),
            "v_cache": _w((lambda *s: torch.randn(*s, dtype=torch.bfloat16) * 0.05)(B, H, Sk, Dh)),
            "wq": _w((lambda *s: torch.randn(*s, dtype=torch.bfloat16) * 0.8)(D, H * Dh) * (D ** -0.5)),
            "wo": _w((lambda *s: torch.randn(*s, dtype=torch.bfloat16) * 0.05)(H * Dh, D) * ((H * Dh) ** -0.5)),
        }
    _A_in = _A_setup()

    def _B_setup():
        B, Sq, D = 16, 160, 448
        Hq, Hkv, Sk, Dh = 16, 16, 512, 256
        assert Hq % Hkv == 0, (Hq, Hkv)
        return {
            "x": _w((lambda *s: torch.randn(*s, dtype=torch.bfloat16) * 0.8)(B, Sq, D)),
            "k_cache": _w((lambda *s: torch.randn(*s, dtype=torch.bfloat16) * 0.8)(B, Hkv, Sk, Dh)),
            "v_cache": _w((lambda *s: torch.randn(*s, dtype=torch.bfloat16) * 0.05)(B, Hkv, Sk, Dh)),
            "wq": _w((lambda *s: torch.randn(*s, dtype=torch.bfloat16) * 0.8)(D, Hq * Dh) * (D ** -0.5)),
            "wo": _w((lambda *s: torch.randn(*s, dtype=torch.bfloat16) * 0.05)(Hq * Dh, D) * ((Hq * Dh) ** -0.5)),
        }
    _B_in = _B_setup()

    return {
        "A_x": _A_in["x"],
        "A_k_cache": _A_in["k_cache"],
        "A_v_cache": _A_in["v_cache"],
        "A_wq": _A_in["wq"],
        "A_wo": _A_in["wo"],
        "B_x": _B_in["x"],
        "B_k_cache": _B_in["k_cache"],
        "B_v_cache": _B_in["v_cache"],
        "B_wq": _B_in["wq"],
        "B_wo": _B_in["wo"],
    }

def reference(A_x, A_k_cache, A_v_cache, A_wq, A_wo, B_x, B_k_cache, B_v_cache, B_wq, B_wo):
    def _A_ref(x, k_cache, v_cache, wq, wo):
        B, Sq, D = x.shape
        H, Dh = 16, 256
        q = (lambda x, *d: x.permute(*d))((x @ wq).reshape(B, Sq, H, Dh), 0, 2, 1, 3)
        scores = torch.einsum("bhqd,bhkd->bhqk", q, k_cache) * (Dh ** -0.5)
        p = _softmax(scores, axis=-1)
        o = torch.einsum("bhqk,bhkd->bhqd", p, v_cache)
        return (lambda x, *d: x.permute(*d))(o, 0, 2, 1, 3).reshape(B, Sq, H * Dh) @ wo

    def _B_ref(x, k_cache, v_cache, wq, wo):
        B, Sq, D = x.shape
        Hq, Dh = 16, 256
        Hkv = k_cache.shape[1]
        rep = Hq // Hkv
        q = (lambda x, *d: x.permute(*d))((x @ wq).reshape(B, Sq, Hq, Dh), 0, 2, 1, 3)
        k = (lambda x, n, axis: torch.repeat_interleave(x, n, dim=axis))(k_cache, rep, axis=1)
        v = (lambda x, n, axis: torch.repeat_interleave(x, n, dim=axis))(v_cache, rep, axis=1)
        scores = torch.einsum("bhqd,bhkd->bhqk", q, k) * (Dh ** -0.5)
        p = _softmax(scores, axis=-1)
        o = torch.einsum("bhqk,bhkd->bhqd", p, v)
        return (lambda x, *d: x.permute(*d))(o, 0, 2, 1, 3).reshape(B, Sq, Hq * Dh) @ wo

    a = _A_ref(A_x, A_k_cache, A_v_cache, A_wq, A_wo)
    b = _B_ref(B_x, B_k_cache, B_v_cache, B_wq, B_wo)
    return torch.concatenate([a, b], axis=-1)
```

```asm
; @launch grid=(256,1,1) block=(256,1,1) lds=163840
.amdgcn_target "amdgcn-amd-amdhsa--gfx950"
.macro M d,a,b,c
v_mfma_f32_16x16x32_bf16 \d, \a, \b, \c
.endm
.macro MC d,a,b
v_mfma_f32_16x16x32_bf16 \d, \a, \b, \d
.endm
.macro TR d,r,o
ds_read_b64_tr_b16 \d, \r offset:\o
.endm
.macro RD d,r,o
ds_read_b128 \d, \r offset:\o
.endm
.macro LG n
s_waitcnt lgkmcnt(\n)
.endm
.macro CV d,a,b
v_cvt_pk_bf16_f32 \d, \a, \b
.endm
.macro AR d,a
v_accvgpr_read_b32 \d, \a
.endm
.macro AW d,a
v_accvgpr_write_b32 \d, \a
.endm
.text
.globl concat_heads__mha_block_cached__gqa_block_cached__near_ridge_kernel
.p2align 8
.type concat_heads__mha_block_cached__gqa_block_cached__near_ridge_kernel,@function
concat_heads__mha_block_cached__gqa_block_cached__near_ridge_kernel:
s_cmp_lt_u32 s2, 256
s_cbranch_scc1 E_go
s_endpgm
E_go:
s_and_b32 s61, s2, 7
s_lshr_b32 s62, s2, 3
s_lshr_b32 s63, s61, 2
s_mul_i32 s50, s63, 40
s_add_u32 s56, s0, s50
s_addc_u32 s57, s1, 0
s_load_dwordx2 s[8:9], s[56:57], 0
s_load_dwordx2 s[20:21], s[56:57], 24
s_load_dwordx2 s[12:13], s[56:57], 8
s_load_dwordx2 s[16:17], s[56:57], 16
s_load_dwordx2 s[24:25], s[56:57], 32
s_load_dwordx2 s[28:29], s[0:1], 96
s_load_dwordx2 s[4:5], s[0:1], 80
s_load_dwordx2 s[96:97], s[0:1], 88
s_getpc_b64 s[54:55]
E_pc:
s_add_u32 s54, s54, Y_entry-E_pc
s_addc_u32 s55, s55, 0
s_bfe_u32 s3, s2, 0x50003
v_lshrrev_b32 v15, 4, v0
v_lshl_add_u32 v15, v15, 5, s3
v_lshlrev_b32 v15, 7, v15
global_load_dword a60, v15, s[54:55]
s_and_b32 s38, s61, 3
s_lshl_b32 s38, s38, 1
s_and_b32 s50, s62, 1
s_add_u32 s38, s38, s50
s_lshr_b32 s60, s62, 1
s_and_b32 s61, s38, 1
s_and_b32 s62, s60, 15
v_lshrrev_b32 v21, 6, v0
v_lshlrev_b32 v15, 7, v0
v_readfirstlane_b32 s32, v21
v_and_b32 v21, 63, v0
s_mov_b32 s43, 0
s_mov_b32 s10, 143360
s_mov_b32 s11, 0x20000
s_mov_b32 s23, 0x20000
s_and_b32 s33, s32, 1
s_mul_i32 s34, s32, 8448
s_lshr_b32 s59, s32, 1
s_lshl_b32 s50, s33, 6
s_add_u32 s39, s34, s50
s_mul_i32 s37, s59, 71680
s_mul_i32 s36, s33, 28672
s_add_u32 s36, s36, s37
s_mul_i32 s50, s33, 7168
s_add_u32 s37, s37, s50
s_add_u32 s37, s37, 57344
s_lshl_b32 s50, s32, 13
v_lshl_add_u32 v12, v21, 4, s50
v_bfe_u32 v21, v12, 4, 6
v_lshrrev_b32 v22, 3, v21
v_mul_u32_u24 v14, 896, v22
v_lshrrev_b32 v22, 4, v21
v_and_b32 v23, 7, v21
v_xor_b32 v22, v22, v23
v_lshl_add_u32 v14, v22, 4, v14
LG 0
s_mul_i32 s50, s60, 143360
s_add_u32 s8, s8, s50
s_addc_u32 s9, s9, 0
s_lshl_b32 s50, s38, 10
s_add_u32 s20, s20, s50
s_addc_u32 s21, s21, 0
s_sub_u32 s22, 3670016, s50
E_start:
s_mov_b32 s42, 0x3db8aa3b
s_mov_b32 s44, 0x2b800000
s_mov_b32 s45, 0x57800000
s_mov_b64 s[46:47], 0
v_lshrrev_b32 v22, 8, v15
v_bfe_u32 v23, v15, 7, 1
v_cmp_gt_u32 vcc, 12, v22
v_mul_u32_u24 v22, 8192, v22
v_lshl_add_u32 v22, v23, 7, v22
v_cndmask_b32 v22, 2.0, v22, vcc
s_mul_i32 s52, s62, 98304
s_add_u32 s52, s52, 0
buffer_load_dword a60, v22, s[20:23], s52 offen
s_add_u32 s40, s36, 0
s_add_u32 m0, s34, 0
s_add_u32 s41, s36, 7168
buffer_load_dwordx4 v14, s[8:11], s40 offen offset:0 lds
s_add_u32 m0, s34, 2112
s_add_u32 s40, s36, 14336
buffer_load_dwordx4 v14, s[8:11], s41 offen offset:0 lds
s_add_u32 m0, s34, 1024
s_add_u32 s41, s36, 21504
buffer_load_dwordx4 v14, s[8:11], s40 offen offset:0 lds
s_add_u32 m0, s34, 3136
s_add_u32 s40, s37, 0
buffer_load_dwordx4 v14, s[8:11], s41 offen offset:0 lds
s_add_u32 m0, s39, 5248
s_add_u32 s41, s36, 128
buffer_load_dwordx4 v14, s[8:11], s40 offen offset:0 lds
s_add_u32 m0, s34, 4224
s_add_u32 s40, s36, 7296
buffer_load_dwordx4 v14, s[8:11], s41 offen offset:0 lds
s_add_u32 m0, s34, 6336
s_add_u32 s41, s37, 128
buffer_load_dwordx4 v14, s[8:11], s40 offen offset:0 lds
s_add_u32 m0, s39, 7360
s_add_u32 s40, s36, 14464
buffer_load_dwordx4 v14, s[8:11], s41 offen offset:0 lds
s_add_u32 m0, s34, 67584
s_add_u32 s41, s36, 21632
buffer_load_dwordx4 v14, s[8:11], s40 offen offset:0 lds
s_add_u32 m0, s34, 69696
s_add_u32 s40, s36, 256
buffer_load_dwordx4 v14, s[8:11], s41 offen offset:0 lds
s_add_u32 m0, s34, 68608
s_add_u32 s41, s36, 7424
buffer_load_dwordx4 v14, s[8:11], s40 offen offset:0 lds
s_add_u32 m0, s34, 70720
s_add_u32 s40, s36, 14592
buffer_load_dwordx4 v14, s[8:11], s41 offen offset:0 lds
s_add_u32 m0, s34, 71808
s_add_u32 s41, s36, 21760
buffer_load_dwordx4 v14, s[8:11], s40 offen offset:0 lds
s_add_u32 m0, s34, 73920
s_add_u32 s40, s37, 256
buffer_load_dwordx4 v14, s[8:11], s41 offen offset:0 lds
s_add_u32 m0, s39, 72832
s_nop 0
buffer_load_dwordx4 v14, s[8:11], s40 offen offset:0 lds
s_cmp_lg_u32 s43, 0
s_cbranch_scc1 E_srd
s_lshl_b32 s58, s60, 3
s_add_u32 s58, s58, s38
s_lshl_b32 s50, s58, 19
s_add_u32 s12, s12, s50
s_addc_u32 s13, s13, 0
s_add_u32 s16, s16, s50
s_addc_u32 s17, s17, 0
s_mul_i32 s50, s38, 458752
s_add_u32 s24, s24, s50
s_addc_u32 s25, s25, 0
s_lshl_b32 s58, s63, 4
s_add_u32 s58, s58, s60
s_lshl_b32 s50, s58, 3
s_add_u32 s96, s96, s50
s_addc_u32 s97, s97, 0
s_lshl_b32 s58, s58, 2
s_add_u32 s58, s58, s32
s_mul_i32 s50, s58, 287744
s_add_u32 s28, s28, s50
s_addc_u32 s29, s29, 0
s_mov_b32 s14, 524288
s_mov_b32 s15, 0x20000
s_mov_b32 s18, 524288
s_mov_b32 s19, 0x20000
s_mov_b32 s26, 458752
s_mov_b32 s27, 0x20000
s_mov_b32 s31, 0x20000
s_mov_b32 s6, 4587520
s_mov_b32 s7, 0x20000
s_mov_b32 s98, 8
s_mov_b32 s99, 0x20000
s_lshl_b32 s35, s32, 10
s_lshl_b32 s50, s33, 3
s_add_u32 s35, s35, s50
s_lshl_b32 s50, s59, 6
s_add_u32 s35, s35, s50
s_mul_i32 s100, s60, 10
s_mul_i32 s50, s59, 5
s_add_u32 s100, s100, s50
s_mul_i32 s100, s100, 28672
s_mul_i32 s50, s63, 896
s_add_u32 s100, s100, s50
s_mov_b32 s30, 286752
s_mul_i32 s3, s32, 7168
s_add_u32 s3, s3, 135168
v_bfe_u32 v21, v12, 4, 6
v_bfe_u32 v13, v21, 5, 1
v_lshlrev_b32 v13, 4, v13
v_bfe_u32 v23, v21, 4, 1
v_lshl_add_u32 v13, v23, 2, v13
v_bfe_u32 v23, v21, 3, 1
v_add_u32 v13, v13, v23
s_lshr_b32 s101, s32, 1
s_lshl_b32 s101, s101, 3
s_lshl_b32 s50, s33, 1
s_add_u32 s101, s101, s50
v_add_u32 v13, s101, v13
v_lshlrev_b32 v13, 13, v13
v_and_b32 v23, 7, v21
v_lshl_add_u32 v13, v23, 4, v13
s_mov_b32 s63, 0
s_lshl_b32 s50, s32, 15
s_xor_b32 s63, s63, s50
E_srd:
s_branch Y_entry
.p2align 12
Y_entry:
v_bfe_u32 v21, v12, 4, 6
v_lshrrev_b32 v23, 2, v21
v_mul_u32_u24 v4, 1056, v23
v_and_b32 v22, 3, v21
v_lshl_add_u32 v4, v22, 3, v4
s_mul_i32 s101, s33, 16960
s_mul_i32 s50, s33, 16832
s_add_u32 s50, s50, 64
v_add_u32 v5, s50, v4
s_sub_u32 s50, 16960, s50
v_add_u32 v6, s50, v4
s_sub_u32 s50, 16960, s101
v_add_u32 v7, s50, v4
v_add_u32 v4, s101, v4
v_bfe_u32 v23, v21, 3, 1
v_mul_u32_u24 v8, 1032, v23
v_bfe_u32 v23, v21, 4, 1
v_mul_u32_u24 v23, 2112, v23
v_add_u32 v8, v8, v23
v_bfe_u32 v23, v21, 2, 1
v_lshl_add_u32 v8, v23, 7, v8
v_bfe_u32 v23, v21, 5, 1
v_lshl_add_u32 v8, v23, 9, v8
v_lshl_add_u32 v8, v22, 4, v8
s_lshl_b32 s101, s33, 6
s_sub_u32 s50, 64, s101
v_add_u32 v9, s50, v8
v_add_u32 v8, s101, v8
v_lshl_add_u32 v16, v21, 4, s3
s_xor_b32 s50, s32, 1
s_mul_i32 s50, s50, 7168
s_add_u32 s50, s50, 135168
v_lshl_add_u32 v17, v21, 4, s50
v_bfe_u32 v21, v12, 4, 6
v_lshrrev_b32 v22, 4, v21
v_bfe_u32 v23, v21, 1, 2
v_xor_b32 v22, v22, v23
v_and_b32 v23, 7, v21
v_lshlrev_b32 v23, 7, v23
v_lshl_add_u32 v22, v22, 4, v23
v_bfe_u32 v21, v21, 3, 1
v_mul_u32_u24 v23, 2112, v21
v_add3_u32 v0, v22, v23, s34
v_lshlrev_b32 v23, 11, v21
v_add3_u32 v2, v22, v23, s3
s_and_b32 s50, s32, 2
s_mul_i32 s101, s50, 8448
v_mul_u32_u24 v23, 8512, v21
v_add3_u32 v1, v22, v23, s101
s_mul_i32 s101, s50, 7168
s_add_u32 s101, s101, 135168
v_mul_u32_u24 v23, 7168, v21
v_add3_u32 v3, v22, v23, s101
s_nop 0
s_mov_b32 s41, 0
s_add_u32 m0, s35, 33792
s_mov_b32 s40, 262144
buffer_load_dwordx4 v13, s[20:23], s41 offen offset:0 lds
s_add_u32 m0, s35, 38016
s_mov_b32 s41, 524288
buffer_load_dwordx4 v13, s[20:23], s40 offen offset:0 lds
s_add_u32 m0, s35, 42240
s_mov_b32 s40, 786432
buffer_load_dwordx4 v13, s[20:23], s41 offen offset:0 lds
s_add_u32 m0, s35, 46464
s_mov_b32 s41, 1048576
buffer_load_dwordx4 v13, s[20:23], s40 offen offset:0 lds
s_add_u32 m0, s35, 50688
s_mov_b32 s40, 1310720
buffer_load_dwordx4 v13, s[20:23], s41 offen offset:0 lds
s_add_u32 m0, s35, 54912
s_mov_b32 s41, 128
buffer_load_dwordx4 v13, s[20:23], s40 offen offset:0 lds
s_mov_b64 exec, 0
s_cmp_eq_u32 s32, 0
s_cbranch_scc1 Y_pg1
s_cmp_eq_u32 s32, 1
s_cbranch_scc1 Y_pg2
s_cmp_eq_u32 s32, 2
s_cbranch_scc1 Y_pg3
s_branch Y_pg4
Y_wr0:
s_mov_b64 exec, -1
s_add_u32 m0, s35, 101376
s_mov_b32 s40, 262272
buffer_load_dwordx4 v13, s[20:23], s41 offen offset:0 lds
s_add_u32 m0, s35, 105600
s_mov_b32 s41, 524416
buffer_load_dwordx4 v13, s[20:23], s40 offen offset:0 lds
s_add_u32 m0, s35, 109824
s_mov_b32 s40, 786560
buffer_load_dwordx4 v13, s[20:23], s41 offen offset:0 lds
s_add_u32 m0, s35, 114048
s_mov_b32 s41, 1048704
buffer_load_dwordx4 v13, s[20:23], s40 offen offset:0 lds
s_add_u32 m0, s35, 118272
s_mov_b32 s40, 1310848
buffer_load_dwordx4 v13, s[20:23], s41 offen offset:0 lds
s_add_u32 m0, s35, 122496
v_lshrrev_b32 v22, 8, v15
buffer_load_dwordx4 v13, s[20:23], s40 offen offset:0 lds
v_bfe_u32 v23, v15, 7, 1
v_cmp_gt_u32 vcc, 12, v22
v_mul_u32_u24 v22, 8192, v22
v_lshl_add_u32 v22, v23, 7, v22
v_cndmask_b32 v22, 2.0, v22, vcc
s_mul_i32 s52, s62, 98304
s_add_u32 s52, s52, 256
buffer_load_dword a60, v22, s[20:23], s52 offen
s_add_u32 s41, s36, 384
s_add_u32 m0, s3, 2048
s_add_u32 s40, s36, 7552
buffer_load_dwordx4 v14, s[8:11], s41 offen offset:0 lds
s_add_u32 m0, s3, 4096
s_add_u32 s41, s36, 14720
buffer_load_dwordx4 v14, s[8:11], s40 offen offset:0 lds
s_add_u32 m0, s3, 3072
s_add_u32 s40, s36, 21888
buffer_load_dwordx4 v14, s[8:11], s41 offen offset:0 lds
s_add_u32 m0, s3, 5120
s_add_u32 s41, s37, 384
buffer_load_dwordx4 v14, s[8:11], s40 offen offset:0 lds
s_add_u32 m0, s3, 6144
s_nop 0
buffer_load_dwordx4 v14, s[8:11], s41 offen offset:0 lds
s_waitcnt vmcnt(12)
s_barrier
RD v[100:103],v0,0
RD v[112:115],v0,64
RD v[104:107],v0,1024
RD v[116:119],v0,1088
RD v[96:99],v1,5248
RD v[108:111],v1,5312
RD v[124:127],v0,4224
RD v[136:139],v0,4288
RD v[120:123],v1,7360
RD v[132:135],v1,7424
v_add_u32 v0, 67584, v0
RD v[128:131],v0,0
RD v[140:143],v0,64
RD v[148:151],v0,1024
RD v[160:163],v0,1088
RD v[152:155],v0,4224
LG 12
RD v[164:167],v0,4288
v_add_u32 v1, 67584, v1
RD v[144:147],v1,5248
RD v[156:159],v1,5312
LG 12
TR a[0:1],v8,33792
TR a[2:3],v8,34048
TR a[4:5],v8,38016
LG 12
TR a[6:7],v8,38272
TR a[8:9],v8,42240
TR a[10:11],v8,42496
LG 12
TR a[12:13],v8,46464
TR a[14:15],v8,46720
TR a[16:17],v8,50688
LG 12
TR a[18:19],v8,50944
TR a[20:21],v8,54912
TR a[22:23],v8,55168
LG 12
s_barrier
LG 0
M v[56:59],a[0:3],v[96:99],0
s_add_u32 m0, s34, 0
TR a[24:25],v8,33800
TR a[26:27],v8,34056
MC v[56:59],a[4:7],v[108:111]
s_add_u32 s40, s36, 512
TR a[28:29],v8,38024
TR a[30:31],v8,38280
MC v[56:59],a[8:11],v[120:123]
s_add_u32 s41, s36, 7680
TR a[32:33],v8,42248
TR a[34:35],v8,42504
MC v[56:59],a[12:15],v[132:135]
s_mul_i32 s52, s62, 131072
TR a[36:37],v8,46472
buffer_load_dwordx4 v14, s[8:11], s40 offen offset:0 lds
MC v[56:59],a[16:19],v[144:147]
s_add_u32 m0, s34, 2112
TR a[38:39],v8,46728
TR v[36:37],v8,50696
MC v[56:59],a[20:23],v[156:159]
s_add_u32 s40, s36, 14848
TR v[38:39],v8,50952
TR v[40:41],v8,54920
M v[60:63],a[0:3],v[100:103],0
s_add_u32 s52, s52, 1572864
TR v[42:43],v8,55176
v_bfe_u32 v23, v15, 7, 2
MC v[60:63],a[4:7],v[112:115]
s_mul_i32 s50, s33, 16960
buffer_load_dwordx4 v14, s[8:11], s41 offen offset:0 lds
MC v[60:63],a[8:11],v[124:127]
s_add_u32 m0, s34, 1024
TR v[44:45],v9,33792
v_lshrrev_b32 v22, 9, v15
MC v[60:63],a[12:15],v[136:139]
s_add_u32 s41, s36, 22016
TR v[46:47],v9,34048
v_cmp_gt_u32 vcc, 16, v22
MC v[60:63],a[16:19],v[148:151]
LG 8
TR v[48:49],v9,38016
v_mul_u32_u24 v22, 8192, v22
MC v[60:63],a[20:23],v[160:163]
s_mul_i32 s101, s33, 16832
buffer_load_dwordx4 v14, s[8:11], s40 offen offset:0 lds
M v[64:67],a[0:3],v[104:107],0
s_add_u32 m0, s34, 3136
TR v[50:51],v9,38272
v_lshl_add_u32 v22, v23, 7, v22
MC v[64:67],a[4:7],v[116:119]
s_add_u32 s40, s37, 512
TR v[52:53],v9,42240
v_cndmask_b32 v22, 2.0, v22, vcc
MC v[64:67],a[8:11],v[128:131]
s_add_u32 s101, s101, 64
TR v[54:55],v9,42496
v_add_u32 v8, 67584, v8
MC v[64:67],a[12:15],v[140:143]
s_or_b32 s51, s38, s43
buffer_load_dwordx4 v14, s[8:11], s41 offen offset:0 lds
MC v[64:67],a[16:19],v[152:155]
s_add_u32 m0, s39, 5248
TR a[40:41],v9,46464
v_subrev_u32 v0, 67584, v0
MC v[64:67],a[20:23],v[164:167]
s_add_u32 s41, s36, 640
TR a[42:43],v9,46720
v_subrev_u32 v1, 67584, v1
M v[68:71],a[24:27],v[96:99],0
LG 5
TR a[44:45],v9,50688
v_add_u32 v6, 67584, v6
MC v[68:71],a[28:31],v[108:111]
s_cmp_eq_u32 s51, 0
s_cselect_b32 s51, 286720, 2.0
buffer_load_dwordx4 v14, s[8:11], s40 offen offset:0 lds
MC v[68:71],a[32:35],v[120:123]
s_add_u32 m0, s34, 4224
TR a[46:47],v9,50944
v_add_u32 v4, 67584, v4
MC v[68:71],a[36:39],v[132:135]
s_add_u32 s40, s36, 7808
TR a[0:1],v9,54912
v_add_u32 v5, 67584, v5
MC v[68:71],v[36:39],v[144:147]
TR a[2:3],v9,55168
v_add_u32 v7, 67584, v7
MC v[68:71],v[40:43],v[156:159]
buffer_load_dwordx4 v14, s[8:11], s41 offen offset:0 lds
M v[72:75],a[24:27],v[100:103],0
s_add_u32 m0, s34, 6336
TR a[4:5],v9,33800
s_add_u32 s41, s37, 640
MC v[72:75],a[28:31],v[112:115]
TR a[6:7],v9,34056
MC v[72:75],a[32:35],v[124:127]
TR a[8:9],v9,38024
MC v[72:75],a[36:39],v[136:139]
buffer_load_dwordx4 v14, s[8:11], s40 offen offset:0 lds
MC v[72:75],v[36:39],v[148:151]
s_add_u32 m0, s39, 7360
TR a[10:11],v9,38280
s_mov_b32 s40, 256
MC v[72:75],v[40:43],v[160:163]
TR a[12:13],v9,42248
M v[76:79],a[24:27],v[104:107],0
LG 5
TR a[14:15],v9,42504
MC v[76:79],a[28:31],v[116:119]
buffer_load_dword a60, v22, s[20:23], s52 offen
MC v[76:79],a[32:35],v[128:131]
s_lshl_b32 s52, s32, 13
TR a[16:17],v9,46472
v_bfe_u32 v22, v12, 4, 6
MC v[76:79],a[36:39],v[140:143]
s_add_u32 s52, s52, 0
TR a[18:19],v9,46728
v_lshrrev_b32 v23, 3, v22
MC v[76:79],v[36:39],v[152:155]
TR a[20:21],v9,50696
v_and_b32 v22, 7, v22
MC v[76:79],v[40:43],v[164:167]
buffer_load_dwordx4 v14, s[8:11], s41 offen offset:0 lds
M v[80:83],v[44:47],v[100:103],0
s_add_u32 m0, s35, 67584
TR a[22:23],v9,50952
v_cmp_gt_u32 vcc, 4, v23
MC v[80:83],v[48:51],v[112:115]
s_mov_b32 s41, 262400
TR a[24:25],v9,54920
v_add_u32 v21, 0, v23
MC v[80:83],v[52:55],v[124:127]
TR a[26:27],v9,55176
v_lshlrev_b32 v22, 7, v22
MC v[80:83],a[40:43],v[136:139]
buffer_load_dwordx4 v13, s[20:23], s40 offen offset:0 lds
MC v[80:83],a[44:47],v[148:151]
s_waitcnt vmcnt(10)
s_barrier
v_add_u32 v9, 67584, v9
MC v[80:83],a[0:3],v[160:163]
s_add_u32 m0, s35, 71808
RD v[172:175],v2,2048
RD v[184:187],v2,2112
M v[84:87],v[44:47],v[104:107],0
LG 5
RD v[176:179],v2,3072
RD v[188:191],v2,3136
MC v[84:87],v[48:51],v[116:119]
s_mov_b32 s40, 524544
RD v[168:171],v3,6144
buffer_load_dwordx4 v13, s[20:23], s41 offen offset:0 lds
MC v[84:87],v[52:55],v[128:131]
s_add_u32 m0, s35, 76032
RD v[180:183],v3,6208
TR a[28:29],v8,33792
MC v[84:87],a[40:43],v[140:143]
s_mov_b32 s41, 786688
TR a[30:31],v8,34048
TR a[32:33],v8,38016
MC v[84:87],a[44:47],v[152:155]
TR a[34:35],v8,38272
TR a[36:37],v8,42240
MC v[84:87],a[0:3],v[164:167]
LG 11
TR a[38:39],v8,42496
buffer_load_dwordx4 v13, s[20:23], s40 offen offset:0 lds
M v[88:91],a[4:7],v[100:103],0
s_add_u32 m0, s35, 80256
TR v[36:37],v8,46464
TR v[38:39],v8,46720
MC v[88:91],a[8:11],v[112:115]
LG 12
TR v[40:41],v8,50688
TR v[42:43],v8,50944
MC v[88:91],a[12:15],v[124:127]
LG 12
TR v[44:45],v8,54912
TR v[46:47],v8,55168
MC v[88:91],a[16:19],v[136:139]
LG 12
TR v[48:49],v8,33800
buffer_load_dwordx4 v13, s[20:23], s41 offen offset:0 lds
MC v[88:91],a[20:23],v[148:151]
s_add_u32 m0, s35, 84480
TR v[50:51],v8,34056
TR v[52:53],v8,38024
MC v[88:91],a[24:27],v[160:163]
LG 12
TR v[54:55],v8,38280
s_mov_b32 s40, 1048832
M v[92:95],a[4:7],v[104:107],0
s_mov_b32 s41, 1310976
TR a[40:41],v8,42248
v_and_b32 v21, 3, v21
MC v[92:95],a[8:11],v[116:119]
LG 11
TR a[42:43],v8,42504
buffer_load_dwordx4 v13, s[20:23], s40 offen offset:0 lds
MC v[92:95],a[12:15],v[128:131]
s_add_u32 m0, s35, 88704
TR a[44:45],v8,46472
v_mul_u32_u24 v23, 32768, v23
MC v[92:95],a[16:19],v[140:143]
s_add_u32 s40, s36, 14976
TR a[46:47],v8,46728
v_lshl_add_u32 v22, v21, 10, v22
MC v[92:95],a[20:23],v[152:155]
LG 8
TR a[0:1],v8,50696
v_add_u32 v22, v22, v23
MC v[92:95],a[24:27],v[164:167]
buffer_load_dwordx4 v13, s[20:23], s41 offen offset:0 lds
M a[160:163],a[28:31],v[96:99],0
s_add_u32 m0, s34, 33792
TR a[2:3],v8,50952
v_bfe_u32 v21, v12, 4, 6
MC a[160:163],a[32:35],v[108:111]
s_add_u32 s41, s36, 22144
TR a[4:5],v8,54920
v_add_u32 v22, 32768, v22
MC a[160:163],a[36:39],v[120:123]
TR a[6:7],v8,55176
v_bfe_u32 v23, v15, 7, 1
MC a[160:163],v[36:39],v[132:135]
buffer_load_dwordx4 v14, s[8:11], s40 offen offset:0 lds
MC a[160:163],v[40:43],v[144:147]
s_add_u32 m0, s34, 35904
TR a[8:9],v9,33792
v_xor_b32 v22, s63, v22
MC a[160:163],v[44:47],v[156:159]
s_add_u32 s40, s36, 768
TR a[10:11],v9,34048
v_cndmask_b32 v22, 2.0, v22, vcc
M a[164:167],a[28:31],v[100:103],0
LG 5
TR a[12:13],v9,38016
MC a[164:167],a[32:35],v[112:115]
buffer_load_dwordx4 v14, s[8:11], s41 offen offset:0 lds
MC a[164:167],a[36:39],v[124:127]
s_add_u32 m0, s34, 34816
TR a[14:15],v9,38272
s_add_u32 s41, s36, 7936
MC a[164:167],v[36:39],v[136:139]
TR a[16:17],v9,42240
MC a[164:167],v[40:43],v[148:151]
TR a[18:19],v9,42496
MC a[164:167],v[44:47],v[160:163]
buffer_load_dwordx4 v14, s[8:11], s40 offen offset:0 lds
M a[168:171],a[28:31],v[104:107],0
s_add_u32 m0, s34, 36928
TR a[20:21],v9,46464
s_add_u32 s40, s36, 15104
MC a[168:171],a[32:35],v[116:119]
TR a[22:23],v9,46720
MC a[168:171],a[36:39],v[128:131]
TR a[24:25],v9,50688
MC a[168:171],v[36:39],v[140:143]
buffer_load_dwordx4 v14, s[8:11], s41 offen offset:0 lds
MC a[168:171],v[40:43],v[152:155]
s_add_u32 m0, s34, 38016
TR a[26:27],v9,50944
s_add_u32 s41, s36, 22272
MC a[168:171],v[44:47],v[164:167]
TR a[28:29],v9,54912
M a[172:175],v[48:51],v[96:99],0
LG 5
TR a[30:31],v9,55168
MC a[172:175],v[52:55],v[108:111]
buffer_load_dwordx4 v14, s[8:11], s40 offen offset:0 lds
MC a[172:175],a[40:43],v[120:123]
s_add_u32 m0, s34, 40128
TR a[32:33],v9,33800
s_add_u32 s40, s37, 768
MC a[172:175],a[44:47],v[132:135]
TR a[34:35],v9,34056
MC a[172:175],a[0:3],v[144:147]
TR a[36:37],v9,38024
MC a[172:175],a[4:7],v[156:159]
buffer_load_dwordx4 v14, s[8:11], s41 offen offset:0 lds
M a[176:179],v[48:51],v[100:103],0
s_add_u32 m0, s39, 39040
TR a[38:39],v9,38280
s_mov_b32 s41, 1572864
MC a[176:179],v[52:55],v[112:115]
TR v[36:37],v9,42248
MC a[176:179],a[40:43],v[124:127]
TR v[38:39],v9,42504
MC a[176:179],a[44:47],v[136:139]
buffer_load_dwordx4 v14, s[8:11], s40 offen offset:0 lds
MC a[176:179],a[0:3],v[148:151]
s_add_u32 m0, s35, 0
TR v[40:41],v9,46472
s_mov_b32 s40, 1835008
MC a[176:179],a[4:7],v[160:163]
TR v[42:43],v9,46728
M a[180:183],v[48:51],v[104:107],0
LG 5
TR v[44:45],v9,50696
MC a[180:183],v[52:55],v[116:119]
TR v[46:47],v9,50952
MC a[180:183],a[40:43],v[128:131]
s_waitcnt vmcnt(13)
s_barrier
MC a[180:183],a[44:47],v[140:143]
TR v[48:49],v9,54920
MC a[180:183],a[0:3],v[152:155]
TR v[50:51],v9,55176
MC a[180:183],a[4:7],v[164:167]
RD v[196:199],v0,0
M a[184:187],a[8:11],v[100:103],0
RD v[208:211],v0,64
MC a[184:187],a[12:15],v[112:115]
RD v[200:203],v0,1024
MC a[184:187],a[16:19],v[124:127]
RD v[212:215],v0,1088
MC a[184:187],a[20:23],v[136:139]
RD v[192:195],v1,5248
MC a[184:187],a[24:27],v[148:151]
LG 7
RD v[204:207],v1,5312
MC a[184:187],a[28:31],v[160:163]
RD v[220:223],v0,4224
M a[188:191],a[8:11],v[104:107],0
RD v[232:235],v0,4288
MC a[188:191],a[12:15],v[116:119]
RD v[216:219],v1,7360
MC a[188:191],a[16:19],v[128:131]
RD v[228:231],v1,7424
MC a[188:191],a[20:23],v[140:143]
s_waitcnt vmcnt(7)
s_barrier
MC a[188:191],a[24:27],v[152:155]
TR v[52:53],v8,0
TR v[54:55],v8,256
MC a[188:191],a[28:31],v[164:167]
LG 7
TR a[40:41],v8,4224
TR a[42:43],v8,4480
M a[192:195],a[32:35],v[100:103],0
TR a[44:45],v8,8448
TR a[46:47],v8,8704
MC a[192:195],a[36:39],v[112:115]
TR a[0:1],v8,12672
TR a[2:3],v8,12928
MC a[192:195],v[36:39],v[124:127]
TR a[4:5],v8,16896
TR a[6:7],v8,17152
MC a[192:195],v[40:43],v[136:139]
LG 11
TR a[8:9],v8,21120
TR a[10:11],v8,21376
MC a[192:195],v[44:47],v[148:151]
TR a[12:13],v8,8
TR a[14:15],v8,264
MC a[192:195],v[48:51],v[160:163]
LG 12
TR a[16:17],v8,4232
TR a[18:19],v8,4488
M a[196:199],a[32:35],v[104:107],0
LG 12
TR a[20:21],v8,8456
TR a[22:23],v8,8712
MC a[196:199],a[36:39],v[116:119]
LG 12
TR a[24:25],v8,12680
TR a[26:27],v8,12936
MC a[196:199],v[36:39],v[128:131]
LG 12
TR a[28:29],v8,16904
buffer_load_dwordx4 v13, s[20:23], s41 offen offset:0 lds
MC a[196:199],v[40:43],v[140:143]
s_add_u32 m0, s35, 4224
TR a[30:31],v8,17160
s_mov_b32 s41, 2097152
MC a[196:199],v[44:47],v[152:155]
LG 12
TR a[32:33],v8,21128
MC a[196:199],v[48:51],v[164:167]
TR a[34:35],v8,21384
v_subrev_u32 v8, 67584, v8
M a[200:203],v[52:55],v[96:99],0
buffer_load_dwordx4 v13, s[20:23], s40 offen offset:0 lds
MC a[200:203],a[40:43],v[108:111]
LG 8
TR a[36:37],v9,0
s_add_u32 m0, s35, 8448
MC a[200:203],a[44:47],v[120:123]
s_mov_b32 s40, 2359296
TR a[38:39],v9,256
MC a[200:203],a[0:3],v[132:135]
Y_pg1:
s_cbranch_execz Y_pg5
TR v[36:37],v9,4224
MC a[200:203],a[4:7],v[144:147]
buffer_load_dwordx4 v13, s[20:23], s41 offen offset:0 lds
MC a[200:203],a[8:11],v[156:159]
s_add_u32 m0, s35, 12672
TR v[38:39],v9,4480
s_mov_b32 s41, 2621440
M a[204:207],v[52:55],v[100:103],0
TR v[40:41],v9,8448
MC a[204:207],a[40:43],v[112:115]
TR v[42:43],v9,8704
MC a[204:207],a[44:47],v[124:127]
buffer_load_dwordx4 v13, s[20:23], s40 offen offset:0 lds
MC a[204:207],a[0:3],v[136:139]
LG 5
TR v[44:45],v9,12672
s_add_u32 m0, s35, 16896
MC a[204:207],a[4:7],v[148:151]
s_mov_b32 s40, 2883584
TR v[46:47],v9,12928
MC a[204:207],a[8:11],v[160:163]
TR v[48:49],v9,16896
M a[208:211],v[52:55],v[104:107],0
buffer_load_dwordx4 v13, s[20:23], s41 offen offset:0 lds
MC a[208:211],a[40:43],v[116:119]
s_add_u32 m0, s35, 21120
TR v[50:51],v9,17152
s_mov_b32 s41, 3145728
MC a[208:211],a[44:47],v[128:131]
TR v[52:53],v9,21120
MC a[208:211],a[0:3],v[140:143]
TR v[54:55],v9,21376
MC a[208:211],a[4:7],v[152:155]
buffer_load_dwordx4 v13, s[20:23], s40 offen offset:0 lds
MC a[208:211],a[8:11],v[164:167]
s_add_u32 m0, s35, 25344
TR a[40:41],v9,8
s_mov_b32 s40, 3407872
M a[212:215],a[12:15],v[96:99],0
TR a[42:43],v9,264
MC a[212:215],a[16:19],v[108:111]
TR a[44:45],v9,4232
MC a[212:215],a[20:23],v[120:123]
buffer_load_dwordx4 v13, s[20:23], s41 offen offset:0 lds
MC a[212:215],a[24:27],v[132:135]
LG 5
TR a[46:47],v9,4488
s_add_u32 m0, s35, 29568
MC a[212:215],a[28:31],v[144:147]
s_mov_b32 s41, 1572992
TR a[0:1],v9,8456
MC a[212:215],a[32:35],v[156:159]
TR a[2:3],v9,8712
M a[216:219],a[12:15],v[100:103],0
buffer_load_dwordx4 v13, s[20:23], s40 offen offset:0 lds
MC a[216:219],a[16:19],v[112:115]
s_add_u32 m0, s35, 101376
TR a[4:5],v9,12680
s_mov_b32 s40, 1835136
MC a[216:219],a[20:23],v[124:127]
TR a[6:7],v9,12936
MC a[216:219],a[24:27],v[136:139]
TR a[8:9],v9,16904
MC a[216:219],a[28:31],v[148:151]
buffer_load_dwordx4 v13, s[20:23], s41 offen offset:0 lds
MC a[216:219],a[32:35],v[160:163]
s_add_u32 m0, s35, 105600
TR a[10:11],v9,17160
s_mov_b32 s41, 2097280
M a[220:223],a[12:15],v[104:107],0
s_waitcnt vmcnt(9)
s_barrier
MC a[220:223],a[16:19],v[116:119]
TR a[12:13],v9,21128
MC a[220:223],a[20:23],v[128:131]
buffer_load_dwordx4 v13, s[20:23], s40 offen offset:0 lds
MC a[220:223],a[24:27],v[140:143]
s_add_u32 m0, s35, 109824
TR a[14:15],v9,21384
s_mov_b32 s40, 2359424
MC a[220:223],a[28:31],v[152:155]
LG 4
RD v[224:227],v0,33792
v_subrev_u32 v9, 67584, v9
MC a[220:223],a[32:35],v[164:167]
RD v[236:239],v0,33856
M a[224:227],a[36:39],v[100:103],0
buffer_load_dwordx4 v13, s[20:23], s41 offen offset:0 lds
MC a[224:227],v[36:39],v[112:115]
s_add_u32 m0, s35, 114048
RD v[244:247],v0,34816
s_mov_b32 s41, 2621568
MC a[224:227],v[40:43],v[124:127]
RD a[48:51],v0,34880
MC a[224:227],v[44:47],v[136:139]
RD v[248:251],v0,38016
MC a[224:227],v[48:51],v[148:151]
buffer_load_dwordx4 v13, s[20:23], s40 offen offset:0 lds
MC a[224:227],v[52:55],v[160:163]
s_add_u32 m0, s35, 118272
RD a[52:55],v0,38080
s_mov_b32 s40, 2883712
M a[228:231],a[36:39],v[104:107],0
RD v[240:243],v1,39040
MC a[228:231],v[36:39],v[116:119]
RD v[252:255],v1,39104
MC a[228:231],v[40:43],v[128:131]
s_waitcnt vmcnt(4)
s_barrier
MC a[228:231],v[44:47],v[140:143]
TR a[16:17],v8,0
buffer_load_dwordx4 v13, s[20:23], s41 offen offset:0 lds
MC a[228:231],v[48:51],v[152:155]
s_add_u32 m0, s35, 122496
TR a[18:19],v8,256
TR a[20:21],v8,4224
MC a[228:231],v[52:55],v[164:167]
LG 6
TR a[22:23],v8,4480
TR a[24:25],v8,8448
M a[232:235],a[40:43],v[100:103],0
s_mov_b32 s41, 3145856
TR a[26:27],v8,8704
TR a[28:29],v8,12672
MC a[232:235],a[44:47],v[112:115]
TR a[30:31],v8,12928
buffer_load_dwordx4 v13, s[20:23], s40 offen offset:0 lds
MC a[232:235],a[0:3],v[124:127]
s_add_u32 m0, s35, 126720
TR a[32:33],v8,16896
TR a[34:35],v8,17152
MC a[232:235],a[4:7],v[136:139]
s_mov_b32 s40, 3408000
TR a[36:37],v8,21120
TR a[38:39],v8,21376
MC a[232:235],a[8:11],v[148:151]
LG 12
TR v[36:37],v8,25344
TR v[38:39],v8,25600
MC a[232:235],a[12:15],v[160:163]
LG 12
TR v[40:41],v8,29568
buffer_load_dwordx4 v13, s[20:23], s41 offen offset:0 lds
M a[236:239],a[40:43],v[104:107],0
s_add_u32 m0, s35, 130944
TR v[42:43],v8,29824
s_mov_b32 s41, 1573120
MC a[236:239],a[44:47],v[116:119]
LG 11
TR v[44:45],v8,8
MC a[236:239],a[0:3],v[128:131]
TR v[46:47],v8,264
MC a[236:239],a[4:7],v[140:143]
buffer_load_dwordx4 v13, s[20:23], s40 offen offset:0 lds
MC a[236:239],a[8:11],v[152:155]
s_add_u32 m0, s35, 33792
TR v[48:49],v8,4232
s_mov_b32 s40, 1835264
MC a[236:239],a[12:15],v[164:167]
LG 7
TR v[50:51],v8,4488
MC v[56:59],a[16:19],v[168:171]
TR v[52:53],v8,8456
MC v[56:59],a[20:23],v[180:183]
TR v[54:55],v8,8712
MC v[56:59],a[24:27],v[192:195]
TR a[40:41],v8,12680
buffer_load_dwordx4 v13, s[20:23], s41 offen offset:0 lds
MC v[56:59],a[28:31],v[204:207]
s_add_u32 m0, s35, 38016
TR a[42:43],v8,12936
s_mov_b32 s41, 2097408
MC v[56:59],a[32:35],v[216:219]
TR a[44:45],v8,16904
MC v[56:59],a[36:39],v[228:231]
LG 7
TR a[46:47],v8,17160
MC v[56:59],v[36:39],v[240:243]
buffer_load_dwordx4 v13, s[20:23], s40 offen offset:0 lds
MC v[56:59],v[40:43],v[252:255]
s_add_u32 m0, s35, 42240
TR a[0:1],v8,21128
s_mov_b32 s40, 2359552
MC v[60:63],a[16:19],v[172:175]
TR a[2:3],v8,21384
s_nop 0
MC v[60:63],a[20:23],v[184:187]
TR a[4:5],v8,25352
v_mul_f32 v56, s42, v56
MC v[60:63],a[24:27],v[196:199]
buffer_load_dwordx4 v13, s[20:23], s41 offen offset:0 lds
MC v[60:63],a[28:31],v[208:211]
s_add_u32 m0, s35, 46464
TR a[6:7],v8,25608
v_mul_f32 v57, s42, v57
MC v[60:63],a[32:35],v[220:223]
s_mov_b32 s41, 2621696
TR a[8:9],v8,29576
v_mul_f32 v58, s42, v58
MC v[60:63],a[36:39],v[232:235]
TR a[10:11],v8,29832
v_mul_f32 v59, s42, v59
MC v[60:63],v[36:39],v[244:247]
buffer_load_dwordx4 v13, s[20:23], s40 offen offset:0 lds
MC v[60:63],v[40:43],a[48:51]
LG 5
TR a[12:13],v9,0
v_add_u32 v8, 67584, v8
MC v[64:67],a[16:19],v[176:179]
s_add_u32 m0, s35, 50688
TR a[14:15],v9,256
CV v56,v56,v57
MC v[64:67],a[20:23],v[188:191]
s_mov_b32 s40, 2883840
TR a[16:17],v9,4224
AW a64,v56
MC v[64:67],a[24:27],v[200:203]
buffer_load_dwordx4 v13, s[20:23], s41 offen offset:0 lds
MC v[64:67],a[28:31],v[212:215]
s_add_u32 m0, s35, 54912
TR a[18:19],v9,4480
CV v57,v58,v59
MC v[64:67],a[32:35],v[224:227]
s_mov_b32 s41, 3145984
TR a[20:21],v9,8448
AW a65,v57
MC v[64:67],a[36:39],v[236:239]
TR a[22:23],v9,8704
v_mul_f32 v60, s42, v60
MC v[64:67],v[36:39],v[248:251]
buffer_load_dwordx4 v13, s[20:23], s40 offen offset:0 lds
MC v[64:67],v[40:43],a[52:55]
s_add_u32 m0, s35, 59136
TR a[24:25],v9,12672
v_mul_f32 v61, s42, v61
MC v[68:71],v[44:47],v[168:171]
s_mov_b32 s40, 3408128
TR a[26:27],v9,12928
v_mul_f32 v62, s42, v62
MC v[68:71],v[48:51],v[180:183]
TR a[28:29],v9,16896
v_mul_f32 v63, s42, v63
MC v[68:71],v[52:55],v[192:195]
buffer_load_dwordx4 v13, s[20:23], s41 offen offset:0 lds
MC v[68:71],a[40:43],v[204:207]
LG 5
TR a[30:31],v9,17152
CV v60,v60,v61
MC v[68:71],a[44:47],v[216:219]
s_add_u32 m0, s35, 63360
TR a[32:33],v9,21120
AW a96,v60
MC v[68:71],a[0:3],v[228:231]
s_mov_b32 s41, 384
TR a[34:35],v9,21376
CV v61,v62,v63
MC v[68:71],a[4:7],v[240:243]
buffer_load_dword a60, v22, s[12:15], s52 offen
MC v[68:71],a[8:11],v[252:255]
s_mul_i32 s52, s62, 229376
TR a[36:37],v9,25344
AW a97,v61
MC v[72:75],v[44:47],v[172:175]
s_add_u32 s52, s52, 512
TR a[38:39],v9,25600
v_mul_f32 v64, s42, v64
MC v[72:75],v[48:51],v[184:187]
TR v[36:37],v9,29568
v_mul_f32 v68, s42, v68
MC v[72:75],v[52:55],v[196:199]
TR v[38:39],v9,29824
v_mul_f32 v69, s42, v69
MC v[72:75],a[40:43],v[208:211]
TR v[40:41],v9,8
buffer_load_dwordx4 v13, s[20:23], s40 offen offset:0 lds
v_mul_f32 v70, s42, v70
MC v[72:75],a[44:47],v[220:223]
s_add_u32 m0, s35, 67584
TR v[42:43],v9,264
v_mul_f32 v71, s42, v71
MC v[72:75],a[0:3],v[232:235]
s_mov_b32 s40, 262528
CV v58,v68,v69
CV v59,v70,v71
MC v[72:75],a[4:7],v[244:247]
LG 6
ds_write_b128 v16, v[56:59] offset:2048
MC v[72:75],a[8:11],a[48:51]
buffer_load_dwordx4 v13, s[20:23], s41 offen offset:0 lds
MC v[76:79],v[44:47],v[176:179]
s_add_u32 m0, s35, 71808
TR v[44:45],v9,4232
v_mul_f32 v65, s42, v65
MC v[76:79],v[48:51],v[188:191]
s_mov_b32 s41, 524672
TR v[46:47],v9,4488
v_mul_f32 v66, s42, v66
MC v[76:79],v[52:55],v[200:203]
TR v[48:49],v9,8456
TR v[50:51],v9,8712
MC v[76:79],a[40:43],v[212:215]
TR v[52:53],v9,12680
v_mul_f32 v67, s42, v67
MC v[76:79],a[44:47],v[224:227]
TR v[54:55],v9,12936
CV v64,v64,v65
MC v[76:79],a[0:3],v[236:239]
TR a[40:41],v9,16904
AW a128,v64
MC v[76:79],a[4:7],v[248:251]
LG 7
TR a[42:43],v9,17160
buffer_load_dwordx4 v13, s[20:23], s40 offen offset:0 lds
MC v[76:79],a[8:11],a[52:55]
s_add_u32 m0, s35, 76032
TR a[44:45],v9,21128
CV v65,v66,v67
MC v[80:83],a[12:15],v[172:175]
s_mov_b32 s40, 786816
TR a[46:47],v9,21384
AW a129,v65
MC v[80:83],a[16:19],v[184:187]
TR a[0:1],v9,25352
v_and_b32 v22, 15, v21
MC v[80:83],a[20:23],v[196:199]
TR a[2:3],v9,25608
v_mul_u32_u24 v22, 1056, v22
MC v[80:83],a[24:27],v[208:211]
TR a[4:5],v9,29576
v_and_b32 v21, 48, v21
MC v[80:83],a[28:31],v[220:223]
buffer_load_dwordx4 v13, s[20:23], s41 offen offset:0 lds
MC v[80:83],a[32:35],v[232:235]
s_add_u32 m0, s35, 80256
TR a[6:7],v9,29832
v_add3_u32 v0, v21, v22, s50
MC v[80:83],a[36:39],v[244:247]
s_waitcnt vmcnt(12)
s_barrier
v_add3_u32 v1, v21, v22, s101
MC v[80:83],v[36:39],a[48:51]
LG 5
TR a[8:9],v8,33792
AW a66,v58
MC v[84:87],a[12:15],v[176:179]
s_sub_u32 s50, 16960, s50
TR a[10:11],v8,34048
AW a67,v59
MC v[84:87],a[16:19],v[188:191]
s_sub_u32 s101, 16960, s101
TR a[12:13],v8,38016
TR a[14:15],v8,38272
MC v[84:87],a[20:23],v[200:203]
s_mov_b32 s41, 1048960
TR a[16:17],v8,42240
buffer_load_dwordx4 v13, s[20:23], s40 offen offset:0 lds
MC v[84:87],a[24:27],v[212:215]
s_add_u32 m0, s35, 84480
TR a[18:19],v8,42496
v_add3_u32 v3, v21, v22, s50
MC v[84:87],a[28:31],v[224:227]
s_mov_b32 s40, 1311104
TR a[20:21],v8,46464
v_add3_u32 v2, v21, v22, s101
MC v[84:87],a[32:35],v[236:239]
TR a[22:23],v8,46720
v_lshrrev_b32 v22, 8, v15
MC v[84:87],a[36:39],v[248:251]
TR a[24:25],v8,50688
v_cmp_gt_u32 vcc, 28, v22
MC v[84:87],v[36:39],a[52:55]
LG 8
TR a[26:27],v8,50944
v_mul_u32_u24 v22, 8192, v22
MC v[88:91],v[40:43],v[172:175]
TR a[28:29],v8,54912
buffer_load_dwordx4 v13, s[20:23], s41 offen offset:0 lds
MC v[88:91],v[44:47],v[184:187]
s_add_u32 m0, s35, 88704
TR a[30:31],v8,55168
v_lshl_add_u32 v22, v23, 7, v22
MC v[88:91],v[48:51],v[196:199]
s_mov_b32 s41, 1573248
TR a[32:33],v8,59136
v_cndmask_b32 v22, 2.0, v22, vcc
MC v[88:91],v[52:55],v[208:211]
TR a[34:35],v8,59392
v_mul_f32 v72, s42, v72
MC v[88:91],a[40:43],v[220:223]
TR a[36:37],v8,63360
v_mul_f32 v73, s42, v73
MC v[88:91],a[44:47],v[232:235]
LG 7
TR a[38:39],v8,63616
v_mul_f32 v74, s42, v74
MC v[88:91],a[0:3],v[244:247]
buffer_load_dwordx4 v13, s[20:23], s40 offen offset:0 lds
MC v[88:91],a[4:7],a[48:51]
s_add_u32 m0, s35, 0
TR v[36:37],v8,33800
v_mul_f32 v75, s42, v75
MC v[92:95],v[40:43],v[176:179]
s_mov_b32 s40, 1835392
TR v[38:39],v8,34056
CV v62,v72,v73
MC v[92:95],v[44:47],v[188:191]
TR v[40:41],v8,38024
CV v63,v74,v75
MC v[92:95],v[48:51],v[200:203]
buffer_load_dwordx4 v13, s[20:23], s41 offen offset:0 lds
MC v[92:95],v[52:55],v[212:215]
s_add_u32 m0, s35, 4224
TR v[42:43],v8,38280
AW a98,v62
MC v[92:95],a[40:43],v[224:227]
s_mov_b32 s41, 2097536
TR v[44:45],v8,42248
AW a99,v63
MC v[92:95],a[44:47],v[236:239]
TR v[46:47],v8,42504
v_add_u32 v9, 67584, v9
MC v[92:95],a[0:3],v[248:251]
LG 6
TR v[48:49],v8,46472
v_mul_f32 v76, s42, v76
MC v[92:95],a[4:7],a[52:55]
TR v[50:51],v8,46728
v_mul_f32 v77, s42, v77
MC a[160:163],a[8:11],v[168:171]
buffer_load_dwordx4 v13, s[20:23], s40 offen offset:0 lds
MC a[160:163],a[12:15],v[180:183]
s_add_u32 m0, s35, 8448
TR v[52:53],v8,50696
v_mul_f32 v78, s42, v78
MC a[160:163],a[16:19],v[192:195]
s_mov_b32 s40, 2359680
TR v[54:55],v8,50952
v_mul_f32 v79, s42, v79
MC a[160:163],a[20:23],v[204:207]
TR a[40:41],v8,54920
CV v66,v76,v77
MC a[160:163],a[24:27],v[216:219]
TR a[42:43],v8,55176
CV v67,v78,v79
MC a[160:163],a[28:31],v[228:231]
TR a[44:45],v8,59144
AW a130,v66
MC a[160:163],a[32:35],v[240:243]
TR a[46:47],v8,59400
AW a131,v67
MC a[160:163],a[36:39],v[252:255]
LG 6
TR a[0:1],v8,63368
v_mul_f32 v80, s42, v80
MC a[164:167],a[8:11],v[172:175]
buffer_load_dwordx4 v13, s[20:23], s41 offen offset:0 lds
MC a[164:167],a[12:15],v[184:187]
s_add_u32 m0, s35, 12672
TR a[2:3],v8,63624
v_mul_f32 v81, s42, v81
MC a[164:167],a[16:19],v[196:199]
s_mov_b32 s41, 2621824
TR a[4:5],v9,33792
v_subrev_u32 v8, 67584, v8
MC a[164:167],a[20:23],v[208:211]
TR a[6:7],v9,34048
AR v24,a160
MC a[164:167],a[24:27],v[220:223]
AR v25,a161
AR v26,a162
MC a[164:167],a[28:31],v[232:235]
AR v27,a163
v_mul_f32 v24, s42, v24
MC a[164:167],a[32:35],v[244:247]
v_mul_f32 v25, s42, v25
v_mul_f32 v26, s42, v26
MC a[164:167],a[36:39],a[48:51]
v_mul_f32 v27, s42, v27
CV v32,v24,v25
MC a[168:171],a[8:11],v[176:179]
TR a[8:9],v9,38016
CV v33,v26,v27
MC a[168:171],a[12:15],v[188:191]
TR a[10:11],v9,38272
buffer_load_dwordx4 v13, s[20:23], s40 offen offset:0 lds
MC a[168:171],a[16:19],v[200:203]
s_add_u32 m0, s35, 16896
TR a[12:13],v9,42240
AW a72,v32
MC a[168:171],a[20:23],v[212:215]
s_mov_b32 s40, 2883968
TR a[14:15],v9,42496
AW a73,v33
AR v28,a164
MC a[168:171],a[24:27],v[224:227]
LG 4
TR a[16:17],v9,46464
AR v29,a165
AR v30,a166
MC a[168:171],a[28:31],v[236:239]
TR a[18:19],v9,46720
AR v31,a167
v_mul_f32 v28, s42, v28
MC a[168:171],a[32:35],v[248:251]
TR a[20:21],v9,50688
v_mul_f32 v29, s42, v29
v_mul_f32 v30, s42, v30
MC a[168:171],a[36:39],a[52:55]
TR a[22:23],v9,50944
v_mul_f32 v31, s42, v31
CV v28,v28,v29
MC a[172:175],v[36:39],v[168:171]
TR a[24:25],v9,54912
CV v30,v30,v31
AW a104,v28
MC a[172:175],v[40:43],v[180:183]
TR a[26:27],v9,55168
buffer_load_dwordx4 v13, s[20:23], s41 offen offset:0 lds
AW a105,v30
MC a[172:175],v[44:47],v[192:195]
s_add_u32 m0, s35, 21120
TR a[28:29],v9,59136
AR v24,a168
MC a[172:175],v[48:51],v[204:207]
s_mov_b32 s41, 3146112
TR a[30:31],v9,59392
AR v25,a169
MC a[172:175],v[52:55],v[216:219]
TR a[32:33],v9,63360
AR v26,a170
MC a[172:175],a[40:43],v[228:231]
TR a[34:35],v9,63616
AR v27,a171
MC a[172:175],a[44:47],v[240:243]
LG 7
TR a[36:37],v9,33800
buffer_load_dword a60, v22, s[20:23], s52 offen
MC a[172:175],a[0:3],v[252:255]
s_lshl_b32 s52, s32, 13
TR a[38:39],v9,34056
v_mul_f32 v24, s42, v24
MC a[176:179],v[36:39],v[172:175]
s_add_u32 s52, s52, 4096
v_mul_f32 v25, s42, v25
v_mul_f32 v26, s42, v26
MC a[176:179],v[40:43],v[184:187]
v_mul_f32 v27, s42, v27
CV v24,v24,v25
MC a[176:179],v[44:47],v[196:199]
Y_pg2:
s_cbranch_execz Y_pg6
buffer_load_dwordx4 v13, s[20:23], s40 offen offset:0 lds
MC a[176:179],v[48:51],v[208:211]
s_add_u32 m0, s35, 25344
CV v26,v26,v27
AW a136,v24
AR v28,a172
MC a[176:179],v[52:55],v[220:223]
s_mov_b32 s40, 3408256
AW a137,v26
v_bfe_u32 v22, v12, 4, 6
AR v29,a173
MC a[176:179],a[40:43],v[232:235]
v_lshrrev_b32 v23, 3, v22
AR v30,a174
AR v31,a175
MC a[176:179],a[44:47],v[244:247]
v_and_b32 v22, 7, v22
v_cmp_gt_u32 vcc, 4, v23
v_mul_f32 v28, s42, v28
MC a[176:179],a[0:3],a[48:51]
v_add_u32 v21, 0, v23
v_lshlrev_b32 v22, 7, v22
v_mul_f32 v29, s42, v29
MC a[180:183],v[36:39],v[176:179]
TR v[36:37],v9,38024
v_and_b32 v21, 3, v21
v_mul_f32 v30, s42, v30
MC a[180:183],v[40:43],v[188:191]
TR v[38:39],v9,38280
buffer_load_dwordx4 v13, s[20:23], s41 offen offset:0 lds
v_mul_f32 v31, s42, v31
MC a[180:183],v[44:47],v[200:203]
s_add_u32 m0, s35, 29568
TR v[40:41],v9,42248
v_lshl_add_u32 v22, v21, 10, v22
CV v34,v28,v29
MC a[180:183],v[48:51],v[212:215]
s_mov_b32 s41, 512
TR v[42:43],v9,42504
v_mul_u32_u24 v23, 32768, v23
CV v35,v30,v31
MC a[180:183],v[52:55],v[224:227]
ds_write_b128 v16, v[32:35] offset:3072
MC a[180:183],a[40:43],v[236:239]
LG 5
TR v[44:45],v9,46472
v_add_u32 v22, v22, v23
MC a[180:183],a[44:47],v[248:251]
TR v[46:47],v9,46728
v_mov_b32 v21, 0
MC a[180:183],a[0:3],a[52:55]
TR v[48:49],v9,50696
v_add_u32 v22, 0, v22
MC a[184:187],a[4:7],v[172:175]
TR v[50:51],v9,50952
v_xor_b32 v22, s63, v22
MC a[184:187],a[8:11],v[184:187]
TR v[52:53],v9,54920
v_xor_b32 v22, 131072, v22
MC a[184:187],a[12:15],v[196:199]
TR v[54:55],v9,55176
buffer_load_dwordx4 v13, s[20:23], s40 offen offset:0 lds
MC a[184:187],a[16:19],v[208:211]
s_add_u32 m0, s35, 101376
TR a[40:41],v9,59144
v_bfe_u32 v23, v15, 7, 1
MC a[184:187],a[20:23],v[220:223]
s_mov_b32 s40, 262656
TR a[42:43],v9,59400
v_cndmask_b32 v22, 2.0, v22, vcc
MC a[184:187],a[24:27],v[232:235]
TR a[44:45],v9,63368
AW a74,v34
MC a[184:187],a[28:31],v[244:247]
LG 7
TR a[46:47],v9,63624
AW a75,v35
MC a[184:187],a[32:35],a[48:51]
s_waitcnt vmcnt(15)
s_barrier
AR v24,a176
MC a[188:191],a[4:7],v[176:179]
TR a[0:1],v8,33792
AR v25,a177
MC a[188:191],a[8:11],v[188:191]
TR a[2:3],v8,34048
AR v26,a178
MC a[188:191],a[12:15],v[200:203]
TR a[4:5],v8,38016
AR v27,a179
MC a[188:191],a[16:19],v[212:215]
TR a[6:7],v8,38272
v_mul_f32 v24, s42, v24
MC a[188:191],a[20:23],v[224:227]
TR a[8:9],v8,42240
v_mul_f32 v25, s42, v25
MC a[188:191],a[24:27],v[236:239]
TR a[10:11],v8,42496
v_mul_f32 v26, s42, v26
MC a[188:191],a[28:31],v[248:251]
LG 6
TR a[12:13],v8,46464
v_mul_f32 v27, s42, v27
MC a[188:191],a[32:35],a[52:55]
TR a[14:15],v8,46720
CV v24,v24,v25
MC a[192:195],a[36:39],v[172:175]
TR a[16:17],v8,50688
CV v26,v26,v27
MC a[192:195],v[36:39],v[184:187]
TR a[18:19],v8,50944
AW a106,v24
MC a[192:195],v[40:43],v[196:199]
TR a[20:21],v8,54912
AW a107,v26
MC a[192:195],v[44:47],v[208:211]
TR a[22:23],v8,55168
AR v28,a180
MC a[192:195],v[48:51],v[220:223]
TR a[24:25],v8,59136
v_subrev_u32 v9, 67584, v9
MC a[192:195],v[52:55],v[232:235]
TR a[26:27],v8,59392
AR v29,a181
MC a[192:195],a[40:43],v[244:247]
LG 7
TR a[28:29],v8,63360
AR v30,a182
MC a[192:195],a[44:47],a[48:51]
TR a[30:31],v8,63616
AR v31,a183
MC a[196:199],a[36:39],v[176:179]
TR a[32:33],v8,33800
v_mul_f32 v28, s42, v28
MC a[196:199],v[36:39],v[188:191]
TR a[34:35],v8,34056
v_mul_f32 v29, s42, v29
MC a[196:199],v[40:43],v[200:203]
TR a[36:37],v8,38024
v_mul_f32 v30, s42, v30
MC a[196:199],v[44:47],v[212:215]
TR a[38:39],v8,38280
buffer_load_dwordx4 v13, s[20:23], s41 offen offset:0 lds
MC a[196:199],v[48:51],v[224:227]
s_add_u32 m0, s35, 105600
TR v[36:37],v8,42248
v_mul_f32 v31, s42, v31
MC a[196:199],v[52:55],v[236:239]
LG 7
TR v[38:39],v8,42504
CV v28,v28,v29
MC a[196:199],a[40:43],v[248:251]
s_mov_b32 s41, 524800
TR v[40:41],v8,46472
CV v30,v30,v31
MC a[196:199],a[44:47],a[52:55]
TR v[42:43],v8,46728
AW a138,v28
MC a[200:203],a[0:3],v[168:171]
TR v[44:45],v8,50696
AW a139,v30
MC a[200:203],a[4:7],v[180:183]
TR v[46:47],v8,50952
AR v24,a184
MC a[200:203],a[8:11],v[192:195]
TR v[48:49],v8,54920
AR v25,a185
MC a[200:203],a[12:15],v[204:207]
TR v[50:51],v8,55176
AR v26,a186
MC a[200:203],a[16:19],v[216:219]
LG 7
TR v[52:53],v8,59144
AR v27,a187
MC a[200:203],a[20:23],v[228:231]
TR v[54:55],v8,59400
v_mul_f32 v24, s42, v24
MC a[200:203],a[24:27],v[240:243]
TR a[40:41],v8,63368
buffer_load_dwordx4 v13, s[20:23], s40 offen offset:0 lds
MC a[200:203],a[28:31],v[252:255]
s_add_u32 m0, s35, 109824
TR a[42:43],v8,63624
v_mul_f32 v25, s42, v25
MC a[204:207],a[0:3],v[172:175]
s_mov_b32 s40, 786944
TR a[44:45],v9,33792
v_mul_f32 v26, s42, v26
MC a[204:207],a[4:7],v[184:187]
TR a[46:47],v9,34048
v_mul_f32 v27, s42, v27
MC a[204:207],a[8:11],v[196:199]
CV v24,v24,v25
CV v26,v26,v27
MC a[204:207],a[12:15],v[208:211]
AW a108,v24
AW a109,v26
MC a[204:207],a[16:19],v[220:223]
AR v28,a188
AR v29,a189
MC a[204:207],a[20:23],v[232:235]
AR v30,a190
AR v31,a191
MC a[204:207],a[24:27],v[244:247]
v_mul_f32 v28, s42, v28
v_mul_f32 v29, s42, v29
MC a[204:207],a[28:31],a[48:51]
v_mul_f32 v30, s42, v30
v_mul_f32 v31, s42, v31
MC a[208:211],a[0:3],v[176:179]
TR a[0:1],v9,38016
CV v28,v28,v29
MC a[208:211],a[4:7],v[188:191]
LG 1
TR a[2:3],v9,38272
buffer_load_dwordx4 v13, s[20:23], s41 offen offset:0 lds
MC a[208:211],a[8:11],v[200:203]
s_add_u32 m0, s35, 114048
TR a[4:5],v9,42240
CV v30,v30,v31
MC a[208:211],a[12:15],v[212:215]
s_mov_b32 s41, 1049088
TR a[6:7],v9,42496
AW a140,v28
MC a[208:211],a[16:19],v[224:227]
TR a[8:9],v9,46464
AW a141,v30
MC a[208:211],a[20:23],v[236:239]
TR a[10:11],v9,46720
AR v24,a192
MC a[208:211],a[24:27],v[248:251]
TR a[12:13],v9,50688
AR v25,a193
MC a[208:211],a[28:31],a[52:55]
TR a[14:15],v9,50944
AR v26,a194
MC a[212:215],a[32:35],v[168:171]
TR a[16:17],v9,54912
AR v27,a195
MC a[212:215],a[36:39],v[180:183]
TR a[18:19],v9,55168
v_mul_f32 v24, s42, v24
MC a[212:215],v[36:39],v[192:195]
TR a[20:21],v9,59136
buffer_load_dword a60, v22, s[16:19], s52 offen
MC a[212:215],v[40:43],v[204:207]
s_mul_i32 s52, s62, 28672
TR a[22:23],v9,59392
v_mul_f32 v25, s42, v25
MC a[212:215],v[44:47],v[216:219]
s_add_u32 s52, s52, 0
TR a[24:25],v9,63360
v_mul_f32 v26, s42, v26
MC a[212:215],v[48:51],v[228:231]
TR a[26:27],v9,63616
v_mul_f32 v27, s42, v27
MC a[212:215],v[52:55],v[240:243]
buffer_load_dwordx4 v13, s[20:23], s40 offen offset:0 lds
v_lshrrev_b32 v22, 8, v15
MC a[212:215],a[40:43],v[252:255]
LG 6
TR a[28:29],v9,33800
CV v24,v24,v25
v_cmp_gt_u32 vcc, 32, v22
MC a[216:219],a[32:35],v[172:175]
s_add_u32 m0, s35, 118272
TR a[30:31],v9,34056
CV v26,v26,v27
v_mul_u32_u24 v22, 896, v22
MC a[216:219],a[36:39],v[184:187]
s_mov_b32 s40, 1311232
AW a110,v24
AW a111,v26
v_lshl_add_u32 v22, v23, 7, v22
MC a[216:219],v[36:39],v[196:199]
AR v28,a196
v_add_u32 v8, 67584, v8
v_cndmask_b32 v22, 2.0, v22, vcc
MC a[216:219],v[40:43],v[208:211]
buffer_load_dword a60, v22, s[24:27], s52 offen
MC a[216:219],v[44:47],v[220:223]
s_lshl_b32 s52, s32, 13
AR v29,a197
AR v30,a198
v_bfe_u32 v22, v12, 4, 6
MC a[216:219],v[48:51],v[232:235]
s_add_u32 s52, s52, 4096
AR v31,a199
v_mul_f32 v28, s42, v28
v_lshlrev_b32 v22, 2, v22
MC a[216:219],v[52:55],v[244:247]
v_mul_f32 v29, s42, v29
v_mul_f32 v30, s42, v30
MC a[216:219],a[40:43],a[48:51]
buffer_store_dword v21, v22, s[28:31], s51 offen sc1
MC a[220:223],a[32:35],v[176:179]
s_lshl_b32 s51, s38, 7
TR a[32:33],v9,38024
v_mul_f32 v31, s42, v31
MC a[220:223],a[36:39],v[188:191]
TR a[34:35],v9,38280
CV v28,v28,v29
MC a[220:223],v[36:39],v[200:203]
TR a[36:37],v9,42248
CV v30,v30,v31
MC a[220:223],v[40:43],v[212:215]
buffer_load_dwordx4 v13, s[20:23], s41 offen offset:0 lds
MC a[220:223],v[44:47],v[224:227]
s_add_u32 m0, s35, 122496
TR a[38:39],v9,42504
AW a142,v28
MC a[220:223],v[48:51],v[236:239]
s_mov_b32 s41, 1573376
TR v[36:37],v9,46472
AW a143,v30
MC a[220:223],v[52:55],v[248:251]
TR v[38:39],v9,46728
AR v24,a200
MC a[220:223],a[40:43],a[52:55]
LG 6
TR v[40:41],v9,50696
AR v25,a201
MC a[224:227],a[44:47],v[172:175]
TR v[42:43],v9,50952
AR v26,a202
MC a[224:227],a[0:3],v[184:187]
TR v[44:45],v9,54920
AR v27,a203
MC a[224:227],a[4:7],v[196:199]
TR v[46:47],v9,55176
buffer_load_dwordx4 v13, s[20:23], s40 offen offset:0 lds
MC a[224:227],a[8:11],v[208:211]
s_add_u32 m0, s35, 33792
TR v[48:49],v9,59144
v_mul_f32 v24, s42, v24
MC a[224:227],a[12:15],v[220:223]
s_mov_b32 s40, 1835520
TR v[50:51],v9,59400
v_mul_f32 v25, s42, v25
MC a[224:227],a[16:19],v[232:235]
TR v[52:53],v9,63368
v_mul_f32 v26, s42, v26
MC a[224:227],a[20:23],v[244:247]
TR v[54:55],v9,63624
v_mul_f32 v27, s42, v27
MC a[224:227],a[24:27],a[48:51]
s_waitcnt vmcnt(18)
s_barrier
CV v32,v24,v25
MC a[228:231],a[44:47],v[176:179]
LG 6
TR a[40:41],v8,0
CV v33,v26,v27
AR v28,a204
MC a[228:231],a[0:3],v[188:191]
TR a[42:43],v8,256
AR v29,a205
AR v30,a206
MC a[228:231],a[4:7],v[200:203]
TR a[44:45],v8,4224
AR v31,a207
MC a[228:231],a[8:11],v[212:215]
TR a[46:47],v8,4480
v_mul_f32 v28, s42, v28
MC a[228:231],a[12:15],v[224:227]
TR a[0:1],v8,8448
v_mul_f32 v29, s42, v29
MC a[228:231],a[16:19],v[236:239]
TR a[2:3],v8,8704
v_mul_f32 v30, s42, v30
MC a[228:231],a[20:23],v[248:251]
TR a[4:5],v8,12672
v_mul_f32 v31, s42, v31
MC a[228:231],a[24:27],a[52:55]
TR a[6:7],v8,12928
CV v28,v28,v29
MC a[232:235],a[28:31],v[172:175]
LG 7
TR a[8:9],v8,16896
CV v30,v30,v31
MC a[232:235],a[32:35],v[184:187]
TR a[10:11],v8,17152
AW a112,v28
MC a[232:235],a[36:39],v[196:199]
TR a[12:13],v8,21120
AW a113,v30
MC a[232:235],v[36:39],v[208:211]
TR a[14:15],v8,21376
AR v28,a212
MC a[232:235],v[40:43],v[220:223]
TR a[16:17],v8,8
AR v29,a213
MC a[232:235],v[44:47],v[232:235]
TR a[18:19],v8,264
AR v30,a214
MC a[232:235],v[48:51],v[244:247]
TR a[20:21],v8,4232
AR v31,a215
MC a[232:235],v[52:55],a[48:51]
LG 7
TR a[22:23],v8,4488
v_mul_f32 v28, s42, v28
MC a[236:239],a[28:31],v[176:179]
TR a[24:25],v8,8456
buffer_load_dwordx4 v13, s[20:23], s41 offen offset:0 lds
v_mul_f32 v29, s42, v29
MC a[236:239],a[32:35],v[188:191]
s_add_u32 m0, s35, 38016
TR a[26:27],v8,8712
v_mul_f32 v30, s42, v30
MC a[236:239],a[36:39],v[200:203]
s_mov_b32 s41, 2097664
TR a[28:29],v8,12680
v_mul_f32 v31, s42, v31
MC a[236:239],v[36:39],v[212:215]
TR a[30:31],v8,12936
CV v34,v28,v29
MC a[236:239],v[40:43],v[224:227]
TR a[32:33],v8,16904
CV v35,v30,v31
MC a[236:239],v[44:47],v[236:239]
ds_write_b128 v16, v[32:35] offset:4096
MC a[236:239],v[48:51],v[248:251]
buffer_load_dwordx4 v13, s[20:23], s40 offen offset:0 lds
MC a[236:239],v[52:55],a[52:55]
LG 6
TR a[34:35],v8,17160
v_mul_f32 v82, s42, v82
M v[56:59],a[40:43],v[96:99],0
s_add_u32 m0, s35, 42240
TR a[36:37],v8,21128
v_mul_f32 v83, s42, v83
MC v[56:59],a[44:47],v[108:111]
s_mov_b32 s40, 2359808
TR a[38:39],v8,21384
CV v80,v80,v81
MC v[56:59],a[0:3],v[120:123]
buffer_load_dwordx4 v13, s[20:23], s41 offen offset:0 lds
MC v[56:59],a[4:7],v[132:135]
s_add_u32 m0, s35, 46464
AW a100,v80
CV v81,v82,v83
MC v[56:59],a[8:11],v[144:147]
s_mov_b32 s41, 2621952
AW a101,v81
v_add_u32 v9, 67584, v9
MC v[56:59],a[12:15],v[156:159]
TR v[36:37],v9,0
v_mul_f32 v84, s42, v84
M v[60:63],a[40:43],v[100:103],0
TR v[38:39],v9,256
v_mul_f32 v85, s42, v85
MC v[60:63],a[44:47],v[112:115]
TR v[40:41],v9,4224
v_mul_f32 v86, s42, v86
MC v[60:63],a[0:3],v[124:127]
TR v[42:43],v9,4480
v_mul_f32 v87, s42, v87
MC v[60:63],a[4:7],v[136:139]
TR v[44:45],v9,8448
CV v84,v84,v85
MC v[60:63],a[8:11],v[148:151]
buffer_load_dwordx4 v13, s[20:23], s40 offen offset:0 lds
MC v[60:63],a[12:15],v[160:163]
LG 5
TR v[46:47],v9,8704
AW a132,v84
M v[64:67],a[40:43],v[104:107],0
s_add_u32 m0, s35, 50688
TR v[48:49],v9,12672
CV v85,v86,v87
MC v[64:67],a[44:47],v[116:119]
s_mov_b32 s40, 2884096
TR v[50:51],v9,12928
AW a133,v85
MC v[64:67],a[0:3],v[128:131]
TR v[52:53],v9,16896
v_mul_f32 v88, s42, v88
MC v[64:67],a[4:7],v[140:143]
TR v[54:55],v9,17152
v_mul_f32 v89, s42, v89
MC v[64:67],a[8:11],v[152:155]
TR a[40:41],v9,21120
v_mul_f32 v90, s42, v90
MC v[64:67],a[12:15],v[164:167]
TR a[42:43],v9,21376
v_mul_f32 v91, s42, v91
M v[68:71],a[16:19],v[96:99],0
buffer_load_dwordx4 v13, s[20:23], s41 offen offset:0 lds
MC v[68:71],a[20:23],v[108:111]
s_add_u32 m0, s35, 54912
TR a[44:45],v9,8
CV v82,v88,v89
MC v[68:71],a[24:27],v[120:123]
s_mov_b32 s41, 3146240
TR a[46:47],v9,264
CV v83,v90,v91
MC v[68:71],a[28:31],v[132:135]
LG 6
TR a[0:1],v9,4232
AW a102,v82
MC v[68:71],a[32:35],v[144:147]
TR a[2:3],v9,4488
AW a103,v83
MC v[68:71],a[36:39],v[156:159]
TR a[4:5],v9,8456
v_mul_f32 v92, s42, v92
M v[72:75],a[16:19],v[100:103],0
TR a[6:7],v9,8712
v_mul_f32 v93, s42, v93
MC v[72:75],a[20:23],v[112:115]
TR a[8:9],v9,12680
v_mul_f32 v94, s42, v94
MC v[72:75],a[24:27],v[124:127]
buffer_load_dwordx4 v13, s[20:23], s40 offen offset:0 lds
MC v[72:75],a[28:31],v[136:139]
s_add_u32 m0, s35, 59136
TR a[10:11],v9,12936
v_mul_f32 v95, s42, v95
MC v[72:75],a[32:35],v[148:151]
s_mov_b32 s40, 3408384
TR a[12:13],v9,16904
CV v86,v92,v93
MC v[72:75],a[36:39],v[160:163]
TR a[14:15],v9,17160
CV v87,v94,v95
M v[76:79],a[16:19],v[104:107],0
LG 6
TR a[16:17],v9,21128
AW a134,v86
MC v[76:79],a[20:23],v[116:119]
TR a[18:19],v9,21384
AW a135,v87
MC v[76:79],a[24:27],v[128:131]
v_subrev_u32 v8, 67584, v8
AR v24,a208
MC v[76:79],a[28:31],v[140:143]
buffer_load_dwordx4 v13, s[20:23], s41 offen offset:0 lds
MC v[76:79],a[32:35],v[152:155]
s_waitcnt vmcnt(16)
s_barrier
AR v25,a209
MC v[76:79],a[36:39],v[164:167]
s_add_u32 m0, s35, 63360
TR a[20:21],v8,0
AR v26,a210
M v[80:83],v[36:39],v[100:103],0
s_mov_b32 s41, 640
TR a[22:23],v8,256
AR v27,a211
MC v[80:83],v[40:43],v[112:115]
TR a[24:25],v8,4224
v_mul_f32 v24, s42, v24
MC v[80:83],v[44:47],v[124:127]
TR a[26:27],v8,4480
v_mul_f32 v25, s42, v25
MC v[80:83],v[48:51],v[136:139]
TR a[28:29],v8,8448
v_mul_f32 v26, s42, v26
MC v[80:83],v[52:55],v[148:151]
Y_pg3:
s_cbranch_execz Y_pg7
TR a[30:31],v8,8704
v_mul_f32 v27, s42, v27
MC v[80:83],a[40:43],v[160:163]
LG 6
TR a[32:33],v8,12672
CV v24,v24,v25
M v[84:87],v[36:39],v[104:107],0
TR a[34:35],v8,12928
CV v26,v26,v27
MC v[84:87],v[40:43],v[116:119]
TR a[36:37],v8,16896
AW a144,v24
MC v[84:87],v[44:47],v[128:131]
buffer_load_dwordx4 v13, s[20:23], s40 offen offset:0 lds
MC v[84:87],v[48:51],v[140:143]
s_add_u32 m0, s35, 67584
TR a[38:39],v8,17152
AW a145,v26
MC v[84:87],v[52:55],v[152:155]
s_mov_b32 s40, 262784
TR v[36:37],v8,21120
v_bfe_u32 v22, v12, 4, 6
MC v[84:87],a[40:43],v[164:167]
TR v[38:39],v8,21376
v_lshrrev_b32 v23, 3, v22
M v[88:91],a[44:47],v[100:103],0
TR v[40:41],v8,25344
v_and_b32 v22, 7, v22
MC v[88:91],a[0:3],v[112:115]
buffer_load_dwordx4 v13, s[20:23], s41 offen offset:0 lds
MC v[88:91],a[4:7],v[124:127]
s_add_u32 m0, s35, 71808
TR v[42:43],v8,25600
v_cmp_gt_u32 vcc, 4, v23
MC v[88:91],a[8:11],v[136:139]
LG 5
TR v[44:45],v8,29568
v_lshlrev_b32 v22, 7, v22
MC v[88:91],a[12:15],v[148:151]
s_mov_b32 s41, 524928
TR v[46:47],v8,29824
v_add_u32 v21, 0, v23
MC v[88:91],a[16:19],v[160:163]
TR v[48:49],v8,8
v_and_b32 v21, 3, v21
M v[92:95],a[44:47],v[104:107],0
TR v[50:51],v8,264
v_mul_u32_u24 v23, 32768, v23
MC v[92:95],a[0:3],v[116:119]
TR v[52:53],v8,4232
v_lshl_add_u32 v22, v21, 10, v22
MC v[92:95],a[4:7],v[128:131]
TR v[54:55],v8,4488
v_add_u32 v22, v22, v23
MC v[92:95],a[8:11],v[140:143]
TR a[40:41],v8,8456
v_add_u32 v22, 163840, v22
MC v[92:95],a[12:15],v[152:155]
buffer_load_dwordx4 v13, s[20:23], s40 offen offset:0 lds
MC v[92:95],a[16:19],v[164:167]
s_add_u32 m0, s35, 76032
TR a[42:43],v8,8712
v_bfe_u32 v23, v15, 7, 1
MC v[56:59],a[20:23],v[168:171]
s_mov_b32 s40, 787072
TR a[44:45],v8,12680
v_xor_b32 v22, s63, v22
MC v[56:59],a[24:27],v[180:183]
LG 6
TR a[46:47],v8,12936
v_xor_b32 v22, 131072, v22
MC v[56:59],a[28:31],v[192:195]
TR a[0:1],v8,16904
v_cndmask_b32 v22, 2.0, v22, vcc
MC v[56:59],a[32:35],v[204:207]
TR a[2:3],v8,17160
AR v24,a216
MC v[56:59],a[36:39],v[216:219]
TR a[4:5],v8,21128
AR v25,a217
MC v[56:59],v[36:39],v[228:231]
TR a[6:7],v8,21384
AR v26,a218
MC v[56:59],v[40:43],v[240:243]
TR a[8:9],v8,25352
AR v27,a219
MC v[56:59],v[44:47],v[252:255]
TR a[10:11],v8,25608
v_mul_f32 v24, s42, v24
MC v[60:63],a[20:23],v[172:175]
TR a[12:13],v8,29576
v_mul_f32 v25, s42, v25
MC v[60:63],a[24:27],v[184:187]
buffer_load_dwordx4 v13, s[20:23], s41 offen offset:0 lds
MC v[60:63],a[28:31],v[196:199]
LG 6
TR a[14:15],v8,29832
v_mul_f32 v26, s42, v26
MC v[60:63],a[32:35],v[208:211]
s_add_u32 m0, s35, 80256
RD a[68:71],v17,2048
v_subrev_u32 v9, 67584, v9
MC v[60:63],a[36:39],v[220:223]
s_mov_b32 s41, 1049216
TR a[16:17],v9,0
v_add_u32 v8, 67584, v8
MC v[60:63],v[36:39],v[232:235]
TR a[18:19],v9,256
v_mul_f32 v56, s42, v56
MC v[60:63],v[40:43],v[244:247]
v_mul_f32 v57, s42, v57
v_mul_f32 v58, s42, v58
MC v[60:63],v[44:47],a[48:51]
v_mul_f32 v59, s42, v59
CV v56,v56,v57
MC v[64:67],a[20:23],v[176:179]
TR a[20:21],v9,4224
AW a88,v56
MC v[64:67],a[24:27],v[188:191]
TR a[22:23],v9,4480
CV v57,v58,v59
MC v[64:67],a[28:31],v[200:203]
TR a[24:25],v9,8448
AW a89,v57
MC v[64:67],a[32:35],v[212:215]
buffer_load_dwordx4 v13, s[20:23], s40 offen offset:0 lds
MC v[64:67],a[36:39],v[224:227]
s_add_u32 m0, s35, 84480
TR a[26:27],v9,8704
v_mul_f32 v60, s42, v60
MC v[64:67],v[36:39],v[236:239]
LG 4
TR a[28:29],v9,12672
v_mul_f32 v61, s42, v61
MC v[64:67],v[40:43],v[248:251]
s_mov_b32 s40, 1311360
TR a[30:31],v9,12928
v_mul_f32 v62, s42, v62
MC v[64:67],v[44:47],a[52:55]
TR a[32:33],v9,16896
v_mul_f32 v63, s42, v63
MC v[68:71],v[48:51],v[168:171]
TR a[34:35],v9,17152
CV v60,v60,v61
MC v[68:71],v[52:55],v[180:183]
TR a[36:37],v9,21120
AW a120,v60
MC v[68:71],a[40:43],v[192:195]
buffer_load_dword a60, v22, s[12:15], s52 offen
MC v[68:71],a[44:47],v[204:207]
s_mul_i32 s52, s62, 229376
TR a[38:39],v9,21376
v_lshrrev_b32 v22, 8, v15
MC v[68:71],a[0:3],v[216:219]
s_add_u32 s52, s52, 768
TR v[36:37],v9,25344
v_cmp_gt_u32 vcc, 28, v22
MC v[68:71],a[4:7],v[228:231]
TR v[38:39],v9,25600
v_mul_u32_u24 v22, 8192, v22
MC v[68:71],a[8:11],v[240:243]
TR v[40:41],v9,29568
v_lshl_add_u32 v22, v23, 7, v22
MC v[68:71],a[12:15],v[252:255]
TR v[42:43],v9,29824
v_cndmask_b32 v22, 2.0, v22, vcc
MC v[72:75],v[48:51],v[172:175]
buffer_load_dword a60, v22, s[20:23], s52 offen
MC v[72:75],v[52:55],v[184:187]
LG 5
TR v[44:45],v9,8
v_bfe_u32 v23, v15, 7, 1
MC v[72:75],a[40:43],v[196:199]
s_mul_i32 s52, s62, 28672
TR v[46:47],v9,264
v_lshrrev_b32 v22, 8, v15
MC v[72:75],a[44:47],v[208:211]
s_add_u32 s52, s52, 256
v_cmp_gt_u32 vcc, 32, v22
v_mul_f32 v68, s42, v68
MC v[72:75],a[0:3],v[220:223]
v_mul_u32_u24 v22, 896, v22
v_mul_f32 v69, s42, v69
MC v[72:75],a[4:7],v[232:235]
v_lshl_add_u32 v22, v23, 7, v22
v_mul_f32 v70, s42, v70
MC v[72:75],a[8:11],v[244:247]
v_cndmask_b32 v22, 2.0, v22, vcc
v_mul_f32 v71, s42, v71
MC v[72:75],a[12:15],a[48:51]
buffer_load_dword a60, v22, s[24:27], s52 offen
MC v[76:79],v[48:51],v[176:179]
s_lshl_b32 s52, s32, 13
TR v[48:49],v9,4232
CV v58,v68,v69
MC v[76:79],v[52:55],v[188:191]
s_add_u32 s52, s52, 0
TR v[50:51],v9,4488
CV v59,v70,v71
MC v[76:79],a[40:43],v[200:203]
ds_write_b128 v16, v[56:59] offset:5120
MC v[76:79],a[44:47],v[212:215]
buffer_load_dwordx4 v13, s[20:23], s41 offen offset:0 lds
MC v[76:79],a[0:3],v[224:227]
s_add_u32 m0, s35, 88704
TR v[52:53],v9,8456
CV v61,v62,v63
MC v[76:79],a[4:7],v[236:239]
s_mov_b32 s41, 1573504
TR v[54:55],v9,8712
AW a121,v61
MC v[76:79],a[8:11],v[248:251]
TR a[40:41],v9,12680
v_mul_f32 v64, s42, v64
MC v[76:79],a[12:15],a[52:55]
buffer_load_dwordx4 v13, s[20:23], s40 offen offset:0 lds
MC v[80:83],a[16:19],v[172:175]
s_add_u32 m0, s35, 0
TR a[42:43],v9,12936
v_mul_f32 v65, s42, v65
MC v[80:83],a[20:23],v[184:187]
LG 5
TR a[44:45],v9,16904
v_mul_f32 v66, s42, v66
MC v[80:83],a[24:27],v[196:199]
s_mov_b32 s40, 1835648
TR a[46:47],v9,17160
v_mul_f32 v67, s42, v67
MC v[80:83],a[28:31],v[208:211]
TR a[0:1],v9,21128
CV v64,v64,v65
MC v[80:83],a[32:35],v[220:223]
TR a[2:3],v9,21384
AW a152,v64
MC v[80:83],a[36:39],v[232:235]
TR a[4:5],v9,25352
CV v65,v66,v67
MC v[80:83],v[36:39],v[244:247]
TR a[6:7],v9,25608
AW a153,v65
MC v[80:83],v[40:43],a[48:51]
TR a[8:9],v9,29576
AW a90,v58
MC v[84:87],a[16:19],v[176:179]
TR a[10:11],v9,29832
AW a91,v59
MC v[84:87],a[20:23],v[188:191]
s_waitcnt vmcnt(17)
s_barrier
v_mul_f32 v72, s42, v72
MC v[84:87],a[24:27],v[200:203]
TR a[12:13],v8,33792
v_mul_f32 v73, s42, v73
MC v[84:87],a[28:31],v[212:215]
LG 6
TR a[14:15],v8,34048
v_mul_f32 v74, s42, v74
MC v[84:87],a[32:35],v[224:227]
TR a[16:17],v8,38016
v_mul_f32 v75, s42, v75
MC v[84:87],a[36:39],v[236:239]
TR a[18:19],v8,38272
CV v62,v72,v73
MC v[84:87],v[36:39],v[248:251]
TR a[20:21],v8,42240
CV v63,v74,v75
MC v[84:87],v[40:43],a[52:55]
TR a[22:23],v8,42496
AW a122,v62
MC v[88:91],v[44:47],v[172:175]
TR a[24:25],v8,46464
AW a123,v63
MC v[88:91],v[48:51],v[184:187]
TR a[26:27],v8,46720
v_add_u32 v9, 67584, v9
MC v[88:91],v[52:55],v[196:199]
buffer_load_dwordx4 v13, s[20:23], s41 offen offset:0 lds
MC v[88:91],a[40:43],v[208:211]
s_add_u32 m0, s35, 4224
TR a[28:29],v8,50688
v_mul_f32 v76, s42, v76
MC v[88:91],a[44:47],v[220:223]
LG 6
TR a[30:31],v8,50944
v_mul_f32 v77, s42, v77
MC v[88:91],a[0:3],v[232:235]
s_mov_b32 s41, 2097792
TR a[32:33],v8,54912
v_mul_f32 v78, s42, v78
MC v[88:91],a[4:7],v[244:247]
TR a[34:35],v8,55168
v_mul_f32 v79, s42, v79
MC v[88:91],a[8:11],a[48:51]
RD a[76:79],v17,3072
CV v66,v76,v77
MC v[92:95],v[44:47],v[176:179]
TR a[36:37],v8,33800
CV v67,v78,v79
MC v[92:95],v[48:51],v[188:191]
TR a[38:39],v8,34056
AW a154,v66
MC v[92:95],v[52:55],v[200:203]
buffer_load_dwordx4 v13, s[20:23], s40 offen offset:0 lds
MC v[92:95],a[40:43],v[212:215]
s_add_u32 m0, s35, 8448
TR v[36:37],v8,38024
AW a155,v67
MC v[92:95],a[44:47],v[224:227]
s_mov_b32 s40, 2359936
TR v[38:39],v8,38280
v_mul_f32 v80, s42, v80
MC v[92:95],a[0:3],v[236:239]
LG 6
TR v[40:41],v8,42248
v_mul_f32 v81, s42, v81
MC v[92:95],a[4:7],v[248:251]
TR v[42:43],v8,42504
v_mul_f32 v82, s42, v82
MC v[92:95],a[8:11],a[52:55]
TR v[44:45],v8,46472
v_mul_f32 v83, s42, v83
M v[56:59],a[12:15],v[96:99],0
TR v[46:47],v8,46728
CV v80,v80,v81
MC v[56:59],a[16:19],v[108:111]
TR v[48:49],v8,50696
AW a124,v80
MC v[56:59],a[20:23],v[120:123]
buffer_load_dwordx4 v13, s[20:23], s41 offen offset:0 lds
MC v[56:59],a[24:27],v[132:135]
s_add_u32 m0, s35, 12672
TR v[50:51],v8,50952
CV v81,v82,v83
MC v[56:59],a[28:31],v[144:147]
LG 6
TR v[52:53],v8,54920
AW a125,v81
MC v[56:59],a[32:35],v[156:159]
s_mov_b32 s41, 2622080
TR v[54:55],v8,55176
v_mul_f32 v84, s42, v84
M v[60:63],a[12:15],v[100:103],0
TR a[40:41],v9,33792
v_mul_f32 v85, s42, v85
MC v[60:63],a[16:19],v[112:115]
TR a[42:43],v9,34048
v_mul_f32 v86, s42, v86
MC v[60:63],a[20:23],v[124:127]
TR a[44:45],v9,38016
v_mul_f32 v87, s42, v87
MC v[60:63],a[24:27],v[136:139]
TR a[46:47],v9,38272
CV v84,v84,v85
MC v[60:63],a[28:31],v[148:151]
TR a[0:1],v9,42240
AW a156,v84
MC v[60:63],a[32:35],v[160:163]
buffer_load_dwordx4 v13, s[20:23], s40 offen offset:0 lds
M v[64:67],a[12:15],v[104:107],0
s_add_u32 m0, s35, 16896
TR a[2:3],v9,42496
CV v85,v86,v87
MC v[64:67],a[16:19],v[116:119]
LG 6
TR a[4:5],v9,46464
AW a157,v85
MC v[64:67],a[20:23],v[128:131]
s_mov_b32 s40, 2884224
TR a[6:7],v9,46720
v_mul_f32 v88, s42, v88
MC v[64:67],a[24:27],v[140:143]
TR a[8:9],v9,50688
v_mul_f32 v89, s42, v89
MC v[64:67],a[28:31],v[152:155]
TR a[10:11],v9,50944
v_mul_f32 v90, s42, v90
MC v[64:67],a[32:35],v[164:167]
TR a[12:13],v9,54912
v_mul_f32 v91, s42, v91
M v[68:71],a[36:39],v[96:99],0
TR a[14:15],v9,55168
v_subrev_u32 v8, 67584, v8
MC v[68:71],v[36:39],v[108:111]
buffer_load_dwordx4 v13, s[20:23], s41 offen offset:0 lds
MC v[68:71],v[40:43],v[120:123]
s_add_u32 m0, s35, 21120
TR a[16:17],v9,33800
CV v82,v88,v89
MC v[68:71],v[44:47],v[132:135]
s_mov_b32 s41, 3146368
TR a[18:19],v9,34056
CV v83,v90,v91
MC v[68:71],v[48:51],v[144:147]
LG 6
TR a[20:21],v9,38024
AW a126,v82
MC v[68:71],v[52:55],v[156:159]
TR a[22:23],v9,38280
AW a127,v83
M v[72:75],a[36:39],v[100:103],0
TR a[24:25],v9,42248
v_mul_f32 v92, s42, v92
MC v[72:75],v[36:39],v[112:115]
TR a[26:27],v9,42504
v_mul_f32 v93, s42, v93
MC v[72:75],v[40:43],v[124:127]
TR a[28:29],v9,46472
v_mul_f32 v94, s42, v94
MC v[72:75],v[44:47],v[136:139]
buffer_load_dwordx4 v13, s[20:23], s40 offen offset:0 lds
MC v[72:75],v[48:51],v[148:151]
s_add_u32 m0, s35, 25344
TR a[30:31],v9,46728
v_mul_f32 v95, s42, v95
MC v[72:75],v[52:55],v[160:163]
s_mov_b32 s40, 3408512
TR a[32:33],v9,50696
CV v86,v92,v93
M v[76:79],a[36:39],v[104:107],0
TR a[34:35],v9,50952
CV v87,v94,v95
MC v[76:79],v[36:39],v[116:119]
LG 6
TR a[36:37],v9,54920
AW a158,v86
MC v[76:79],v[40:43],v[128:131]
TR a[38:39],v9,55176
AW a159,v87
MC v[76:79],v[44:47],v[140:143]
buffer_load_dwordx4 v13, s[20:23], s41 offen offset:0 lds
MC v[76:79],v[48:51],v[152:155]
s_waitcnt vmcnt(16)
s_barrier
v_mul_f32 v27, s42, v27
MC v[76:79],v[52:55],v[164:167]
s_add_u32 m0, s35, 29568
TR v[36:37],v8,33792
CV v24,v24,v25
M v[80:83],a[40:43],v[100:103],0
s_mov_b32 s41, 768
TR v[38:39],v8,34048
CV v26,v26,v27
MC v[80:83],a[44:47],v[112:115]
TR v[40:41],v8,38016
AW a114,v24
MC v[80:83],a[0:3],v[124:127]
TR v[42:43],v8,38272
AW a115,v26
MC v[80:83],a[4:7],v[136:139]
TR v[44:45],v8,42240
AR v28,a220
MC v[80:83],a[8:11],v[148:151]
TR v[46:47],v8,42496
AR v29,a221
MC v[80:83],a[12:15],v[160:163]
LG 6
TR v[48:49],v8,46464
AR v30,a222
M v[84:87],a[40:43],v[104:107],0
TR v[50:51],v8,46720
AR v31,a223
MC v[84:87],a[44:47],v[116:119]
TR v[52:53],v8,50688
v_mul_f32 v28, s42, v28
MC v[84:87],a[0:3],v[128:131]
buffer_load_dwordx4 v13, s[20:23], s40 offen offset:0 lds
MC v[84:87],a[4:7],v[140:143]
s_add_u32 m0, s35, 101376
TR v[54:55],v8,50944
v_mul_f32 v29, s42, v29
MC v[84:87],a[8:11],v[152:155]
s_mov_b32 s40, 262912
TR a[40:41],v8,54912
v_mul_f32 v30, s42, v30
MC v[84:87],a[12:15],v[164:167]
TR a[42:43],v8,55168
v_mul_f32 v31, s42, v31
M v[88:91],a[16:19],v[100:103],0
TR a[44:45],v8,59136
CV v28,v28,v29
MC v[88:91],a[20:23],v[112:115]
buffer_load_dwordx4 v13, s[20:23], s41 offen offset:0 lds
MC v[88:91],a[24:27],v[124:127]
s_add_u32 m0, s35, 105600
TR a[46:47],v8,59392
CV v30,v30,v31
MC v[88:91],a[28:31],v[136:139]
LG 5
TR a[0:1],v8,63360
AW a146,v28
MC v[88:91],a[32:35],v[148:151]
s_mov_b32 s41, 525056
TR a[2:3],v8,63616
AW a147,v30
MC v[88:91],a[36:39],v[160:163]
TR a[4:5],v8,33800
AR v24,a224
M v[92:95],a[16:19],v[104:107],0
TR a[6:7],v8,34056
AR v25,a225
MC v[92:95],a[20:23],v[116:119]
TR a[8:9],v8,38024
AR v26,a226
MC v[92:95],a[24:27],v[128:131]
TR a[10:11],v8,38280
AR v27,a227
MC v[92:95],a[28:31],v[140:143]
TR a[12:13],v8,42248
AR v28,a228
MC v[92:95],a[32:35],v[152:155]
TR a[14:15],v8,42504
AR v29,a229
MC v[92:95],a[36:39],v[164:167]
TR a[16:17],v8,46472
AR v30,a230
MC v[56:59],v[36:39],v[168:171]
LG 7
TR a[18:19],v8,46728
AR v31,a231
MC v[56:59],v[40:43],v[180:183]
TR a[20:21],v8,50696
v_bfe_u32 v22, v12, 4, 6
MC v[56:59],v[44:47],v[192:195]
TR a[22:23],v8,50952
v_lshrrev_b32 v23, 3, v22
MC v[56:59],v[48:51],v[204:207]
buffer_load_dwordx4 v13, s[20:23], s40 offen offset:0 lds
MC v[56:59],v[52:55],v[216:219]
s_add_u32 m0, s35, 109824
TR a[24:25],v8,54920
v_and_b32 v22, 7, v22
MC v[56:59],a[40:43],v[228:231]
s_mov_b32 s40, 787200
TR a[26:27],v8,55176
v_cmp_gt_u32 vcc, 5, v23
MC v[56:59],a[44:47],v[240:243]
TR a[28:29],v8,59144
v_add_u32 v21, 0, v23
MC v[56:59],a[0:3],v[252:255]
TR a[30:31],v8,59400
v_lshlrev_b32 v22, 7, v22
MC v[60:63],v[36:39],v[172:175]
LG 6
TR a[32:33],v8,63368
v_and_b32 v21, 3, v21
MC v[60:63],v[40:43],v[184:187]
TR a[34:35],v8,63624
v_mul_u32_u24 v23, 32768, v23
MC v[60:63],v[44:47],v[196:199]
RD a[84:87],v17,4096
v_lshl_add_u32 v22, v21, 10, v22
MC v[60:63],v[48:51],v[208:211]
v_add_u32 v22, v22, v23
v_mov_b32 v21, 1
MC v[60:63],v[52:55],v[220:223]
v_add_u32 v22, 131072, v22
v_bfe_u32 v23, v15, 7, 1
MC v[60:63],a[40:43],v[232:235]
buffer_load_dwordx4 v13, s[20:23], s41 offen offset:0 lds
MC v[60:63],a[44:47],v[244:247]
s_add_u32 m0, s35, 114048
v_xor_b32 v22, s63, v22
v_subrev_u32 v9, 67584, v9
MC v[60:63],a[0:3],a[48:51]
Y_pg4:
s_cbranch_execz Y_pg8
s_mov_b32 s41, 1049344
TR a[36:37],v9,33792
v_cndmask_b32 v22, 2.0, v22, vcc
MC v[64:67],v[36:39],v[176:179]
TR a[38:39],v9,34048
v_mul_f32 v56, s42, v56
MC v[64:67],v[40:43],v[188:191]
TR v[36:37],v9,38016
v_add_u32 v8, 67584, v8
MC v[64:67],v[44:47],v[200:203]
TR v[38:39],v9,38272
v_mul_f32 v57, s42, v57
MC v[64:67],v[48:51],v[212:215]
TR v[40:41],v9,42240
v_mul_f32 v58, s42, v58
MC v[64:67],v[52:55],v[224:227]
LG 5
TR v[42:43],v9,42496
v_mul_f32 v59, s42, v59
MC v[64:67],a[40:43],v[236:239]
TR v[44:45],v9,46464
CV v56,v56,v57
MC v[64:67],a[44:47],v[248:251]
TR v[46:47],v9,46720
AW a160,v56
MC v[64:67],a[0:3],a[52:55]
buffer_load_dwordx4 v13, s[20:23], s40 offen offset:0 lds
MC v[68:71],a[4:7],v[168:171]
s_add_u32 m0, s35, 118272
TR v[48:49],v9,50688
CV v57,v58,v59
MC v[68:71],a[8:11],v[180:183]
s_mov_b32 s40, 1311488
TR v[50:51],v9,50944
AW a161,v57
MC v[68:71],a[12:15],v[192:195]
TR v[52:53],v9,54912
v_mul_f32 v60, s42, v60
MC v[68:71],a[16:19],v[204:207]
buffer_load_dword a60, v22, s[16:19], s52 offen
MC v[68:71],a[20:23],v[216:219]
s_mul_i32 s52, s62, 28672
TR v[54:55],v9,55168
v_lshrrev_b32 v22, 8, v15
MC v[68:71],a[24:27],v[228:231]
s_add_u32 s52, s52, 512
TR a[40:41],v9,59136
v_cmp_gt_u32 vcc, 32, v22
MC v[68:71],a[28:31],v[240:243]
TR a[42:43],v9,59392
v_mul_u32_u24 v22, 896, v22
MC v[68:71],a[32:35],v[252:255]
LG 6
TR a[44:45],v9,63360
v_lshl_add_u32 v22, v23, 7, v22
MC v[72:75],a[4:7],v[172:175]
TR a[46:47],v9,63616
v_cndmask_b32 v22, 2.0, v22, vcc
MC v[72:75],a[8:11],v[184:187]
TR a[0:1],v9,33800
v_mul_f32 v61, s42, v61
MC v[72:75],a[12:15],v[196:199]
buffer_load_dword a60, v22, s[24:27], s52 offen
MC v[72:75],a[16:19],v[208:211]
s_lshl_b32 s52, s32, 13
TR a[2:3],v9,34056
v_mul_f32 v62, s42, v62
MC v[72:75],a[20:23],v[220:223]
s_add_u32 s52, s52, 0
v_mul_f32 v68, s42, v68
v_mul_f32 v69, s42, v69
MC v[72:75],a[24:27],v[232:235]
v_mul_f32 v70, s42, v70
v_mul_f32 v71, s42, v71
MC v[72:75],a[28:31],v[244:247]
buffer_load_dwordx4 v13, s[20:23], s41 offen offset:0 lds
MC v[72:75],a[32:35],a[48:51]
s_add_u32 m0, s35, 122496
CV v58,v68,v69
CV v59,v70,v71
MC v[76:79],a[4:7],v[176:179]
s_mov_b32 s41, 1573632
ds_write_b128 v16, v[56:59] offset:2048
MC v[76:79],a[8:11],v[188:191]
TR a[4:5],v9,38024
v_mul_f32 v63, s42, v63
MC v[76:79],a[12:15],v[200:203]
TR a[6:7],v9,38280
CV v60,v60,v61
MC v[76:79],a[16:19],v[212:215]
buffer_load_dwordx4 v13, s[20:23], s40 offen offset:0 lds
MC v[76:79],a[20:23],v[224:227]
s_add_u32 m0, s35, 33792
TR a[8:9],v9,42248
AW a192,v60
MC v[76:79],a[24:27],v[236:239]
LG 4
TR a[10:11],v9,42504
CV v61,v62,v63
MC v[76:79],a[28:31],v[248:251]
s_mov_b32 s40, 1835776
TR a[12:13],v9,46472
AW a193,v61
MC v[76:79],a[32:35],a[52:55]
TR a[14:15],v9,46728
v_mul_f32 v64, s42, v64
MC v[80:83],a[36:39],v[172:175]
TR a[16:17],v9,50696
v_mul_f32 v65, s42, v65
MC v[80:83],v[36:39],v[184:187]
TR a[18:19],v9,50952
v_mul_f32 v66, s42, v66
MC v[80:83],v[40:43],v[196:199]
TR a[20:21],v9,54920
v_mul_f32 v67, s42, v67
MC v[80:83],v[44:47],v[208:211]
TR a[22:23],v9,55176
CV v64,v64,v65
MC v[80:83],v[48:51],v[220:223]
TR a[24:25],v9,59144
AW a224,v64
MC v[80:83],v[52:55],v[232:235]
TR a[26:27],v9,59400
CV v65,v66,v67
MC v[80:83],a[40:43],v[244:247]
TR a[28:29],v9,63368
AW a225,v65
MC v[80:83],a[44:47],a[48:51]
LG 7
TR a[30:31],v9,63624
AW a162,v58
MC v[84:87],a[36:39],v[176:179]
s_waitcnt vmcnt(16)
s_barrier
AW a163,v59
MC v[84:87],v[36:39],v[188:191]
TR a[32:33],v8,0
v_mul_f32 v72, s42, v72
MC v[84:87],v[40:43],v[200:203]
TR a[34:35],v8,256
v_mul_f32 v73, s42, v73
MC v[84:87],v[44:47],v[212:215]
TR a[36:37],v8,4224
v_mul_f32 v74, s42, v74
MC v[84:87],v[48:51],v[224:227]
TR a[38:39],v8,4480
v_mul_f32 v75, s42, v75
MC v[84:87],v[52:55],v[236:239]
TR v[36:37],v8,8448
CV v62,v72,v73
MC v[84:87],a[40:43],v[248:251]
TR v[38:39],v8,8704
CV v63,v74,v75
MC v[84:87],a[44:47],a[52:55]
LG 6
TR v[40:41],v8,12672
AW a194,v62
MC v[88:91],a[0:3],v[172:175]
TR v[42:43],v8,12928
AW a195,v63
MC v[88:91],a[4:7],v[184:187]
buffer_load_dwordx4 v13, s[20:23], s41 offen offset:0 lds
MC v[88:91],a[8:11],v[196:199]
s_add_u32 m0, s35, 38016
TR v[44:45],v8,16896
v_add_u32 v9, 67584, v9
MC v[88:91],a[12:15],v[208:211]
s_mov_b32 s41, 2097920
TR v[46:47],v8,17152
v_mul_f32 v76, s42, v76
MC v[88:91],a[16:19],v[220:223]
TR v[48:49],v8,21120
v_mul_f32 v77, s42, v77
MC v[88:91],a[20:23],v[232:235]
TR v[50:51],v8,21376
v_mul_f32 v78, s42, v78
MC v[88:91],a[24:27],v[244:247]
TR v[52:53],v8,8
v_mul_f32 v79, s42, v79
MC v[88:91],a[28:31],a[48:51]
TR v[54:55],v8,264
CV v66,v76,v77
MC v[92:95],a[0:3],v[176:179]
LG 6
TR a[40:41],v8,4232
CV v67,v78,v79
MC v[92:95],a[4:7],v[188:191]
buffer_load_dwordx4 v13, s[20:23], s40 offen offset:0 lds
MC v[92:95],a[8:11],v[200:203]
s_add_u32 m0, s35, 42240
TR a[42:43],v8,4488
AW a226,v66
MC v[92:95],a[12:15],v[212:215]
s_mov_b32 s40, 2360064
TR a[44:45],v8,8456
AW a227,v67
MC v[92:95],a[16:19],v[224:227]
TR a[46:47],v8,8712
v_mul_f32 v80, s42, v80
MC v[92:95],a[20:23],v[236:239]
TR a[0:1],v8,12680
v_mul_f32 v81, s42, v81
MC v[92:95],a[24:27],v[248:251]
TR a[2:3],v8,12936
v_mul_f32 v82, s42, v82
MC v[92:95],a[28:31],a[52:55]
TR a[4:5],v8,16904
v_mul_f32 v83, s42, v83
M v[56:59],a[32:35],v[96:99],0
TR a[6:7],v8,17160
CV v80,v80,v81
MC v[56:59],a[36:39],v[108:111]
buffer_load_dwordx4 v13, s[20:23], s41 offen offset:0 lds
MC v[56:59],v[36:39],v[120:123]
LG 6
TR a[8:9],v8,21128
AW a196,v80
MC v[56:59],v[40:43],v[132:135]
s_add_u32 m0, s35, 46464
TR a[10:11],v8,21384
CV v81,v82,v83
MC v[56:59],v[44:47],v[144:147]
s_mov_b32 s41, 2622208
TR a[12:13],v9,0
AW a197,v81
MC v[56:59],v[48:51],v[156:159]
TR a[14:15],v9,256
v_mul_f32 v84, s42, v84
M v[60:63],a[32:35],v[100:103],0
TR a[16:17],v9,4224
v_mul_f32 v85, s42, v85
MC v[60:63],a[36:39],v[112:115]
TR a[18:19],v9,4480
v_mul_f32 v86, s42, v86
MC v[60:63],v[36:39],v[124:127]
TR a[20:21],v9,8448
v_mul_f32 v87, s42, v87
MC v[60:63],v[40:43],v[136:139]
TR a[22:23],v9,8704
CV v84,v84,v85
MC v[60:63],v[44:47],v[148:151]
buffer_load_dwordx4 v13, s[20:23], s40 offen offset:0 lds
MC v[60:63],v[48:51],v[160:163]
LG 6
TR a[24:25],v9,12672
AW a228,v84
M v[64:67],a[32:35],v[104:107],0
s_add_u32 m0, s35, 50688
TR a[26:27],v9,12928
CV v85,v86,v87
MC v[64:67],a[36:39],v[116:119]
s_mov_b32 s40, 2884352
TR a[28:29],v9,16896
AW a229,v85
MC v[64:67],v[36:39],v[128:131]
TR a[30:31],v9,17152
v_mul_f32 v88, s42, v88
MC v[64:67],v[40:43],v[140:143]
TR a[32:33],v9,21120
v_mul_f32 v89, s42, v89
MC v[64:67],v[44:47],v[152:155]
TR a[34:35],v9,21376
v_mul_f32 v90, s42, v90
MC v[64:67],v[48:51],v[164:167]
TR a[36:37],v9,8
v_mul_f32 v91, s42, v91
M v[68:71],v[52:55],v[96:99],0
buffer_load_dwordx4 v13, s[20:23], s41 offen offset:0 lds
MC v[68:71],a[40:43],v[108:111]
s_add_u32 m0, s35, 54912
TR a[38:39],v9,264
v_subrev_u32 v8, 67584, v8
MC v[68:71],a[44:47],v[120:123]
LG 6
TR v[36:37],v9,4232
CV v82,v88,v89
MC v[68:71],a[0:3],v[132:135]
s_mov_b32 s41, 3146496
TR v[38:39],v9,4488
CV v83,v90,v91
MC v[68:71],a[4:7],v[144:147]
TR v[40:41],v9,8456
AW a198,v82
MC v[68:71],a[8:11],v[156:159]
TR v[42:43],v9,8712
AW a199,v83
M v[72:75],v[52:55],v[100:103],0
TR v[44:45],v9,12680
v_mul_f32 v92, s42, v92
MC v[72:75],a[40:43],v[112:115]
buffer_load_dwordx4 v13, s[20:23], s40 offen offset:0 lds
MC v[72:75],a[44:47],v[124:127]
s_add_u32 m0, s35, 59136
TR v[46:47],v9,12936
v_mul_f32 v93, s42, v93
MC v[72:75],a[0:3],v[136:139]
s_mov_b32 s40, 3408640
TR v[48:49],v9,16904
v_mul_f32 v94, s42, v94
MC v[72:75],a[4:7],v[148:151]
TR v[50:51],v9,17160
v_mul_f32 v95, s42, v95
MC v[72:75],a[8:11],v[160:163]
CV v86,v92,v93
CV v87,v94,v95
M v[76:79],v[52:55],v[104:107],0
LG 5
TR v[52:53],v9,21128
AW a230,v86
MC v[76:79],a[40:43],v[116:119]
TR v[54:55],v9,21384
AW a231,v87
MC v[76:79],a[44:47],v[128:131]
buffer_load_dwordx4 v13, s[20:23], s41 offen offset:0 lds
MC v[76:79],a[0:3],v[140:143]
s_add_u32 m0, s35, 63360
v_mul_f32 v24, s42, v24
v_mul_f32 v25, s42, v25
MC v[76:79],a[4:7],v[152:155]
s_waitcnt vmcnt(15)
s_barrier
v_mul_f32 v26, s42, v26
MC v[76:79],a[8:11],v[164:167]
s_mov_b32 s41, 896
TR a[40:41],v8,0
v_mul_f32 v27, s42, v27
M v[80:83],a[12:15],v[100:103],0
buffer_store_dword v21, v15, s[96:99], s51 offen sc1
MC v[80:83],a[16:19],v[112:115]
s_mov_b32 s51, 0
TR a[42:43],v8,256
CV v24,v24,v25
MC v[80:83],a[20:23],v[124:127]
TR a[44:45],v8,4224
CV v26,v26,v27
MC v[80:83],a[24:27],v[136:139]
TR a[46:47],v8,4480
AW a116,v24
MC v[80:83],a[28:31],v[148:151]
TR a[0:1],v8,8448
AW a117,v26
MC v[80:83],a[32:35],v[160:163]
TR a[2:3],v8,8704
v_mul_f32 v28, s42, v28
M v[84:87],a[12:15],v[104:107],0
TR a[4:5],v8,12672
v_mul_f32 v29, s42, v29
MC v[84:87],a[16:19],v[116:119]
LG 6
TR a[6:7],v8,12928
v_mul_f32 v30, s42, v30
MC v[84:87],a[20:23],v[128:131]
TR a[8:9],v8,16896
v_mul_f32 v31, s42, v31
MC v[84:87],a[24:27],v[140:143]
buffer_load_dwordx4 v13, s[20:23], s40 offen offset:0 lds
MC v[84:87],a[28:31],v[152:155]
s_add_u32 m0, s35, 67584
TR a[10:11],v8,17152
CV v28,v28,v29
MC v[84:87],a[32:35],v[164:167]
s_mov_b32 s40, 263040
TR a[12:13],v8,21120
CV v30,v30,v31
M v[88:91],a[36:39],v[100:103],0
TR a[14:15],v8,21376
AW a148,v28
MC v[88:91],v[36:39],v[112:115]
TR a[16:17],v8,25344
AW a149,v30
MC v[88:91],v[40:43],v[124:127]
buffer_load_dwordx4 v13, s[20:23], s41 offen offset:0 lds
MC v[88:91],v[44:47],v[136:139]
s_add_u32 m0, s35, 71808
TR a[18:19],v8,25600
AR v24,a232
MC v[88:91],v[48:51],v[148:151]
s_mov_b32 s41, 525184
TR a[20:21],v8,29568
AR v25,a233
MC v[88:91],v[52:55],v[160:163]
LG 6
TR a[22:23],v8,29824
AR v26,a234
M v[92:95],a[36:39],v[104:107],0
TR a[24:25],v8,8
AR v27,a235
MC v[92:95],v[36:39],v[116:119]
TR a[26:27],v8,264
AR v28,a236
MC v[92:95],v[40:43],v[128:131]
TR a[28:29],v8,4232
AR v29,a237
MC v[92:95],v[44:47],v[140:143]
TR a[30:31],v8,4488
AR v30,a238
MC v[92:95],v[48:51],v[152:155]
TR a[32:33],v8,8456
AR v31,a239
MC v[92:95],v[52:55],v[164:167]
TR a[34:35],v8,8712
v_bfe_u32 v22, v12, 4, 6
MC v[56:59],a[40:43],v[168:171]
buffer_load_dwordx4 v13, s[20:23], s40 offen offset:0 lds
MC v[56:59],a[44:47],v[180:183]
s_add_u32 m0, s35, 76032
TR a[36:37],v8,12680
v_lshrrev_b32 v23, 3, v22
MC v[56:59],a[0:3],v[192:195]
LG 6
TR a[38:39],v8,12936
v_and_b32 v22, 7, v22
MC v[56:59],a[4:7],v[204:207]
s_mov_b32 s40, 787328
TR v[36:37],v8,16904
v_cmp_gt_u32 vcc, 4, v23
MC v[56:59],a[8:11],v[216:219]
TR v[38:39],v8,17160
v_lshlrev_b32 v22, 7, v22
MC v[56:59],a[12:15],v[228:231]
TR v[40:41],v8,21128
v_subrev_u32 v9, 67584, v9
MC v[56:59],a[16:19],v[240:243]
TR v[42:43],v8,21384
v_add_u32 v21, 0, v23
MC v[56:59],a[20:23],v[252:255]
TR v[44:45],v8,25352
v_and_b32 v21, 3, v21
MC v[60:63],a[40:43],v[172:175]
TR v[46:47],v8,25608
v_mul_u32_u24 v23, 32768, v23
MC v[60:63],a[44:47],v[184:187]
TR v[48:49],v8,29576
v_lshl_add_u32 v22, v21, 10, v22
MC v[60:63],a[0:3],v[196:199]
LG 7
TR v[50:51],v8,29832
v_add_u32 v22, v22, v23
MC v[60:63],a[4:7],v[208:211]
buffer_load_dwordx4 v13, s[20:23], s41 offen offset:0 lds
MC v[60:63],a[8:11],v[220:223]
s_add_u32 m0, s35, 80256
RD a[92:95],v17,5120
v_add_u32 v22, 360448, v22
MC v[60:63],a[12:15],v[232:235]
s_mov_b32 s41, 1049472
TR v[52:53],v9,0
v_xor_b32 v22, s63, v22
MC v[60:63],a[16:19],v[244:247]
TR v[54:55],v9,256
v_cndmask_b32 v22, 2.0, v22, vcc
MC v[60:63],a[20:23],a[48:51]
v_mul_f32 v56, s42, v56
v_add_u32 v8, 67584, v8
MC v[64:67],a[40:43],v[176:179]
TR a[40:41],v9,4224
v_mul_f32 v57, s42, v57
MC v[64:67],a[44:47],v[188:191]
TR a[42:43],v9,4480
v_mul_f32 v58, s42, v58
MC v[64:67],a[0:3],v[200:203]
TR a[44:45],v9,8448
v_mul_f32 v59, s42, v59
MC v[64:67],a[4:7],v[212:215]
LG 6
TR a[46:47],v9,8704
CV v56,v56,v57
MC v[64:67],a[8:11],v[224:227]
buffer_load_dwordx4 v13, s[20:23], s40 offen offset:0 lds
MC v[64:67],a[12:15],v[236:239]
s_add_u32 m0, s35, 84480
TR a[0:1],v9,12672
AW a168,v56
MC v[64:67],a[16:19],v[248:251]
s_mov_b32 s40, 1311616
TR a[2:3],v9,12928
CV v57,v58,v59
MC v[64:67],a[20:23],a[52:55]
TR a[4:5],v9,16896
AW a169,v57
MC v[68:71],a[24:27],v[168:171]
TR a[6:7],v9,17152
v_mul_f32 v60, s42, v60
MC v[68:71],a[28:31],v[180:183]
TR a[8:9],v9,21120
v_mul_f32 v61, s42, v61
MC v[68:71],a[32:35],v[192:195]
buffer_load_dword a60, v22, s[12:15], s52 offen
MC v[68:71],a[36:39],v[204:207]
s_lshl_b32 s52, s32, 13
TR a[10:11],v9,21376
v_bfe_u32 v22, v12, 4, 6
MC v[68:71],v[36:39],v[216:219]
s_add_u32 s52, s52, 4096
TR a[12:13],v9,25344
v_lshrrev_b32 v23, 3, v22
MC v[68:71],v[40:43],v[228:231]
LG 6
TR a[14:15],v9,25600
v_and_b32 v22, 7, v22
v_cmp_gt_u32 vcc, 3, v23
MC v[68:71],v[44:47],v[240:243]
TR a[16:17],v9,29568
v_add_u32 v21, 0, v23
v_lshlrev_b32 v22, 7, v22
MC v[68:71],v[48:51],v[252:255]
TR a[18:19],v9,29824
v_and_b32 v21, 3, v21
v_mul_u32_u24 v23, 32768, v23
MC v[72:75],a[24:27],v[172:175]
TR a[20:21],v9,8
v_lshl_add_u32 v22, v21, 10, v22
MC v[72:75],a[28:31],v[184:187]
TR a[22:23],v9,264
v_add_u32 v22, v22, v23
MC v[72:75],a[32:35],v[196:199]
v_add_u32 v22, 360448, v22
v_bfe_u32 v23, v15, 7, 0
MC v[72:75],a[36:39],v[208:211]
v_xor_b32 v22, s63, v22
v_mul_f32 v68, s42, v68
MC v[72:75],v[36:39],v[220:223]
v_xor_b32 v22, 131072, v22
v_mul_f32 v69, s42, v69
MC v[72:75],v[40:43],v[232:235]
v_cndmask_b32 v22, 2.0, v22, vcc
v_mul_f32 v70, s42, v70
MC v[72:75],v[44:47],v[244:247]
buffer_load_dword a60, v22, s[16:19], s52 offen
MC v[72:75],v[48:51],a[48:51]
s_mul_i32 s52, s62, 28672
v_lshrrev_b32 v22, 7, v15
v_mul_f32 v71, s42, v71
s_add_u32 s52, s52, 768
MC v[76:79],a[24:27],v[176:179]
TR a[24:25],v9,4232
v_cmp_gt_u32 vcc, 32, v22
MC v[76:79],a[28:31],v[188:191]
TR a[26:27],v9,4488
v_mul_u32_u24 v22, 896, v22
MC v[76:79],a[32:35],v[200:203]
buffer_load_dwordx4 v13, s[20:23], s41 offen offset:0 lds
v_lshl_add_u32 v22, v23, 7, v22
MC v[76:79],a[36:39],v[212:215]
s_add_u32 m0, s35, 88704
TR a[28:29],v9,8456
v_cndmask_b32 v22, 2.0, v22, vcc
MC v[76:79],v[36:39],v[224:227]
LG 3
TR a[30:31],v9,8712
CV v58,v68,v69
MC v[76:79],v[40:43],v[236:239]
s_mov_b32 s41, 1573760
TR a[32:33],v9,12680
CV v59,v70,v71
MC v[76:79],v[44:47],v[248:251]
buffer_load_dword a60, v22, s[24:27], s52 offen
MC v[76:79],v[48:51],a[52:55]
ds_write_b128 v16, v[56:59] offset:3072
MC v[80:83],v[52:55],v[172:175]
TR a[34:35],v9,12936
v_mul_f32 v62, s42, v62
MC v[80:83],a[40:43],v[184:187]
Y_pg5:
s_cbranch_execz Y_wr0
TR a[36:37],v9,16904
v_mul_f32 v63, s42, v63
MC v[80:83],a[44:47],v[196:199]
buffer_load_dwordx4 v13, s[20:23], s40 offen offset:0 lds
MC v[80:83],a[0:3],v[208:211]
s_add_u32 m0, s35, 0
TR a[38:39],v9,17160
CV v60,v60,v61
MC v[80:83],a[4:7],v[220:223]
s_mov_b32 s40, 1835904
TR v[36:37],v9,21128
AW a200,v60
MC v[80:83],a[8:11],v[232:235]
TR v[38:39],v9,21384
CV v61,v62,v63
MC v[80:83],a[12:15],v[244:247]
TR v[40:41],v9,25352
AW a201,v61
MC v[80:83],a[16:19],a[48:51]
TR v[42:43],v9,25608
v_mul_f32 v64, s42, v64
MC v[84:87],v[52:55],v[176:179]
TR v[44:45],v9,29576
v_mul_f32 v65, s42, v65
MC v[84:87],a[40:43],v[188:191]
LG 6
TR v[46:47],v9,29832
v_mul_f32 v66, s42, v66
MC v[84:87],a[44:47],v[200:203]
s_waitcnt vmcnt(18)
s_barrier
v_mul_f32 v67, s42, v67
MC v[84:87],a[0:3],v[212:215]
TR v[48:49],v8,33792
CV v64,v64,v65
MC v[84:87],a[4:7],v[224:227]
TR v[50:51],v8,34048
AW a232,v64
MC v[84:87],a[8:11],v[236:239]
TR v[52:53],v8,38016
CV v65,v66,v67
MC v[84:87],a[12:15],v[248:251]
TR v[54:55],v8,38272
AW a233,v65
MC v[84:87],a[16:19],a[52:55]
TR a[40:41],v8,42240
AW a170,v58
MC v[88:91],a[20:23],v[172:175]
TR a[42:43],v8,42496
AW a171,v59
MC v[88:91],a[24:27],v[184:187]
TR a[44:45],v8,46464
v_mul_f32 v72, s42, v72
MC v[88:91],a[28:31],v[196:199]
LG 7
TR a[46:47],v8,46720
v_mul_f32 v73, s42, v73
MC v[88:91],a[32:35],v[208:211]
TR a[0:1],v8,50688
v_mul_f32 v74, s42, v74
MC v[88:91],a[36:39],v[220:223]
TR a[2:3],v8,50944
v_mul_f32 v75, s42, v75
MC v[88:91],v[36:39],v[232:235]
TR a[4:5],v8,54912
CV v62,v72,v73
MC v[88:91],v[40:43],v[244:247]
TR a[6:7],v8,55168
CV v63,v74,v75
MC v[88:91],v[44:47],a[48:51]
TR a[8:9],v8,33800
AW a202,v62
MC v[92:95],a[20:23],v[176:179]
buffer_load_dwordx4 v13, s[20:23], s41 offen offset:0 lds
MC v[92:95],a[24:27],v[188:191]
s_add_u32 m0, s35, 4224
TR a[10:11],v8,34056
AW a203,v63
MC v[92:95],a[28:31],v[200:203]
LG 6
TR a[12:13],v8,38024
v_add_u32 v9, 67584, v9
MC v[92:95],a[32:35],v[212:215]
s_mov_b32 s41, 2098048
TR a[14:15],v8,38280
v_mul_f32 v76, s42, v76
MC v[92:95],a[36:39],v[224:227]
TR a[16:17],v8,42248
v_mul_f32 v77, s42, v77
MC v[92:95],v[36:39],v[236:239]
TR a[18:19],v8,42504
v_mul_f32 v78, s42, v78
MC v[92:95],v[40:43],v[248:251]
TR a[20:21],v8,46472
v_mul_f32 v79, s42, v79
MC v[92:95],v[44:47],a[52:55]
TR a[22:23],v8,46728
CV v66,v76,v77
M v[56:59],v[48:51],v[96:99],0
buffer_load_dwordx4 v13, s[20:23], s40 offen offset:0 lds
MC v[56:59],v[52:55],v[108:111]
s_add_u32 m0, s35, 8448
TR a[24:25],v8,50696
CV v67,v78,v79
MC v[56:59],a[40:43],v[120:123]
s_mov_b32 s40, 2360192
TR a[26:27],v8,50952
AW a234,v66
MC v[56:59],a[44:47],v[132:135]
LG 6
TR a[28:29],v8,54920
AW a235,v67
MC v[56:59],a[0:3],v[144:147]
TR a[30:31],v8,55176
v_mul_f32 v80, s42, v80
MC v[56:59],a[4:7],v[156:159]
TR a[32:33],v9,33792
v_mul_f32 v81, s42, v81
M v[60:63],v[48:51],v[100:103],0
TR a[34:35],v9,34048
v_mul_f32 v82, s42, v82
MC v[60:63],v[52:55],v[112:115]
TR a[36:37],v9,38016
v_mul_f32 v83, s42, v83
MC v[60:63],a[40:43],v[124:127]
buffer_load_dwordx4 v13, s[20:23], s41 offen offset:0 lds
MC v[60:63],a[44:47],v[136:139]
s_add_u32 m0, s35, 12672
TR a[38:39],v9,38272
CV v80,v80,v81
MC v[60:63],a[0:3],v[148:151]
s_mov_b32 s41, 2622336
TR v[36:37],v9,42240
AW a204,v80
MC v[60:63],a[4:7],v[160:163]
TR v[38:39],v9,42496
CV v81,v82,v83
M v[64:67],v[48:51],v[104:107],0
LG 6
TR v[40:41],v9,46464
AW a205,v81
MC v[64:67],v[52:55],v[116:119]
TR v[42:43],v9,46720
v_mul_f32 v84, s42, v84
MC v[64:67],a[40:43],v[128:131]
TR v[44:45],v9,50688
v_mul_f32 v85, s42, v85
MC v[64:67],a[44:47],v[140:143]
TR v[46:47],v9,50944
v_mul_f32 v86, s42, v86
MC v[64:67],a[0:3],v[152:155]
TR v[48:49],v9,54912
v_mul_f32 v87, s42, v87
MC v[64:67],a[4:7],v[164:167]
buffer_load_dwordx4 v13, s[20:23], s40 offen offset:0 lds
M v[68:71],a[8:11],v[96:99],0
s_add_u32 m0, s35, 16896
TR v[50:51],v9,55168
CV v84,v84,v85
MC v[68:71],a[12:15],v[108:111]
s_mov_b32 s40, 2884480
TR v[52:53],v9,33800
AW a236,v84
MC v[68:71],a[16:19],v[120:123]
TR v[54:55],v9,34056
CV v85,v86,v87
MC v[68:71],a[20:23],v[132:135]
LG 6
TR a[40:41],v9,38024
AW a237,v85
MC v[68:71],a[24:27],v[144:147]
TR a[42:43],v9,38280
v_mul_f32 v88, s42, v88
MC v[68:71],a[28:31],v[156:159]
TR a[44:45],v9,42248
v_mul_f32 v89, s42, v89
M v[72:75],a[8:11],v[100:103],0
TR a[46:47],v9,42504
v_mul_f32 v90, s42, v90
MC v[72:75],a[12:15],v[112:115]
buffer_load_dwordx4 v13, s[20:23], s41 offen offset:0 lds
MC v[72:75],a[16:19],v[124:127]
s_add_u32 m0, s35, 21120
TR a[0:1],v9,46472
v_mul_f32 v91, s42, v91
MC v[72:75],a[20:23],v[136:139]
s_mov_b32 s41, 3146624
TR a[2:3],v9,46728
v_subrev_u32 v8, 67584, v8
MC v[72:75],a[24:27],v[148:151]
TR a[4:5],v9,50696
CV v82,v88,v89
MC v[72:75],a[28:31],v[160:163]
TR a[6:7],v9,50952
CV v83,v90,v91
M v[76:79],a[8:11],v[104:107],0
LG 6
TR a[8:9],v9,54920
AW a206,v82
MC v[76:79],a[12:15],v[116:119]
TR a[10:11],v9,55176
AW a207,v83
MC v[76:79],a[16:19],v[128:131]
v_mul_f32 v92, s42, v92
v_mul_f32 v93, s42, v93
MC v[76:79],a[20:23],v[140:143]
buffer_load_dwordx4 v13, s[20:23], s40 offen offset:0 lds
MC v[76:79],a[24:27],v[152:155]
s_waitcnt vmcnt(15)
s_barrier
v_mul_f32 v94, s42, v94
MC v[76:79],a[28:31],v[164:167]
s_add_u32 m0, s35, 25344
TR a[12:13],v8,33792
v_mul_f32 v95, s42, v95
M v[80:83],a[32:35],v[100:103],0
s_mov_b32 s40, 3408768
TR a[14:15],v8,34048
CV v86,v92,v93
MC v[80:83],a[36:39],v[112:115]
TR a[16:17],v8,38016
CV v87,v94,v95
MC v[80:83],v[36:39],v[124:127]
TR a[18:19],v8,38272
AW a238,v86
MC v[80:83],v[40:43],v[136:139]
buffer_load_dwordx4 v13, s[20:23], s41 offen offset:0 lds
MC v[80:83],v[44:47],v[148:151]
s_add_u32 m0, s35, 29568
TR a[20:21],v8,42240
AW a239,v87
MC v[80:83],v[48:51],v[160:163]
s_xor_b32 s41, s63, 0
TR a[22:23],v8,42496
v_subrev_u32 v9, 67584, v9
M v[84:87],a[32:35],v[104:107],0
LG 6
TR a[24:25],v8,46464
v_add_u32 v0, 67584, v0
MC v[84:87],a[36:39],v[116:119]
buffer_load_dwordx4 v13, s[20:23], s40 offen offset:0 lds
MC v[84:87],v[36:39],v[128:131]
s_add_u32 m0, s34, 101376
TR a[26:27],v8,46720
v_add_u32 v1, 67584, v1
MC v[84:87],v[40:43],v[140:143]
s_xor_b32 s40, s63, 135168
TR a[28:29],v8,50688
v_add_u32 v2, 67584, v2
MC v[84:87],v[44:47],v[152:155]
TR a[30:31],v8,50944
v_add_u32 v3, 67584, v3
MC v[84:87],v[48:51],v[164:167]
buffer_load_dwordx4 v12, s[12:15], s41 offen offset:0 nt lds
M v[88:91],v[52:55],v[100:103],0
s_add_u32 m0, s34, 101408
TR a[32:33],v8,54912
AW a80,v32
MC v[88:91],a[40:43],v[112:115]
TR a[34:35],v8,55168
AW a81,v33
MC v[88:91],a[44:47],v[124:127]
TR a[36:37],v8,59136
AW a82,v34
MC v[88:91],a[0:3],v[136:139]
TR a[38:39],v8,59392
AW a83,v35
MC v[88:91],a[4:7],v[148:151]
buffer_load_dwordx4 v12, s[12:15], s41 offen offset:1024 nt lds
MC v[88:91],a[8:11],v[160:163]
LG 5
TR v[36:37],v8,63360
v_mov_b32 v32, 0
M v[92:95],v[52:55],v[104:107],0
s_add_u32 m0, s34, 101440
TR v[38:39],v8,63616
v_mov_b32 v33, 0
MC v[92:95],a[40:43],v[116:119]
TR v[40:41],v8,33800
v_mov_b32 v34, 0
MC v[92:95],a[44:47],v[128:131]
TR v[42:43],v8,34056
v_mov_b32 v35, 0
MC v[92:95],a[0:3],v[140:143]
TR v[44:45],v8,38024
v_mul_f32 v24, s42, v24
MC v[92:95],a[4:7],v[152:155]
TR v[46:47],v8,38280
v_mul_f32 v25, s42, v25
MC v[92:95],a[8:11],v[164:167]
TR v[48:49],v8,42248
v_mul_f32 v26, s42, v26
MC v[56:59],a[12:15],v[168:171]
TR v[50:51],v8,42504
v_mul_f32 v27, s42, v27
MC v[56:59],a[16:19],v[180:183]
TR v[52:53],v8,46472
CV v24,v24,v25
MC v[56:59],a[20:23],v[192:195]
LG 7
TR v[54:55],v8,46728
CV v26,v26,v27
MC v[56:59],a[24:27],v[204:207]
buffer_load_dwordx4 v12, s[12:15], s41 offen offset:2048 nt lds
MC v[56:59],a[28:31],v[216:219]
s_add_u32 m0, s34, 101472
TR a[40:41],v8,50696
AW a118,v24
MC v[56:59],a[32:35],v[228:231]
TR a[42:43],v8,50952
AW a119,v26
MC v[56:59],a[36:39],v[240:243]
TR a[44:45],v8,54920
v_mov_b32 v25, 0
MC v[56:59],v[36:39],v[252:255]
TR a[46:47],v8,55176
v_mov_b32 v27, 0
MC v[60:63],a[12:15],v[172:175]
TR a[0:1],v8,59144
v_mov_b32 v24, 0
MC v[60:63],a[16:19],v[184:187]
TR a[2:3],v8,59400
v_mov_b32 v26, 0
MC v[60:63],a[20:23],v[196:199]
LG 6
TR a[4:5],v8,63368
v_mul_f32 v56, s42, v56
MC v[60:63],a[24:27],v[208:211]
TR a[6:7],v8,63624
v_mul_f32 v57, s42, v57
MC v[60:63],a[28:31],v[220:223]
RD a[164:167],v17,2048
v_mul_f32 v58, s42, v58
MC v[60:63],a[32:35],v[232:235]
TR a[8:9],v9,33792
v_mul_f32 v59, s42, v59
MC v[60:63],a[36:39],v[244:247]
buffer_load_dwordx4 v12, s[12:15], s41 offen offset:3072 nt lds
MC v[60:63],v[36:39],a[48:51]
s_add_u32 m0, s34, 105600
TR a[10:11],v9,34048
CV v56,v56,v57
MC v[64:67],a[12:15],v[176:179]
s_xor_b32 s41, s63, 32768
TR a[12:13],v9,38016
CV v57,v58,v59
MC v[64:67],a[16:19],v[188:191]
TR a[14:15],v9,38272
v_add_u32 v8, 67584, v8
MC v[64:67],a[20:23],v[200:203]
TR a[16:17],v9,42240
AW a176,v56
MC v[64:67],a[24:27],v[212:215]
LG 6
TR a[18:19],v9,42496
AW a177,v57
MC v[64:67],a[28:31],v[224:227]
TR a[20:21],v9,46464
v_mul_f32 v60, s42, v60
MC v[64:67],a[32:35],v[236:239]
TR a[22:23],v9,46720
v_mul_f32 v61, s42, v61
MC v[64:67],a[36:39],v[248:251]
TR a[24:25],v9,50688
v_mul_f32 v62, s42, v62
MC v[64:67],v[36:39],a[52:55]
TR a[26:27],v9,50944
v_mul_f32 v63, s42, v63
MC v[68:71],v[40:43],v[168:171]
TR a[28:29],v9,54912
CV v60,v60,v61
MC v[68:71],v[44:47],v[180:183]
buffer_load_dwordx4 v12, s[12:15], s40 offen offset:0 nt lds
MC v[68:71],v[48:51],v[192:195]
s_add_u32 m0, s34, 105632
TR a[30:31],v9,55168
AW a208,v60
MC v[68:71],v[52:55],v[204:207]
TR a[32:33],v9,59136
CV v61,v62,v63
MC v[68:71],a[40:43],v[216:219]
LG 6
TR a[34:35],v9,59392
AW a209,v61
MC v[68:71],a[44:47],v[228:231]
TR a[36:37],v9,63360
v_mul_f32 v64, s42, v64
MC v[68:71],a[0:3],v[240:243]
TR a[38:39],v9,63616
v_mul_f32 v65, s42, v65
MC v[68:71],a[4:7],v[252:255]
TR v[36:37],v9,33800
v_mul_f32 v66, s42, v66
MC v[72:75],v[40:43],v[172:175]
TR v[38:39],v9,34056
v_mul_f32 v67, s42, v67
MC v[72:75],v[44:47],v[184:187]
CV v64,v64,v65
v_mul_f32 v28, s42, v28
MC v[72:75],v[48:51],v[196:199]
v_mul_f32 v68, s42, v68
v_mul_f32 v69, s42, v69
MC v[72:75],v[52:55],v[208:211]
v_mul_f32 v70, s42, v70
v_mul_f32 v71, s42, v71
MC v[72:75],a[40:43],v[220:223]
CV v58,v68,v69
CV v59,v70,v71
MC v[72:75],a[44:47],v[232:235]
s_waitcnt vmcnt(4)
buffer_load_dwordx4 v12, s[12:15], s40 offen offset:1024 nt lds
MC v[72:75],a[0:3],v[244:247]
s_add_u32 m0, s34, 105664
ds_write_b128 v16, v[56:59] offset:4096
MC v[72:75],a[4:7],a[48:51]
AW a240,v64
CV v65,v66,v67
MC v[76:79],v[40:43],v[176:179]
TR v[40:41],v9,38024
AW a241,v65
MC v[76:79],v[44:47],v[188:191]
TR v[42:43],v9,38280
AW a178,v58
MC v[76:79],v[48:51],v[200:203]
LG 3
TR v[44:45],v9,42248
AW a179,v59
MC v[76:79],v[52:55],v[212:215]
TR v[46:47],v9,42504
v_mul_f32 v72, s42, v72
MC v[76:79],a[40:43],v[224:227]
TR v[48:49],v9,46472
v_mul_f32 v73, s42, v73
MC v[76:79],a[44:47],v[236:239]
TR v[50:51],v9,46728
v_mul_f32 v74, s42, v74
MC v[76:79],a[0:3],v[248:251]
TR v[52:53],v9,50696
v_mul_f32 v75, s42, v75
MC v[76:79],a[4:7],a[52:55]
TR v[54:55],v9,50952
CV v62,v72,v73
MC v[80:83],a[8:11],v[172:175]
s_waitcnt vmcnt(4)
buffer_load_dwordx4 v12, s[12:15], s40 offen offset:2048 nt lds
MC v[80:83],a[12:15],v[184:187]
s_add_u32 m0, s34, 105696
TR a[40:41],v9,54920
CV v63,v74,v75
MC v[80:83],a[16:19],v[196:199]
TR a[42:43],v9,55176
AW a210,v62
MC v[80:83],a[20:23],v[208:211]
TR a[44:45],v9,59144
AW a211,v63
MC v[80:83],a[24:27],v[220:223]
TR a[46:47],v9,59400
v_mul_f32 v76, s42, v76
MC v[80:83],a[28:31],v[232:235]
TR a[0:1],v9,63368
v_mul_f32 v77, s42, v77
MC v[80:83],a[32:35],v[244:247]
LG 6
TR a[2:3],v9,63624
v_mul_f32 v78, s42, v78
MC v[80:83],a[36:39],a[48:51]
s_barrier
v_add_u32 v9, 67584, v9
v_mul_f32 v79, s42, v79
MC v[84:87],a[8:11],v[176:179]
TR a[4:5],v8,0
CV v66,v76,v77
MC v[84:87],a[12:15],v[188:191]
TR a[6:7],v8,256
CV v67,v78,v79
MC v[84:87],a[16:19],v[200:203]
TR a[8:9],v8,4224
AW a242,v66
MC v[84:87],a[20:23],v[212:215]
s_waitcnt vmcnt(4)
buffer_load_dwordx4 v12, s[12:15], s40 offen offset:3072 nt lds
MC v[84:87],a[24:27],v[224:227]
s_add_u32 m0, s34, 33792
TR a[10:11],v8,4480
AW a243,v67
MC v[84:87],a[28:31],v[236:239]
s_xor_b32 s40, s63, 167936
TR a[12:13],v8,8448
v_mul_f32 v80, s42, v80
MC v[84:87],a[32:35],v[248:251]
TR a[14:15],v8,8704
v_mul_f32 v81, s42, v81
MC v[84:87],a[36:39],a[52:55]
TR a[16:17],v8,12672
v_mul_f32 v82, s42, v82
MC v[88:91],v[36:39],v[172:175]
LG 6
TR a[18:19],v8,12928
v_mul_f32 v83, s42, v83
MC v[88:91],v[40:43],v[184:187]
TR a[20:21],v8,16896
CV v80,v80,v81
MC v[88:91],v[44:47],v[196:199]
TR a[22:23],v8,17152
AW a212,v80
MC v[88:91],v[48:51],v[208:211]
TR a[24:25],v8,21120
CV v81,v82,v83
MC v[88:91],v[52:55],v[220:223]
TR a[26:27],v8,21376
AW a213,v81
MC v[88:91],a[40:43],v[232:235]
TR a[28:29],v8,8
v_mul_f32 v84, s42, v84
MC v[88:91],a[44:47],v[244:247]
s_waitcnt vmcnt(4)
buffer_load_dwordx4 v12, s[12:15], s41 offen offset:0 nt lds
MC v[88:91],a[0:3],a[48:51]
s_add_u32 m0, s34, 33824
TR a[30:31],v8,264
v_mul_f32 v85, s42, v85
MC v[92:95],v[36:39],v[176:179]
TR a[32:33],v8,4232
v_mul_f32 v86, s42, v86
MC v[92:95],v[40:43],v[188:191]
LG 6
TR a[34:35],v8,4488
v_mul_f32 v87, s42, v87
MC v[92:95],v[44:47],v[200:203]
TR a[36:37],v8,8456
CV v84,v84,v85
MC v[92:95],v[48:51],v[212:215]
TR a[38:39],v8,8712
AW a244,v84
MC v[92:95],v[52:55],v[224:227]
TR v[36:37],v8,12680
CV v85,v86,v87
MC v[92:95],a[40:43],v[236:239]
TR v[38:39],v8,12936
AW a245,v85
MC v[92:95],a[44:47],v[248:251]
TR v[40:41],v8,16904
v_mul_f32 v88, s42, v88
MC v[92:95],a[0:3],a[52:55]
TR v[42:43],v8,17160
v_mul_f32 v89, s42, v89
M v[56:59],a[4:7],v[96:99],0
TR v[44:45],v8,21128
v_mul_f32 v90, s42, v90
MC v[56:59],a[8:11],v[108:111]
LG 7
TR v[46:47],v8,21384
v_mul_f32 v91, s42, v91
MC v[56:59],a[12:15],v[120:123]
s_waitcnt vmcnt(4)
buffer_load_dwordx4 v12, s[12:15], s41 offen offset:1024 nt lds
MC v[56:59],a[16:19],v[132:135]
s_add_u32 m0, s34, 33856
TR v[48:49],v9,0
CV v82,v88,v89
MC v[56:59],a[20:23],v[144:147]
TR v[50:51],v9,256
CV v83,v90,v91
MC v[56:59],a[24:27],v[156:159]
Y_pg6:
s_cbranch_execz Y_wr0
TR v[52:53],v9,4224
AW a214,v82
M v[60:63],a[4:7],v[100:103],0
TR v[54:55],v9,4480
AW a215,v83
MC v[60:63],a[8:11],v[112:115]
TR a[40:41],v9,8448
v_mul_f32 v92, s42, v92
MC v[60:63],a[12:15],v[124:127]
TR a[42:43],v9,8704
v_mul_f32 v93, s42, v93
MC v[60:63],a[16:19],v[136:139]
LG 6
TR a[44:45],v9,12672
v_mul_f32 v94, s42, v94
MC v[60:63],a[20:23],v[148:151]
TR a[46:47],v9,12928
v_mul_f32 v95, s42, v95
MC v[60:63],a[24:27],v[160:163]
TR a[0:1],v9,16896
CV v86,v92,v93
M v[64:67],a[4:7],v[104:107],0
TR a[2:3],v9,17152
CV v87,v94,v95
MC v[64:67],a[8:11],v[116:119]
s_waitcnt vmcnt(4)
buffer_load_dwordx4 v12, s[12:15], s41 offen offset:2048 nt lds
MC v[64:67],a[12:15],v[128:131]
s_add_u32 m0, s34, 33888
TR a[4:5],v9,21120
AW a246,v86
MC v[64:67],a[16:19],v[140:143]
TR a[6:7],v9,21376
AW a247,v87
MC v[64:67],a[20:23],v[152:155]
TR a[8:9],v9,8
v_subrev_u32 v8, 67584, v8
MC v[64:67],a[24:27],v[164:167]
TR a[10:11],v9,264
v_mul_f32 v29, s42, v29
M v[68:71],a[28:31],v[96:99],0
LG 6
TR a[12:13],v9,4232
v_mul_f32 v30, s42, v30
MC v[68:71],a[32:35],v[108:111]
TR a[14:15],v9,4488
v_mul_f32 v31, s42, v31
MC v[68:71],a[36:39],v[120:123]
TR a[16:17],v9,8456
CV v28,v28,v29
MC v[68:71],v[36:39],v[132:135]
TR a[18:19],v9,8712
CV v30,v30,v31
MC v[68:71],v[40:43],v[144:147]
TR a[20:21],v9,12680
AW a150,v28
MC v[68:71],v[44:47],v[156:159]
TR a[22:23],v9,12936
AW a151,v30
M v[72:75],a[28:31],v[100:103],0
s_waitcnt vmcnt(4)
buffer_load_dwordx4 v12, s[12:15], s41 offen offset:3072 nt lds
MC v[72:75],a[32:35],v[112:115]
s_add_u32 m0, s34, 38016
TR a[24:25],v9,16904
v_mov_b32 v29, 0
MC v[72:75],a[36:39],v[124:127]
s_xor_b32 s41, s63, 0
TR a[26:27],v9,17160
v_mov_b32 v31, 0
MC v[72:75],v[36:39],v[136:139]
v_mov_b32 v28, 0
v_mov_b32 v30, 0
MC v[72:75],v[40:43],v[148:151]
v_bfe_u32 v21, v12, 4, 2
v_mov_b32 v22, 0x3f803f80
MC v[72:75],v[44:47],v[160:163]
v_cmp_eq_u32 vcc, 0, v21
s_nop 0
M v[76:79],a[28:31],v[104:107],0
LG 3
TR a[28:29],v9,21128
v_cndmask_b32 v23, 0, v22, vcc
MC v[76:79],a[32:35],v[116:119]
TR a[30:31],v9,21384
v_cmp_eq_u32 vcc, 1, v21
MC v[76:79],a[36:39],v[128:131]
v_subrev_u32 v9, 67584, v9
MC v[76:79],v[36:39],v[140:143]
MC v[76:79],v[40:43],v[152:155]
s_barrier
MC v[76:79],v[44:47],v[164:167]
s_waitcnt vmcnt(4)
buffer_load_dwordx4 v12, s[12:15], s40 offen offset:0 nt lds
M v[80:83],v[48:51],v[100:103],0
s_add_u32 m0, s34, 38048
TR a[32:33],v8,0
MC v[80:83],v[52:55],v[112:115]
TR a[34:35],v8,256
MC v[80:83],a[40:43],v[124:127]
TR a[36:37],v8,4224
MC v[80:83],a[44:47],v[136:139]
TR a[38:39],v8,4480
MC v[80:83],a[0:3],v[148:151]
TR v[36:37],v8,8448
MC v[80:83],a[4:7],v[160:163]
TR v[38:39],v8,8704
M v[84:87],v[48:51],v[104:107],0
TR v[40:41],v8,12672
MC v[84:87],v[52:55],v[116:119]
TR v[42:43],v8,12928
MC v[84:87],a[40:43],v[128:131]
TR v[44:45],v8,16896
MC v[84:87],a[44:47],v[140:143]
LG 7
TR v[46:47],v8,17152
MC v[84:87],a[0:3],v[152:155]
TR v[48:49],v8,21120
MC v[84:87],a[4:7],v[164:167]
s_waitcnt vmcnt(4)
buffer_load_dwordx4 v12, s[12:15], s40 offen offset:1024 nt lds
M v[88:91],a[8:11],v[100:103],0
s_add_u32 m0, s34, 38080
TR v[50:51],v8,21376
MC v[88:91],a[12:15],v[112:115]
TR v[52:53],v8,25344
MC v[88:91],a[16:19],v[124:127]
TR v[54:55],v8,25600
MC v[88:91],a[20:23],v[136:139]
TR a[40:41],v8,29568
MC v[88:91],a[24:27],v[148:151]
TR a[42:43],v8,29824
MC v[88:91],a[28:31],v[160:163]
LG 6
TR a[44:45],v8,8
M v[92:95],a[8:11],v[104:107],0
TR a[46:47],v8,264
MC v[92:95],a[12:15],v[116:119]
TR a[0:1],v8,4232
MC v[92:95],a[16:19],v[128:131]
TR a[2:3],v8,4488
MC v[92:95],a[20:23],v[140:143]
TR a[4:5],v8,8456
MC v[92:95],a[24:27],v[152:155]
s_waitcnt vmcnt(4)
buffer_load_dwordx4 v12, s[12:15], s40 offen offset:2048 nt lds
MC v[92:95],a[28:31],v[164:167]
s_add_u32 m0, s34, 38112
TR a[6:7],v8,8712
MC v[56:59],a[32:35],v[168:171]
TR a[8:9],v8,12680
MC v[56:59],a[36:39],v[180:183]
TR a[10:11],v8,12936
MC v[56:59],v[36:39],v[192:195]
LG 6
TR a[12:13],v8,16904
MC v[56:59],v[40:43],v[204:207]
TR a[14:15],v8,17160
MC v[56:59],v[44:47],v[216:219]
TR a[16:17],v8,21128
MC v[56:59],v[48:51],v[228:231]
TR a[18:19],v8,21384
MC v[56:59],v[52:55],v[240:243]
TR a[20:21],v8,25352
MC v[56:59],a[40:43],v[252:255]
TR a[22:23],v8,25608
s_nop 0
MC v[60:63],a[32:35],v[172:175]
TR a[24:25],v8,29576
s_nop 0
MC v[60:63],a[36:39],v[184:187]
s_waitcnt vmcnt(4)
buffer_load_dwordx4 v12, s[12:15], s40 offen offset:3072 nt lds
MC v[60:63],v[36:39],v[196:199]
s_add_u32 m0, s34, 67584
TR a[26:27],v8,29832
v_mul_f32 v56, s42, v56
MC v[60:63],v[40:43],v[208:211]
LG 6
TR a[28:29],v9,0
v_mul_f32 v57, s42, v57
MC v[60:63],v[44:47],v[220:223]
s_xor_b32 s40, s63, 135168
TR a[30:31],v9,256
v_mul_f32 v58, s42, v58
MC v[60:63],v[48:51],v[232:235]
RD a[172:175],v17,3072
v_mul_f32 v59, s42, v59
MC v[60:63],v[52:55],v[244:247]
CV v56,v56,v57
CV v57,v58,v59
MC v[60:63],a[40:43],a[48:51]
AW a184,v56
AW a185,v57
MC v[64:67],a[32:35],v[176:179]
TR a[32:33],v9,4224
s_nop 0
MC v[64:67],a[36:39],v[188:191]
TR a[34:35],v9,4480
MC v[64:67],v[36:39],v[200:203]
TR a[36:37],v9,8448
v_mul_f32 v60, s42, v60
MC v[64:67],v[40:43],v[212:215]
TR a[38:39],v9,8704
v_mul_f32 v61, s42, v61
MC v[64:67],v[44:47],v[224:227]
s_waitcnt vmcnt(4)
buffer_load_dwordx4 v12, s[16:19], s41 offen offset:0 nt lds
MC v[64:67],v[48:51],v[236:239]
s_add_u32 m0, s34, 67616
TR v[36:37],v9,12672
v_mul_f32 v62, s42, v62
MC v[64:67],v[52:55],v[248:251]
LG 5
TR v[38:39],v9,12928
v_mul_f32 v63, s42, v63
MC v[64:67],a[40:43],a[52:55]
TR v[40:41],v9,16896
CV v60,v60,v61
MC v[68:71],a[44:47],v[168:171]
TR v[42:43],v9,17152
AW a216,v60
MC v[68:71],a[0:3],v[180:183]
TR v[44:45],v9,21120
CV v61,v62,v63
MC v[68:71],a[4:7],v[192:195]
TR v[46:47],v9,21376
AW a217,v61
MC v[68:71],a[8:11],v[204:207]
TR v[48:49],v9,25344
v_mul_f32 v64, s42, v64
MC v[68:71],a[12:15],v[216:219]
TR v[50:51],v9,25600
v_mul_f32 v65, s42, v65
MC v[68:71],a[16:19],v[228:231]
TR v[52:53],v9,29568
v_mul_f32 v66, s42, v66
MC v[68:71],a[20:23],v[240:243]
TR v[54:55],v9,29824
v_mul_f32 v67, s42, v67
MC v[68:71],a[24:27],v[252:255]
LG 7
TR a[40:41],v9,8
CV v64,v64,v65
MC v[72:75],a[44:47],v[172:175]
s_waitcnt vmcnt(4)
buffer_load_dwordx4 v12, s[16:19], s41 offen offset:1024 nt lds
MC v[72:75],a[0:3],v[184:187]
s_add_u32 m0, s34, 67648
TR a[42:43],v9,264
AW a248,v64
MC v[72:75],a[4:7],v[196:199]
v_mul_f32 v68, s42, v68
v_mul_f32 v69, s42, v69
MC v[72:75],a[8:11],v[208:211]
v_mul_f32 v70, s42, v70
v_mul_f32 v71, s42, v71
MC v[72:75],a[12:15],v[220:223]
CV v58,v68,v69
CV v59,v70,v71
MC v[72:75],a[16:19],v[232:235]
ds_write_b128 v16, v[56:59] offset:0
MC v[72:75],a[20:23],v[244:247]
CV v65,v66,v67
AW a186,v58
MC v[72:75],a[24:27],a[48:51]
AW a249,v65
AW a187,v59
MC v[76:79],a[44:47],v[176:179]
TR a[44:45],v9,4232
s_nop 0
MC v[76:79],a[0:3],v[188:191]
TR a[46:47],v9,4488
MC v[76:79],a[4:7],v[200:203]
TR a[0:1],v9,8456
v_mul_f32 v72, s42, v72
MC v[76:79],a[8:11],v[212:215]
s_waitcnt vmcnt(4)
buffer_load_dwordx4 v12, s[16:19], s41 offen offset:2048 nt lds
MC v[76:79],a[12:15],v[224:227]
s_add_u32 m0, s34, 67680
TR a[2:3],v9,8712
v_mul_f32 v73, s42, v73
MC v[76:79],a[16:19],v[236:239]
LG 4
TR a[4:5],v9,12680
v_mul_f32 v74, s42, v74
MC v[76:79],a[20:23],v[248:251]
TR a[6:7],v9,12936
v_mul_f32 v75, s42, v75
MC v[76:79],a[24:27],a[52:55]
TR a[8:9],v9,16904
CV v62,v72,v73
MC v[80:83],a[28:31],v[172:175]
TR a[10:11],v9,17160
CV v63,v74,v75
MC v[80:83],a[32:35],v[184:187]
TR a[12:13],v9,21128
AW a218,v62
MC v[80:83],a[36:39],v[196:199]
TR a[14:15],v9,21384
AW a219,v63
MC v[80:83],v[36:39],v[208:211]
TR a[16:17],v9,25352
v_mul_f32 v76, s42, v76
MC v[80:83],v[40:43],v[220:223]
TR a[18:19],v9,25608
v_mul_f32 v77, s42, v77
MC v[80:83],v[44:47],v[232:235]
TR a[20:21],v9,29576
v_mul_f32 v78, s42, v78
MC v[80:83],v[48:51],v[244:247]
s_waitcnt vmcnt(4)
buffer_load_dwordx4 v12, s[16:19], s41 offen offset:3072 nt lds
MC v[80:83],v[52:55],a[48:51]
s_add_u32 m0, s34, 71808
TR a[22:23],v9,29832
v_mul_f32 v79, s42, v79
MC v[84:87],a[28:31],v[176:179]
s_xor_b32 s41, s63, 65536
CV v66,v76,v77
CV v67,v78,v79
MC v[84:87],a[32:35],v[188:191]
AW a250,v66
AW a251,v67
MC v[84:87],a[36:39],v[200:203]
v_mul_f32 v80, s42, v80
v_mul_f32 v81, s42, v81
MC v[84:87],v[36:39],v[212:215]
v_mul_f32 v82, s42, v82
v_mul_f32 v83, s42, v83
MC v[84:87],v[40:43],v[224:227]
CV v80,v80,v81
AW a220,v80
MC v[84:87],v[44:47],v[236:239]
s_cmp_lg_u32 s43, 0
s_cbranch_scc1 Y_hook0
Y_ret0:
CV v81,v82,v83
AW a221,v81
MC v[84:87],v[48:51],v[248:251]
s_barrier
MC v[84:87],v[52:55],a[52:55]
LG 0
RD a[24:27],v0,34176
s_nop 0
MC v[88:91],a[40:43],v[172:175]
RD a[28:31],v1,34176
s_nop 0
MC v[88:91],a[44:47],v[184:187]
s_waitcnt vmcnt(4)
buffer_load_dwordx4 v12, s[16:19], s40 offen offset:0 nt lds
MC v[88:91],a[0:3],v[196:199]
s_add_u32 m0, s34, 71840
RD a[32:35],v0,34304
v_mul_f32 v84, s42, v84
MC v[88:91],a[4:7],v[208:211]
RD a[36:39],v1,34304
v_mul_f32 v85, s42, v85
MC v[88:91],a[8:11],v[220:223]
RD v[52:55],v0,34432
v_mul_f32 v86, s42, v86
MC v[88:91],a[12:15],v[232:235]
RD a[188:191],v17,0
v_mul_f32 v87, s42, v87
MC v[88:91],a[16:19],v[244:247]
CV v84,v84,v85
AW a252,v84
MC v[88:91],a[20:23],a[48:51]
CV v85,v86,v87
AW a48,v23
MC v[92:95],a[40:43],v[176:179]
AW a253,v85
AW a49,v23
MC v[92:95],a[44:47],v[188:191]
AW a50,v23
AW a51,v23
MC v[92:95],a[0:3],v[200:203]
RD a[0:3],v0,33792
v_cndmask_b32 v23, 0, v22, vcc
MC v[92:95],a[4:7],v[212:215]
RD a[4:7],v1,33792
v_cmp_eq_u32 vcc, 2, v21
MC v[92:95],a[8:11],v[224:227]
RD a[8:11],v0,33920
v_mul_f32 v88, s42, v88
MC v[92:95],a[12:15],v[236:239]
RD a[12:15],v1,33920
v_mul_f32 v89, s42, v89
MC v[92:95],a[16:19],v[248:251]
RD a[16:19],v0,34048
v_mul_f32 v90, s42, v90
MC v[92:95],a[20:23],a[52:55]
LG 4
RD a[20:23],v1,34048
AW a52,v23
M v[36:39],a[0:3],a[64:67],v[32:35]
s_waitcnt vmcnt(4) lgkmcnt(4)
buffer_load_dwordx4 v12, s[16:19], s40 offen offset:1024 nt lds
MC v[36:39],a[4:7],a[68:71]
LG 3
AW a53,v23
AW a54,v23
MC v[36:39],a[8:11],a[72:75]
LG 2
v_mul_f32 v92, s42, v92
v_mul_f32 v93, s42, v93
MC v[36:39],a[12:15],a[76:79]
LG 1
CV v86,v92,v93
v_mul_f32 v94, s42, v94
MC v[36:39],a[16:19],a[80:83]
LG 0
v_mul_f32 v95, s42, v95
AW a254,v86
MC v[36:39],a[20:23],a[84:87]
s_add_u32 m0, s34, 71872
CV v87,v94,v95
AW a55,v23
MC v[36:39],a[24:27],a[88:91]
AW a255,v87
v_cndmask_b32 v23, 0, v22, vcc
MC v[36:39],a[28:31],a[92:95]
AW a56,v23
AW a57,v23
M v[40:43],a[0:3],a[96:99],v[24:27]
s_waitcnt vmcnt(4)
buffer_load_dwordx4 v12, s[16:19], s40 offen offset:2048 nt lds
MC v[40:43],a[4:7],a[100:103]
s_add_u32 m0, s34, 71904
AW a58,v23
AW a59,v23
MC v[40:43],a[8:11],a[104:107]
v_exp_f32 v36, v36
MC v[40:43],a[12:15],a[108:111]
v_exp_f32 v37, v37
MC v[40:43],a[16:19],a[112:115]
v_exp_f32 v38, v38
MC v[40:43],a[20:23],a[116:119]
v_exp_f32 v39, v39
MC v[40:43],a[24:27],a[120:123]
CV v72,v36,v37
CV v73,v38,v39
MC v[40:43],a[28:31],a[124:127]
v_mul_f32 v91, s42, v91
CV v82,v88,v89
M v[44:47],a[0:3],a[128:131],v[28:31]
s_mov_b32 s42, 286720
RD a[0:3],v1,34432
CV v83,v90,v91
MC v[44:47],a[4:7],a[132:135]
RD a[4:7],v0,34560
AW a222,v82
MC v[44:47],a[8:11],a[136:139]
RD a[8:11],v1,34560
AW a223,v83
MC v[44:47],a[12:15],a[140:143]
RD a[12:15],v0,34688
v_lshrrev_b32 v23, 9, v15
MC v[44:47],a[16:19],a[144:147]
RD a[16:19],v1,34688
v_subrev_u32 v0, 67584, v0
MC v[44:47],a[20:23],a[148:151]
s_waitcnt vmcnt(4)
buffer_load_dwordx4 v12, s[16:19], s40 offen offset:3072 nt lds
MC v[44:47],a[24:27],a[152:155]
s_add_u32 m0, s34, 0
v_exp_f32 v40, v40
MC v[44:47],a[28:31],a[156:159]
s_xor_b32 s40, s63, 200704
v_exp_f32 v41, v41
M v[48:51],a[32:35],a[64:67],v[32:35]
v_exp_f32 v42, v42
MC v[48:51],a[36:39],a[68:71]
v_exp_f32 v43, v43
MC v[48:51],v[52:55],a[72:75]
LG 2
RD a[20:23],v2,33792
CV v56,v40,v41
MC v[48:51],a[0:3],a[76:79]
RD a[24:27],v3,33792
CV v57,v42,v43
MC v[48:51],a[4:7],a[80:83]
v_exp_f32 v44, v44
MC v[48:51],a[8:11],a[84:87]
LG 2
v_exp_f32 v45, v45
MC v[48:51],a[12:15],a[88:91]
v_exp_f32 v46, v46
MC v[48:51],a[16:19],a[92:95]
v_exp_f32 v47, v47
M v[36:39],a[32:35],a[96:99],v[24:27]
s_waitcnt vmcnt(4)
buffer_load_dwordx4 v12, s[12:15], s41 offen offset:0 nt lds
MC v[36:39],a[36:39],a[100:103]
s_add_u32 m0, s34, 32
RD a[28:31],v2,33920
CV v64,v44,v45
MC v[36:39],v[52:55],a[104:107]
v_exp_f32 v48, v48
MC v[36:39],a[0:3],a[108:111]
v_exp_f32 v49, v49
MC v[36:39],a[4:7],a[112:115]
v_exp_f32 v50, v50
MC v[36:39],a[8:11],a[116:119]
v_exp_f32 v51, v51
MC v[36:39],a[12:15],a[120:123]
CV v74,v48,v49
CV v75,v50,v51
MC v[36:39],a[16:19],a[124:127]
ds_write_b128 v16, v[72:75] offset:1024
M v[40:43],a[32:35],a[128:131],v[28:31]
RD a[32:35],v3,33920
CV v65,v46,v47
MC v[40:43],a[36:39],a[132:135]
RD a[36:39],v2,34048
v_subrev_u32 v1, 67584, v1
MC v[40:43],v[52:55],a[136:139]
RD v[52:55],v3,34048
v_lshlrev_b32 v23, 7, v23
MC v[40:43],a[0:3],a[140:143]
RD a[0:3],v2,34176
v_add_u32 v23, 27000, v23
MC v[40:43],a[4:7],a[144:147]
s_waitcnt vmcnt(4)
buffer_load_dwordx4 v12, s[12:15], s41 offen offset:1024 nt lds
MC v[40:43],a[8:11],a[148:151]
s_add_u32 m0, s34, 64
RD a[4:7],v3,34176
v_bfe_u32 v21, v12, 4, 6
MC v[40:43],a[12:15],a[152:155]
v_exp_f32 v36, v36
MC v[40:43],a[16:19],a[156:159]
LG 5
v_exp_f32 v37, v37
M v[44:47],a[20:23],a[96:99],v[24:27]
v_exp_f32 v38, v38
MC v[44:47],a[24:27],a[100:103]
v_exp_f32 v39, v39
MC v[44:47],a[28:31],a[104:107]
LG 2
RD a[8:11],v2,34304
CV v58,v36,v37
MC v[44:47],a[32:35],a[108:111]
RD a[12:15],v3,34304
CV v59,v38,v39
MC v[44:47],a[36:39],a[112:115]
RD a[16:19],v2,34432
MC v[44:47],v[52:55],a[116:119]
LG 3
v_exp_f32 v40, v40
MC v[44:47],a[0:3],a[120:123]
v_exp_f32 v41, v41
MC v[44:47],a[4:7],a[124:127]
s_waitcnt vmcnt(4)
buffer_load_dwordx4 v12, s[12:15], s41 offen offset:2048 nt lds
M v[48:51],a[20:23],a[128:131],v[28:31]
s_add_u32 m0, s34, 96
v_exp_f32 v42, v42
MC v[48:51],a[24:27],a[132:135]
RD a[20:23],v3,34432
CV v66,v40,v41
MC v[48:51],a[28:31],a[136:139]
RD a[24:27],v2,34560
MC v[48:51],a[32:35],a[140:143]
RD a[28:31],v3,34560
MC v[48:51],a[36:39],a[144:147]
RD a[32:35],v2,34688
v_subrev_u32 v2, 67584, v2
MC v[48:51],v[52:55],a[148:151]
RD a[36:39],v3,34688
v_subrev_u32 v3, 67584, v3
MC v[48:51],a[0:3],a[152:155]
v_exp_f32 v43, v43
MC v[48:51],a[4:7],a[156:159]
LG 5
v_exp_f32 v44, v44
M v[36:39],a[8:11],a[96:99],v[24:27]
v_exp_f32 v45, v45
MC v[36:39],a[12:15],a[100:103]
v_exp_f32 v46, v46
MC v[36:39],a[16:19],a[104:107]
s_waitcnt vmcnt(4) lgkmcnt(3)
buffer_load_dwordx4 v12, s[12:15], s41 offen offset:3072 nt lds
MC v[36:39],a[20:23],a[108:111]
s_add_u32 m0, s34, 4224
v_exp_f32 v47, v47
MC v[36:39],a[24:27],a[112:115]
Y_pg7:
s_cbranch_execz Y_wr0
LG 1
s_barrier
CV v67,v42,v43
MC v[36:39],a[28:31],a[116:119]
s_xor_b32 s41, s63, 32768
RD v[52:55],v0,33792
CV v60,v44,v45
MC v[36:39],a[32:35],a[120:123]
LG 1
RD a[0:3],v1,33792
CV v61,v46,v47
MC v[36:39],a[36:39],a[124:127]
RD a[4:7],v0,33920
s_nop 0
M v[40:43],a[8:11],a[128:131],v[28:31]
v_exp_f32 v48, v48
MC v[40:43],a[12:15],a[132:135]
RD a[8:11],v1,33920
s_nop 0
MC v[40:43],a[16:19],a[136:139]
RD a[12:15],v0,34048
MC v[40:43],a[20:23],a[140:143]
RD a[16:19],v1,34048
MC v[40:43],a[24:27],a[144:147]
RD a[20:23],v0,34176
MC v[40:43],a[28:31],a[148:151]
RD a[24:27],v1,34176
MC v[40:43],a[32:35],a[152:155]
s_waitcnt vmcnt(4)
buffer_load_dwordx4 v12, s[12:15], s40 offen offset:0 nt lds
MC v[40:43],a[36:39],a[156:159]
LG 5
v_exp_f32 v49, v49
M v[44:47],v[52:55],a[64:67],v[32:35]
s_add_u32 m0, s34, 4256
v_exp_f32 v50, v50
MC v[44:47],a[0:3],a[68:71]
v_exp_f32 v51, v51
MC v[44:47],a[4:7],a[72:75]
LG 3
RD a[28:31],v0,34304
CV v68,v48,v49
MC v[44:47],a[8:11],a[76:79]
RD a[32:35],v1,34304
CV v69,v50,v51
MC v[44:47],a[12:15],a[80:83]
LG 3
v_exp_f32 v36, v36
MC v[44:47],a[16:19],a[84:87]
v_exp_f32 v37, v37
MC v[44:47],a[20:23],a[88:91]
LG 2
v_exp_f32 v38, v38
MC v[44:47],a[24:27],a[92:95]
v_exp_f32 v39, v39
M v[48:51],v[52:55],a[96:99],v[24:27]
RD a[36:39],v0,34432
CV v62,v36,v37
MC v[48:51],a[0:3],a[100:103]
s_waitcnt vmcnt(4)
buffer_load_dwordx4 v12, s[12:15], s40 offen offset:1024 nt lds
MC v[48:51],a[4:7],a[104:107]
s_add_u32 m0, s34, 4288
RD a[180:183],v17,4096
CV v63,v38,v39
MC v[48:51],a[8:11],a[108:111]
v_exp_f32 v40, v40
MC v[48:51],a[12:15],a[112:115]
v_exp_f32 v41, v41
MC v[48:51],a[16:19],a[116:119]
v_exp_f32 v42, v42
MC v[48:51],a[20:23],a[120:123]
v_exp_f32 v43, v43
MC v[48:51],a[24:27],a[124:127]
v_exp_f32 v44, v44
M v[36:39],v[52:55],a[128:131],v[28:31]
RD v[52:55],v1,34432
CV v70,v40,v41
MC v[36:39],a[0:3],a[132:135]
RD a[0:3],v0,34560
CV v71,v42,v43
MC v[36:39],a[4:7],a[136:139]
RD a[4:7],v1,34560
MC v[36:39],a[8:11],a[140:143]
RD a[8:11],v0,34688
MC v[36:39],a[12:15],a[144:147]
s_waitcnt vmcnt(4)
buffer_load_dwordx4 v12, s[12:15], s40 offen offset:2048 nt lds
MC v[36:39],a[16:19],a[148:151]
s_add_u32 m0, s34, 4320
RD a[12:15],v1,34688
MC v[36:39],a[20:23],a[152:155]
v_exp_f32 v45, v45
MC v[36:39],a[24:27],a[156:159]
LG 5
v_exp_f32 v46, v46
M v[40:43],a[28:31],a[64:67],v[32:35]
v_exp_f32 v47, v47
MC v[40:43],a[32:35],a[68:71]
RD a[16:19],v2,33792
CV v92,v44,v45
MC v[40:43],a[36:39],a[72:75]
LG 3
v_exp_f32 v48, v48
MC v[40:43],v[52:55],a[76:79]
v_exp_f32 v49, v49
MC v[40:43],a[0:3],a[80:83]
v_exp_f32 v50, v50
MC v[40:43],a[4:7],a[84:87]
LG 1
v_exp_f32 v51, v51
MC v[40:43],a[8:11],a[88:91]
RD a[20:23],v3,33792
CV v93,v46,v47
MC v[40:43],a[12:15],a[92:95]
s_waitcnt vmcnt(4)
buffer_load_dwordx4 v12, s[12:15], s40 offen offset:3072 nt lds
M v[44:47],a[28:31],a[96:99],v[24:27]
s_add_u32 m0, s34, 101376
RD a[24:27],v2,33920
CV v76,v48,v49
MC v[44:47],a[32:35],a[100:103]
s_xor_b32 s40, s63, 167936
RD a[40:43],v17,1024
CV v77,v50,v51
MC v[44:47],a[36:39],a[104:107]
v_exp_f32 v36, v36
MC v[44:47],v[52:55],a[108:111]
v_exp_f32 v37, v37
MC v[44:47],a[0:3],a[112:115]
v_exp_f32 v38, v38
MC v[44:47],a[4:7],a[116:119]
v_exp_f32 v39, v39
MC v[44:47],a[8:11],a[120:123]
v_exp_f32 v40, v40
MC v[44:47],a[12:15],a[124:127]
v_exp_f32 v41, v41
M v[48:51],a[28:31],a[128:131],v[28:31]
RD a[28:31],v3,33920
CV v84,v36,v37
MC v[48:51],a[32:35],a[132:135]
RD a[32:35],v2,34048
CV v85,v38,v39
MC v[48:51],a[36:39],a[136:139]
RD a[36:39],v3,34048
CV v94,v40,v41
MC v[48:51],v[52:55],a[140:143]
s_waitcnt vmcnt(4)
buffer_load_dwordx4 v12, s[16:19], s41 offen offset:0 nt lds
MC v[48:51],a[0:3],a[144:147]
s_add_u32 m0, s34, 101408
RD v[52:55],v2,34176
MC v[48:51],a[4:7],a[148:151]
RD a[0:3],v3,34176
MC v[48:51],a[8:11],a[152:155]
v_exp_f32 v42, v42
MC v[48:51],a[12:15],a[156:159]
LG 5
v_exp_f32 v43, v43
M v[36:39],a[16:19],a[96:99],v[24:27]
v_exp_f32 v44, v44
MC v[36:39],a[20:23],a[100:103]
v_exp_f32 v45, v45
MC v[36:39],a[24:27],a[104:107]
LG 2
v_exp_f32 v46, v46
MC v[36:39],a[28:31],a[108:111]
v_exp_f32 v47, v47
MC v[36:39],a[32:35],a[112:115]
RD a[4:7],v2,34304
CV v95,v42,v43
MC v[36:39],a[36:39],a[116:119]
s_waitcnt vmcnt(4) lgkmcnt(1)
buffer_load_dwordx4 v12, s[16:19], s41 offen offset:1024 nt lds
MC v[36:39],v[52:55],a[120:123]
s_add_u32 m0, s34, 101440
RD a[8:11],v3,34304
CV v78,v44,v45
MC v[36:39],a[0:3],a[124:127]
RD a[12:15],v2,34432
CV v79,v46,v47
M v[40:43],a[16:19],a[128:131],v[28:31]
RD a[16:19],v3,34432
s_nop 0
MC v[40:43],a[20:23],a[132:135]
RD a[20:23],v2,34560
MC v[40:43],a[24:27],a[136:139]
RD a[24:27],v3,34560
MC v[40:43],a[28:31],a[140:143]
RD a[28:31],v2,34688
MC v[40:43],a[32:35],a[144:147]
RD a[32:35],v3,34688
MC v[40:43],a[36:39],a[148:151]
v_exp_f32 v48, v48
MC v[40:43],v[52:55],a[152:155]
v_exp_f32 v49, v49
MC v[40:43],a[0:3],a[156:159]
s_waitcnt vmcnt(4) lgkmcnt(5)
buffer_load_dwordx4 v12, s[16:19], s41 offen offset:2048 nt lds
M v[44:47],a[4:7],a[96:99],v[24:27]
s_add_u32 m0, s34, 101472
v_exp_f32 v50, v50
MC v[44:47],a[8:11],a[100:103]
v_exp_f32 v51, v51
MC v[44:47],a[12:15],a[104:107]
LG 2
s_barrier
CV v86,v48,v49
MC v[44:47],a[16:19],a[108:111]
TR a[36:37],v4,0
CV v87,v50,v51
MC v[44:47],a[20:23],a[112:115]
TR a[38:39],v4,512
MC v[44:47],a[24:27],a[116:119]
LG 2
TR v[52:53],v6,0
MC v[44:47],a[28:31],a[120:123]
TR v[54:55],v6,512
MC v[44:47],a[32:35],a[124:127]
TR a[0:1],v4,32
s_nop 0
M v[48:51],a[4:7],a[128:131],v[28:31]
TR a[2:3],v4,544
s_nop 0
MC v[48:51],a[8:11],a[132:135]
TR a[4:5],v6,32
MC v[48:51],a[12:15],a[136:139]
s_waitcnt vmcnt(4)
buffer_load_dwordx4 v12, s[16:19], s41 offen offset:3072 nt lds
MC v[48:51],a[16:19],a[140:143]
s_add_u32 m0, s34, 105600
TR a[6:7],v6,544
s_xor_b32 s41, s63, 98304
MC v[48:51],a[20:23],a[144:147]
TR a[8:9],v5,0
MC v[48:51],a[24:27],a[148:151]
TR a[10:11],v5,512
MC v[48:51],a[28:31],a[152:155]
TR a[12:13],v7,0
MC v[48:51],a[32:35],a[156:159]
TR a[14:15],v7,512
s_nop 0
M a[60:63],a[48:51],v[56:59],0
TR a[16:17],v5,32
s_nop 0
MC a[60:63],a[48:51],v[60:63]
TR a[18:19],v5,544
MC a[60:63],a[52:55],v[64:67]
LG 7
TR a[20:21],v7,32
MC a[60:63],a[52:55],v[68:71]
TR a[22:23],v7,544
MC a[60:63],a[56:59],v[72:75]
TR a[24:25],v4,128
MC a[60:63],a[56:59],a[40:43]
s_waitcnt vmcnt(4)
buffer_load_dwordx4 v12, s[16:19], s40 offen offset:0 nt lds
M v[96:99],a[36:39],v[56:59],0
s_add_u32 m0, s34, 105632
TR a[26:27],v4,640
MC v[96:99],v[52:55],v[60:63]
TR a[28:29],v6,128
M v[104:107],v[52:55],v[68:71],0
TR a[30:31],v6,640
MC v[104:107],a[36:39],v[64:67]
TR a[32:33],v4,160
M v[112:115],a[36:39],v[72:75],0
LG 6
TR a[34:35],v4,672
MC v[112:115],v[52:55],a[40:43]
TR a[36:37],v6,160
M v[100:103],a[0:3],v[56:59],0
TR a[38:39],v6,672
MC v[100:103],a[4:7],v[60:63]
ds_write_b128 v16, v[92:95] offset:0
M v[108:111],a[4:7],v[68:71],0
TR v[52:53],v5,128
MC v[108:111],a[0:3],v[64:67]
TR v[54:55],v5,640
M v[116:119],a[0:3],v[72:75],0
TR a[0:1],v7,128
MC v[116:119],a[4:7],a[40:43]
s_waitcnt vmcnt(4)
buffer_load_dwordx4 v12, s[16:19], s40 offen offset:1024 nt lds
M v[120:123],a[8:11],v[56:59],0
s_add_u32 m0, s34, 105664
TR a[2:3],v7,640
MC v[120:123],a[12:15],v[60:63]
LG 6
TR a[4:5],v5,160
M v[128:131],a[12:15],v[68:71],0
s_mov_b64 exec, 0
s_cmp_eq_u32 s32, 0
s_cbranch_scc1 Y_pg9
s_cmp_eq_u32 s32, 1
s_cbranch_scc1 Y_pg10
s_cmp_eq_u32 s32, 2
s_cbranch_scc1 Y_pg11
s_branch Y_pg12
Y_wr1:
s_mov_b64 exec, -1
TR a[6:7],v5,672
MC v[128:131],a[8:11],v[64:67]
TR a[8:9],v7,160
M v[124:127],a[16:19],v[56:59],0
TR a[10:11],v7,672
MC v[124:127],a[20:23],v[60:63]
TR a[12:13],v4,256
M v[132:135],a[20:23],v[68:71],0
TR a[14:15],v4,768
MC v[132:135],a[16:19],v[64:67]
TR a[16:17],v6,256
M v[136:139],a[24:27],v[56:59],0
TR a[18:19],v6,768
MC v[136:139],a[28:31],v[60:63]
v_exp_f32 v36, v36
M v[144:147],a[28:31],v[68:71],0
s_waitcnt vmcnt(4)
buffer_load_dwordx4 v12, s[16:19], s40 offen offset:2048 nt lds
MC v[144:147],a[24:27],v[64:67]
LG 5
TR a[20:21],v4,288
s_add_u32 m0, s34, 105696
M v[152:155],a[24:27],v[72:75],0
TR a[22:23],v4,800
MC v[152:155],a[28:31],a[40:43]
TR a[24:25],v6,288
M v[140:143],a[32:35],v[56:59],0
TR a[26:27],v6,800
MC v[140:143],a[36:39],v[60:63]
v_exp_f32 v37, v37
M v[148:151],a[36:39],v[68:71],0
TR a[28:29],v5,256
CV v80,v36,v37
MC v[148:151],a[32:35],v[64:67]
TR a[30:31],v5,768
M v[156:159],a[32:35],v[72:75],0
TR a[32:33],v7,256
MC v[156:159],a[36:39],a[40:43]
TR a[34:35],v7,768
M v[160:163],v[52:55],v[56:59],0
TR a[36:37],v5,288
MC v[160:163],a[0:3],v[60:63]
s_waitcnt vmcnt(4)
buffer_load_dwordx4 v12, s[16:19], s40 offen offset:3072 nt lds
M v[168:171],a[0:3],v[68:71],0
LG 5
TR a[38:39],v5,800
s_add_u32 m0, s34, 33792
MC v[168:171],v[52:55],v[64:67]
s_xor_b32 s40, s63, 233472
TR v[52:53],v7,288
M v[164:167],a[4:7],v[56:59],0
TR v[54:55],v7,800
MC v[164:167],a[8:11],v[60:63]
TR a[0:1],v4,384
M v[172:175],a[8:11],v[68:71],0
TR a[2:3],v4,896
MC v[172:175],a[4:7],v[64:67]
TR a[4:5],v6,384
M v[176:179],a[12:15],v[56:59],0
TR a[6:7],v6,896
MC v[176:179],a[16:19],v[60:63]
v_exp_f32 v38, v38
M v[184:187],a[16:19],v[68:71],0
TR a[8:9],v4,416
MC v[184:187],a[12:15],v[64:67]
TR a[10:11],v4,928
M v[192:195],a[12:15],v[72:75],0
s_waitcnt vmcnt(4)
buffer_load_dwordx4 v12, s[12:15], s41 offen offset:0 nt lds
MC v[192:195],a[16:19],a[40:43]
LG 5
TR a[12:13],v6,416
s_add_u32 m0, s34, 33824
M v[180:183],a[20:23],v[56:59],0
TR a[14:15],v6,928
MC v[180:183],a[24:27],v[60:63]
v_exp_f32 v39, v39
M v[188:191],a[24:27],v[68:71],0
TR a[16:17],v5,384
CV v81,v38,v39
MC v[188:191],a[20:23],v[64:67]
TR a[18:19],v5,896
M v[196:199],a[20:23],v[72:75],0
TR a[20:21],v7,384
MC v[196:199],a[24:27],a[40:43]
TR a[22:23],v7,896
M v[200:203],a[28:31],v[56:59],0
TR a[24:25],v5,416
MC v[200:203],a[32:35],v[60:63]
TR a[26:27],v5,928
M v[208:211],a[32:35],v[68:71],0
v_exp_f32 v40, v40
MC v[208:211],a[28:31],v[64:67]
s_waitcnt vmcnt(4)
buffer_load_dwordx4 v12, s[12:15], s41 offen offset:1024 nt lds
M v[204:207],a[36:39],v[56:59],0
s_add_u32 m0, s34, 33856
TR a[28:29],v7,416
MC v[204:207],v[52:55],v[60:63]
LG 5
TR a[30:31],v7,928
M v[212:215],v[52:55],v[68:71],0
v_exp_f32 v41, v41
MC v[212:215],a[36:39],v[64:67]
v_exp_f32 v42, v42
M v[216:219],a[0:3],v[56:59],0
v_exp_f32 v43, v43
MC v[216:219],a[4:7],v[60:63]
s_barrier
CV v88,v40,v41
CV v89,v42,v43
M v[224:227],a[4:7],v[68:71],0
RD a[32:35],v0,0
MC v[224:227],a[0:3],v[64:67]
RD a[36:39],v1,0
M v[232:235],a[0:3],v[72:75],0
RD v[52:55],v0,128
MC v[232:235],a[4:7],a[40:43]
s_waitcnt vmcnt(4)
buffer_load_dwordx4 v12, s[12:15], s41 offen offset:2048 nt lds
M v[220:223],a[8:11],v[56:59],0
s_add_u32 m0, s34, 33888
RD a[0:3],v1,128
MC v[220:223],a[12:15],v[60:63]
RD a[4:7],v0,256
M v[228:231],a[12:15],v[68:71],0
v_exp_f32 v44, v44
MC v[228:231],a[8:11],v[64:67]
v_exp_f32 v45, v45
M v[236:239],a[8:11],v[72:75],0
RD a[8:11],v1,256
CV v82,v44,v45
MC v[236:239],a[12:15],a[40:43]
RD a[12:15],v0,384
M v[240:243],a[16:19],v[56:59],0
LG 4
v_exp_f32 v46, v46
MC v[240:243],a[20:23],v[60:63]
v_exp_f32 v47, v47
M v[248:251],a[20:23],v[68:71],0
v_exp_f32 v48, v48
MC v[248:251],a[16:19],v[64:67]
RD a[16:19],v1,384
CV v83,v46,v47
M v[244:247],a[24:27],v[56:59],0
s_waitcnt vmcnt(4)
buffer_load_dwordx4 v12, s[12:15], s41 offen offset:3072 nt lds
MC v[244:247],a[28:31],v[60:63]
s_add_u32 m0, s34, 38016
v_exp_f32 v49, v49
M v[252:255],a[28:31],v[68:71],0
s_xor_b32 s41, s63, 65536
v_exp_f32 v50, v50
MC v[252:255],a[24:27],v[64:67]
v_exp_f32 v51, v51
M v[36:39],a[32:35],a[64:67],v[32:35]
RD a[20:23],v0,512
CV v90,v48,v49
MC v[36:39],a[36:39],a[68:71]
RD a[28:31],v0,640
CV v91,v50,v51
MC v[36:39],v[52:55],a[72:75]
LG 3
RD a[24:27],v1,512
MC v[36:39],a[0:3],a[76:79]
RD a[44:47],v17,0
MC v[36:39],a[4:7],a[80:83]
MC v[36:39],a[8:11],a[84:87]
MC v[36:39],a[12:15],a[88:91]
s_waitcnt vmcnt(4) lgkmcnt(4)
buffer_load_dwordx4 v12, s[12:15], s40 offen offset:0 nt lds
MC v[36:39],a[16:19],a[92:95]
s_add_u32 m0, s34, 38048
s_nop 1
M v[40:43],a[32:35],a[96:99],v[24:27]
s_nop 2
MC v[40:43],a[36:39],a[100:103]
v_exp_f32 v36, v36
MC v[40:43],v[52:55],a[104:107]
v_exp_f32 v37, v37
MC v[40:43],a[0:3],a[108:111]
v_exp_f32 v38, v38
MC v[40:43],a[4:7],a[112:115]
v_exp_f32 v39, v39
MC v[40:43],a[8:11],a[116:119]
CV v72,v36,v37
CV v73,v38,v39
MC v[40:43],a[12:15],a[120:123]
MC v[40:43],a[16:19],a[124:127]
s_nop 2
M v[44:47],a[32:35],a[128:131],v[28:31]
RD a[32:35],v1,640
s_nop 0
MC v[44:47],a[36:39],a[132:135]
RD a[36:39],v0,768
MC v[44:47],v[52:55],a[136:139]
s_waitcnt vmcnt(4)
buffer_load_dwordx4 v12, s[12:15], s40 offen offset:1024 nt lds
MC v[44:47],a[0:3],a[140:143]
s_add_u32 m0, s34, 38080
RD v[52:55],v1,768
MC v[44:47],a[4:7],a[144:147]
RD a[0:3],v0,896
MC v[44:47],a[8:11],a[148:151]
RD a[4:7],v1,896
MC v[44:47],a[12:15],a[152:155]
v_exp_f32 v40, v40
MC v[44:47],a[16:19],a[156:159]
LG 5
v_exp_f32 v41, v41
M v[48:51],a[20:23],a[64:67],v[32:35]
v_exp_f32 v42, v42
MC v[48:51],a[24:27],a[68:71]
v_exp_f32 v43, v43
MC v[48:51],a[28:31],a[72:75]
s_waitcnt vmcnt(4) lgkmcnt(3)
buffer_load_dwordx4 v12, s[12:15], s40 offen offset:2048 nt lds
MC v[48:51],a[32:35],a[76:79]
s_add_u32 m0, s34, 38112
RD a[8:11],v2,0
CV v56,v40,v41
MC v[48:51],a[36:39],a[80:83]
LG 2
RD a[12:15],v3,0
CV v57,v42,v43
MC v[48:51],v[52:55],a[84:87]
RD a[16:19],v2,128
MC v[48:51],a[0:3],a[88:91]
LG 3
v_exp_f32 v44, v44
MC v[48:51],a[4:7],a[92:95]
v_exp_f32 v45, v45
M v[36:39],a[20:23],a[96:99],v[24:27]
v_exp_f32 v46, v46
MC v[36:39],a[24:27],a[100:103]
v_exp_f32 v47, v47
MC v[36:39],a[28:31],a[104:107]
CV v64,v44,v45
CV v65,v46,v47
MC v[36:39],a[32:35],a[108:111]
v_exp_f32 v48, v48
MC v[36:39],a[36:39],a[112:115]
s_waitcnt vmcnt(4)
buffer_load_dwordx4 v12, s[12:15], s40 offen offset:3072 nt lds
MC v[36:39],v[52:55],a[116:119]
s_add_u32 m0, s34, 67584
v_exp_f32 v49, v49
MC v[36:39],a[0:3],a[120:123]
s_xor_b32 s40, s63, 200704
v_exp_f32 v50, v50
MC v[36:39],a[4:7],a[124:127]
v_exp_f32 v51, v51
M v[40:43],a[20:23],a[128:131],v[28:31]
RD a[20:23],v3,128
CV v74,v48,v49
MC v[40:43],a[24:27],a[132:135]
RD a[24:27],v2,256
CV v75,v50,v51
MC v[40:43],a[28:31],a[136:139]
RD a[28:31],v3,256
MC v[40:43],a[32:35],a[140:143]
RD a[32:35],v2,384
MC v[40:43],a[36:39],a[144:147]
RD a[36:39],v3,384
MC v[40:43],v[52:55],a[148:151]
v_exp_f32 v36, v36
MC v[40:43],a[0:3],a[152:155]
v_exp_f32 v37, v37
MC v[40:43],a[4:7],a[156:159]
s_waitcnt vmcnt(4) lgkmcnt(5)
buffer_load_dwordx4 v12, s[16:19], s41 offen offset:0 nt lds
M v[44:47],a[8:11],a[96:99],v[24:27]
s_add_u32 m0, s34, 67616
v_exp_f32 v38, v38
MC v[44:47],a[12:15],a[100:103]
v_exp_f32 v39, v39
MC v[44:47],a[16:19],a[104:107]
LG 2
RD v[52:55],v2,512
CV v58,v36,v37
MC v[44:47],a[20:23],a[108:111]
Y_pg8:
s_cbranch_execz Y_wr0
RD a[0:3],v3,512
CV v59,v38,v39
MC v[44:47],a[24:27],a[112:115]
RD a[4:7],v2,640
MC v[44:47],a[28:31],a[116:119]
LG 3
v_exp_f32 v40, v40
MC v[44:47],a[32:35],a[120:123]
v_exp_f32 v41, v41
MC v[44:47],a[36:39],a[124:127]
v_exp_f32 v42, v42
M v[48:51],a[8:11],a[128:131],v[28:31]
RD a[8:11],v3,640
CV v66,v40,v41
MC v[48:51],a[12:15],a[132:135]
RD a[12:15],v2,768
s_nop 0
MC v[48:51],a[16:19],a[136:139]
RD a[16:19],v3,768
MC v[48:51],a[20:23],a[140:143]
s_waitcnt vmcnt(4)
buffer_load_dwordx4 v12, s[16:19], s41 offen offset:1024 nt lds
MC v[48:51],a[24:27],a[144:147]
s_add_u32 m0, s34, 67648
RD a[20:23],v2,896
MC v[48:51],a[28:31],a[148:151]
RD a[24:27],v3,896
MC v[48:51],a[32:35],a[152:155]
v_exp_f32 v43, v43
MC v[48:51],a[36:39],a[156:159]
LG 5
CV v67,v42,v43
s_nop 0
M v[36:39],v[52:55],a[96:99],v[24:27]
ds_write_b128 v16, v[72:75] offset:1024
MC v[36:39],a[0:3],a[100:103]
v_exp_f32 v44, v44
MC v[36:39],a[4:7],a[104:107]
LG 3
s_barrier
MC v[36:39],a[8:11],a[108:111]
s_waitcnt vmcnt(4)
buffer_load_dwordx4 v12, s[16:19], s41 offen offset:2048 nt lds
MC v[36:39],a[12:15],a[112:115]
s_add_u32 m0, s34, 67680
TR a[28:29],v4,33792
MC v[36:39],a[16:19],a[116:119]
LG 2
TR a[30:31],v4,34304
MC v[36:39],a[20:23],a[120:123]
TR a[32:33],v6,33792
MC v[36:39],a[24:27],a[124:127]
TR a[34:35],v6,34304
s_nop 0
M v[40:43],v[52:55],a[128:131],v[28:31]
TR a[36:37],v4,33824
s_nop 0
MC v[40:43],a[0:3],a[132:135]
TR a[38:39],v4,34336
MC v[40:43],a[4:7],a[136:139]
TR v[52:53],v6,33824
MC v[40:43],a[8:11],a[140:143]
TR v[54:55],v6,34336
MC v[40:43],a[12:15],a[144:147]
TR a[0:1],v5,33792
MC v[40:43],a[16:19],a[148:151]
TR a[2:3],v5,34304
MC v[40:43],a[20:23],a[152:155]
s_waitcnt vmcnt(4)
buffer_load_dwordx4 v12, s[16:19], s41 offen offset:3072 nt lds
MC v[40:43],a[24:27],a[156:159]
s_add_u32 m0, s34, 71808
TR a[4:5],v7,33792
s_xor_b32 s41, s63, 131072
MC a[60:63],a[48:51],v[76:79]
TR a[6:7],v7,34304
s_nop 0
MC a[60:63],a[48:51],v[80:83]
TR a[8:9],v5,33824
MC a[60:63],a[52:55],v[84:87]
LG 6
TR a[10:11],v5,34336
MC a[60:63],a[52:55],v[88:91]
TR a[12:13],v7,33824
MC a[60:63],a[56:59],v[92:95]
TR a[14:15],v7,34336
MC a[60:63],a[56:59],a[44:47]
TR a[16:17],v4,33920
MC v[96:99],a[28:31],v[76:79]
TR a[18:19],v4,34432
MC v[96:99],a[32:35],v[80:83]
TR a[20:21],v6,33920
MC v[104:107],a[32:35],v[88:91]
s_waitcnt vmcnt(4)
buffer_load_dwordx4 v12, s[16:19], s40 offen offset:0 nt lds
MC v[104:107],a[28:31],v[84:87]
s_add_u32 m0, s34, 71840
TR a[22:23],v6,34432
MC v[112:115],a[28:31],v[92:95]
TR a[24:25],v4,33952
MC v[112:115],a[32:35],a[44:47]
LG 6
TR a[26:27],v4,34464
MC v[100:103],a[36:39],v[76:79]
TR a[28:29],v6,33952
MC v[100:103],v[52:55],v[80:83]
TR a[30:31],v6,34464
MC v[108:111],v[52:55],v[88:91]
TR a[32:33],v5,33920
MC v[108:111],a[36:39],v[84:87]
TR a[34:35],v5,34432
MC v[116:119],a[36:39],v[92:95]
TR a[36:37],v7,33920
MC v[116:119],v[52:55],a[44:47]
TR a[38:39],v7,34432
MC v[120:123],a[0:3],v[76:79]
s_waitcnt vmcnt(4)
buffer_load_dwordx4 v12, s[16:19], s40 offen offset:1024 nt lds
MC v[120:123],a[4:7],v[80:83]
s_add_u32 m0, s34, 71872
TR v[52:53],v5,33952
MC v[128:131],a[4:7],v[88:91]
LG 6
TR v[54:55],v5,34464
MC v[128:131],a[0:3],v[84:87]
TR a[0:1],v7,33952
MC v[124:127],a[8:11],v[76:79]
TR a[2:3],v7,34464
MC v[124:127],a[12:15],v[80:83]
TR a[4:5],v4,34048
MC v[132:135],a[12:15],v[88:91]
TR a[6:7],v4,34560
MC v[132:135],a[8:11],v[84:87]
TR a[8:9],v6,34048
MC v[136:139],a[16:19],v[76:79]
TR a[10:11],v6,34560
MC v[136:139],a[20:23],v[80:83]
v_exp_f32 v45, v45
MC v[144:147],a[20:23],v[88:91]
s_waitcnt vmcnt(4)
buffer_load_dwordx4 v12, s[16:19], s40 offen offset:2048 nt lds
MC v[144:147],a[16:19],v[84:87]
s_add_u32 m0, s34, 71904
TR a[12:13],v4,34080
CV v60,v44,v45
MC v[152:155],a[16:19],v[92:95]
LG 5
TR a[14:15],v4,34592
MC v[152:155],a[20:23],a[44:47]
TR a[16:17],v6,34080
MC v[140:143],a[24:27],v[76:79]
TR a[18:19],v6,34592
MC v[140:143],a[28:31],v[80:83]
v_exp_f32 v46, v46
MC v[148:151],a[28:31],v[88:91]
TR a[20:21],v5,34048
MC v[148:151],a[24:27],v[84:87]
TR a[22:23],v5,34560
MC v[156:159],a[24:27],v[92:95]
TR a[24:25],v7,34048
MC v[156:159],a[28:31],a[44:47]
TR a[26:27],v7,34560
MC v[160:163],a[32:35],v[76:79]
TR a[28:29],v5,34080
MC v[160:163],a[36:39],v[80:83]
s_waitcnt vmcnt(4)
buffer_load_dwordx4 v12, s[16:19], s40 offen offset:3072 nt lds
MC v[168:171],a[36:39],v[88:91]
s_add_u32 m0, s34, 0
TR a[30:31],v5,34592
s_xor_b32 s40, s63, 4096
MC v[168:171],a[32:35],v[84:87]
LG 6
TR a[32:33],v7,34080
MC v[164:167],v[52:55],v[76:79]
TR a[34:35],v7,34592
MC v[164:167],a[0:3],v[80:83]
TR a[36:37],v4,34176
MC v[172:175],a[0:3],v[88:91]
TR a[38:39],v4,34688
MC v[172:175],v[52:55],v[84:87]
TR v[52:53],v6,34176
MC v[176:179],a[4:7],v[76:79]
TR v[54:55],v6,34688
MC v[176:179],a[8:11],v[80:83]
v_exp_f32 v47, v47
MC v[184:187],a[8:11],v[88:91]
TR a[0:1],v4,34208
CV v61,v46,v47
MC v[184:187],a[4:7],v[84:87]
s_waitcnt vmcnt(4)
buffer_load_dwordx4 v12, s[12:15], s41 offen offset:0 nt lds
MC v[192:195],a[4:7],v[92:95]
s_add_u32 m0, s34, 32
TR a[2:3],v4,34720
MC v[192:195],a[8:11],a[44:47]
LG 5
TR a[4:5],v6,34208
MC v[180:183],a[12:15],v[76:79]
TR a[6:7],v6,34720
MC v[180:183],a[16:19],v[80:83]
v_exp_f32 v48, v48
MC v[188:191],a[16:19],v[88:91]
TR a[8:9],v5,34176
MC v[188:191],a[12:15],v[84:87]
TR a[10:11],v5,34688
MC v[196:199],a[12:15],v[92:95]
TR a[12:13],v7,34176
MC v[196:199],a[16:19],a[44:47]
TR a[14:15],v7,34688
MC v[200:203],a[20:23],v[76:79]
TR a[16:17],v5,34208
MC v[200:203],a[24:27],v[80:83]
s_waitcnt vmcnt(4)
buffer_load_dwordx4 v12, s[12:15], s41 offen offset:1024 nt lds
MC v[208:211],a[24:27],v[88:91]
s_add_u32 m0, s34, 64
TR a[18:19],v5,34720
MC v[208:211],a[20:23],v[84:87]
TR a[20:21],v7,34208
MC v[204:207],a[28:31],v[76:79]
LG 6
TR a[22:23],v7,34720
MC v[204:207],a[32:35],v[80:83]
v_exp_f32 v49, v49
MC v[212:215],a[32:35],v[88:91]
v_exp_f32 v50, v50
MC v[212:215],a[28:31],v[84:87]
v_exp_f32 v51, v51
MC v[216:219],a[36:39],v[76:79]
CV v68,v48,v49
CV v69,v50,v51
MC v[216:219],v[52:55],v[80:83]
s_barrier
MC v[224:227],v[52:55],v[88:91]
RD a[24:27],v0,33792
MC v[224:227],a[36:39],v[84:87]
RD a[28:31],v1,33792
MC v[232:235],a[36:39],v[92:95]
s_waitcnt vmcnt(4)
buffer_load_dwordx4 v12, s[12:15], s41 offen offset:2048 nt lds
MC v[232:235],v[52:55],a[44:47]
s_add_u32 m0, s34, 96
RD a[32:35],v0,33920
MC v[220:223],a[0:3],v[76:79]
RD a[36:39],v1,33920
MC v[220:223],a[4:7],v[80:83]
RD v[52:55],v0,34048
MC v[228:231],a[4:7],v[88:91]
v_exp_f32 v36, v36
MC v[228:231],a[0:3],v[84:87]
v_exp_f32 v37, v37
MC v[236:239],a[0:3],v[92:95]
RD a[0:3],v1,34048
CV v62,v36,v37
MC v[236:239],a[4:7],a[44:47]
LG 4
RD a[4:7],v0,34176
MC v[240:243],a[8:11],v[76:79]
v_exp_f32 v38, v38
MC v[240:243],a[12:15],v[80:83]
v_exp_f32 v39, v39
MC v[248:251],a[12:15],v[88:91]
s_waitcnt vmcnt(4)
buffer_load_dwordx4 v12, s[12:15], s41 offen offset:3072 nt lds
MC v[248:251],a[8:11],v[84:87]
s_add_u32 m0, s34, 4224
RD a[8:11],v1,34176
CV v63,v38,v39
MC v[244:247],a[16:19],v[76:79]
s_xor_b32 s41, s63, 98304
v_exp_f32 v40, v40
MC v[244:247],a[20:23],v[80:83]
v_exp_f32 v41, v41
MC v[252:255],a[20:23],v[88:91]
v_exp_f32 v42, v42
MC v[252:255],a[16:19],v[84:87]
v_exp_f32 v43, v43
M v[44:47],a[24:27],a[64:67],v[32:35]
RD a[12:15],v0,34304
CV v70,v40,v41
MC v[44:47],a[28:31],a[68:71]
LG 2
RD a[20:23],v0,34432
CV v71,v42,v43
MC v[44:47],a[32:35],a[72:75]
RD a[16:19],v1,34304
MC v[44:47],a[36:39],a[76:79]
RD a[40:43],v17,1024
MC v[44:47],v[52:55],a[80:83]
s_waitcnt vmcnt(4)
buffer_load_dwordx4 v12, s[12:15], s40 offen offset:0 nt lds
MC v[44:47],a[0:3],a[84:87]
s_add_u32 m0, s34, 4256
MC v[44:47],a[4:7],a[88:91]
LG 4
MC v[44:47],a[8:11],a[92:95]
s_nop 2
M v[48:51],a[24:27],a[96:99],v[24:27]
s_nop 2
MC v[48:51],a[28:31],a[100:103]
v_exp_f32 v44, v44
MC v[48:51],a[32:35],a[104:107]
v_exp_f32 v45, v45
MC v[48:51],a[36:39],a[108:111]
v_exp_f32 v46, v46
MC v[48:51],v[52:55],a[112:115]
v_exp_f32 v47, v47
MC v[48:51],a[0:3],a[116:119]
CV v92,v44,v45
CV v93,v46,v47
MC v[48:51],a[4:7],a[120:123]
s_waitcnt vmcnt(4)
buffer_load_dwordx4 v12, s[12:15], s40 offen offset:1024 nt lds
MC v[48:51],a[8:11],a[124:127]
s_add_u32 m0, s34, 4288
s_nop 1
M v[36:39],a[24:27],a[128:131],v[28:31]
RD a[24:27],v1,34432
s_nop 0
MC v[36:39],a[28:31],a[132:135]
RD a[28:31],v0,34560
MC v[36:39],a[32:35],a[136:139]
RD a[32:35],v1,34560
MC v[36:39],a[36:39],a[140:143]
RD a[36:39],v0,34688
MC v[36:39],v[52:55],a[144:147]
RD v[52:55],v1,34688
MC v[36:39],a[0:3],a[148:151]
v_exp_f32 v48, v48
MC v[36:39],a[4:7],a[152:155]
v_exp_f32 v49, v49
MC v[36:39],a[8:11],a[156:159]
LG 5
v_exp_f32 v50, v50
M v[40:43],a[12:15],a[64:67],v[32:35]
v_exp_f32 v51, v51
MC v[40:43],a[16:19],a[68:71]
s_waitcnt vmcnt(4)
buffer_load_dwordx4 v12, s[12:15], s40 offen offset:2048 nt lds
MC v[40:43],a[20:23],a[72:75]
LG 2
RD a[0:3],v2,33792
CV v76,v48,v49
MC v[40:43],a[24:27],a[76:79]
s_add_u32 m0, s34, 4320
RD a[4:7],v3,33792
CV v77,v50,v51
MC v[40:43],a[28:31],a[80:83]
s_getpc_b64 s[54:55]
RD a[8:11],v2,33920
MC v[40:43],a[32:35],a[84:87]
LG 3
v_exp_f32 v36, v36
MC v[40:43],a[36:39],a[88:91]
global_load_dword v14, v23, s[54:55]
MC v[40:43],v[52:55],a[92:95]
v_exp_f32 v37, v37
M v[44:47],a[12:15],a[96:99],v[24:27]
v_exp_f32 v38, v38
MC v[44:47],a[16:19],a[100:103]
v_exp_f32 v39, v39
MC v[44:47],a[20:23],a[104:107]
CV v84,v36,v37
CV v85,v38,v39
MC v[44:47],a[24:27],a[108:111]
s_waitcnt vmcnt(5)
buffer_load_dwordx4 v12, s[12:15], s40 offen offset:3072 nt lds
MC v[44:47],a[28:31],a[112:115]
s_add_u32 m0, s34, 101376
v_exp_f32 v40, v40
MC v[44:47],a[32:35],a[116:119]
s_xor_b32 s40, s63, 233472
v_exp_f32 v41, v41
MC v[44:47],a[36:39],a[120:123]
v_exp_f32 v42, v42
MC v[44:47],v[52:55],a[124:127]
v_exp_f32 v43, v43
M v[48:51],a[12:15],a[128:131],v[28:31]
RD a[12:15],v3,33920
CV v94,v40,v41
MC v[48:51],a[16:19],a[132:135]
RD a[16:19],v2,34048
CV v95,v42,v43
MC v[48:51],a[20:23],a[136:139]
RD a[20:23],v3,34048
v_lshrrev_b32 v23, 9, v15
MC v[48:51],a[24:27],a[140:143]
RD a[24:27],v2,34176
v_lshlrev_b32 v23, 7, v23
MC v[48:51],a[28:31],a[144:147]
RD a[28:31],v3,34176
v_add_u32 v23, 27000, v23
MC v[48:51],a[32:35],a[148:151]
s_waitcnt vmcnt(5)
buffer_load_dwordx4 v12, s[16:19], s41 offen offset:0 nt lds
MC v[48:51],a[36:39],a[152:155]
s_add_u32 m0, s34, 101408
v_exp_f32 v44, v44
MC v[48:51],v[52:55],a[156:159]
LG 5
v_exp_f32 v45, v45
M v[36:39],a[0:3],a[96:99],v[24:27]
v_exp_f32 v46, v46
MC v[36:39],a[4:7],a[100:103]
v_exp_f32 v47, v47
MC v[36:39],a[8:11],a[104:107]
LG 2
RD a[32:35],v2,34304
CV v78,v44,v45
MC v[36:39],a[12:15],a[108:111]
RD a[36:39],v3,34304
CV v79,v46,v47
MC v[36:39],a[16:19],a[112:115]
RD v[52:55],v2,34432
MC v[36:39],a[20:23],a[116:119]
LG 3
v_exp_f32 v48, v48
MC v[36:39],a[24:27],a[120:123]
v_exp_f32 v49, v49
MC v[36:39],a[28:31],a[124:127]
v_exp_f32 v50, v50
M v[40:43],a[0:3],a[128:131],v[28:31]
RD a[0:3],v3,34432
CV v86,v48,v49
MC v[40:43],a[4:7],a[132:135]
RD a[4:7],v2,34560
s_nop 0
MC v[40:43],a[8:11],a[136:139]
s_waitcnt vmcnt(5)
buffer_load_dwordx4 v12, s[16:19], s41 offen offset:1024 nt lds
MC v[40:43],a[12:15],a[140:143]
s_add_u32 m0, s34, 101440
RD a[8:11],v3,34560
MC v[40:43],a[16:19],a[144:147]
RD a[12:15],v2,34688
MC v[40:43],a[20:23],a[148:151]
RD a[16:19],v3,34688
MC v[40:43],a[24:27],a[152:155]
v_exp_f32 v51, v51
MC v[40:43],a[28:31],a[156:159]
LG 5
CV v87,v50,v51
s_nop 0
M v[44:47],a[32:35],a[96:99],v[24:27]
ds_write_b128 v16, v[92:95] offset:0
MC v[44:47],a[36:39],a[100:103]
v_exp_f32 v36, v36
MC v[44:47],v[52:55],a[104:107]
s_waitcnt vmcnt(5) lgkmcnt(4)
buffer_load_dwordx4 v12, s[16:19], s41 offen offset:2048 nt lds
MC v[44:47],a[0:3],a[108:111]
s_barrier
MC v[44:47],a[4:7],a[112:115]
LG 2
TR a[20:21],v4,0
s_add_u32 m0, s34, 101472
MC v[44:47],a[8:11],a[116:119]
TR a[22:23],v4,512
MC v[44:47],a[12:15],a[120:123]
LG 3
TR a[24:25],v6,0
MC v[44:47],a[16:19],a[124:127]
TR a[26:27],v6,512
s_nop 0
M v[48:51],a[32:35],a[128:131],v[28:31]
TR a[28:29],v4,32
s_nop 0
MC v[48:51],a[36:39],a[132:135]
TR a[30:31],v4,544
MC v[48:51],v[52:55],a[136:139]
TR a[32:33],v6,32
MC v[48:51],a[0:3],a[140:143]
TR a[34:35],v6,544
MC v[48:51],a[4:7],a[144:147]
s_waitcnt vmcnt(5)
buffer_load_dwordx4 v12, s[16:19], s41 offen offset:3072 nt lds
MC v[48:51],a[8:11],a[148:151]
s_add_u32 m0, s34, 105600
TR a[36:37],v5,0
s_xor_b32 s41, s63, 163840
MC v[48:51],a[12:15],a[152:155]
TR a[38:39],v5,512
MC v[48:51],a[16:19],a[156:159]
TR v[52:53],v7,0
s_nop 0
MC a[60:63],a[48:51],v[56:59]
TR v[54:55],v7,512
s_nop 0
MC a[60:63],a[48:51],v[60:63]
TR a[0:1],v5,32
MC a[60:63],a[52:55],v[64:67]
LG 6
TR a[2:3],v5,544
MC a[60:63],a[52:55],v[68:71]
TR a[4:5],v7,32
MC a[60:63],a[56:59],v[72:75]
TR a[6:7],v7,544
MC a[60:63],a[56:59],a[40:43]
TR a[8:9],v4,128
MC v[96:99],a[20:23],v[56:59]
s_waitcnt vmcnt(4)
buffer_load_dwordx4 v12, s[16:19], s40 offen offset:0 nt lds
MC v[96:99],a[24:27],v[60:63]
s_add_u32 m0, s34, 105632
TR a[10:11],v4,640
MC v[104:107],a[24:27],v[68:71]
TR a[12:13],v6,128
MC v[104:107],a[20:23],v[64:67]
TR a[14:15],v6,640
MC v[112:115],a[20:23],v[72:75]
TR a[16:17],v4,160
MC v[112:115],a[24:27],a[40:43]
LG 6
TR a[18:19],v4,672
MC v[100:103],a[28:31],v[56:59]
TR a[20:21],v6,160
MC v[100:103],a[32:35],v[60:63]
TR a[22:23],v6,672
MC v[108:111],a[32:35],v[68:71]
TR a[24:25],v5,128
MC v[108:111],a[28:31],v[64:67]
TR a[26:27],v5,640
MC v[116:119],a[28:31],v[72:75]
TR a[28:29],v7,128
MC v[116:119],a[32:35],a[40:43]
s_waitcnt vmcnt(4)
buffer_load_dwordx4 v12, s[16:19], s40 offen offset:1024 nt lds
MC v[120:123],a[36:39],v[56:59]
s_add_u32 m0, s34, 105664
TR a[30:31],v7,640
MC v[120:123],v[52:55],v[60:63]
TR a[32:33],v5,160
MC v[128:131],v[52:55],v[68:71]
LG 6
TR a[34:35],v5,672
MC v[128:131],a[36:39],v[64:67]
TR a[36:37],v7,160
MC v[124:127],a[0:3],v[56:59]
TR a[38:39],v7,672
MC v[124:127],a[4:7],v[60:63]
TR v[52:53],v4,256
MC v[132:135],a[4:7],v[68:71]
TR v[54:55],v4,768
MC v[132:135],a[0:3],v[64:67]
TR a[0:1],v6,256
MC v[136:139],a[8:11],v[56:59]
TR a[2:3],v6,768
MC v[136:139],a[12:15],v[60:63]
s_waitcnt vmcnt(4)
buffer_load_dwordx4 v12, s[16:19], s40 offen offset:2048 nt lds
MC v[144:147],a[12:15],v[68:71]
s_add_u32 m0, s34, 105696
TR a[4:5],v4,288
MC v[144:147],a[8:11],v[64:67]
LG 6
TR a[6:7],v4,800
MC v[152:155],a[8:11],v[72:75]
TR a[8:9],v6,288
MC v[152:155],a[12:15],a[40:43]
TR a[10:11],v6,800
MC v[140:143],a[16:19],v[56:59]
v_exp_f32 v37, v37
MC v[140:143],a[20:23],v[60:63]
TR a[12:13],v5,256
CV v80,v36,v37
MC v[148:151],a[20:23],v[68:71]
Y_pg9:
s_cbranch_execz Y_wr1
TR a[14:15],v5,768
MC v[148:151],a[16:19],v[64:67]
v_exp_f32 v38, v38
MC v[156:159],a[16:19],v[72:75]
TR a[16:17],v7,256
MC v[156:159],a[20:23],a[40:43]
s_waitcnt vmcnt(4)
buffer_load_dwordx4 v12, s[16:19], s40 offen offset:3072 nt lds
MC v[160:163],a[24:27],v[56:59]
s_add_u32 m0, s34, 33792
TR a[18:19],v7,768
s_xor_b32 s40, s63, 36864
MC v[160:163],a[28:31],v[60:63]
TR a[20:21],v5,288
MC v[168:171],a[28:31],v[68:71]
LG 5
TR a[22:23],v5,800
MC v[168:171],a[24:27],v[64:67]
TR a[24:25],v7,288
MC v[164:167],a[32:35],v[56:59]
TR a[26:27],v7,800
MC v[164:167],a[36:39],v[60:63]
TR a[28:29],v4,384
MC v[172:175],a[36:39],v[68:71]
TR a[30:31],v4,896
MC v[172:175],a[32:35],v[64:67]
TR a[32:33],v6,384
MC v[176:179],v[52:55],v[56:59]
TR a[34:35],v6,896
MC v[176:179],a[0:3],v[60:63]
s_waitcnt vmcnt(4)
buffer_load_dwordx4 v12, s[12:15], s41 offen offset:0 nt lds
MC v[184:187],a[0:3],v[68:71]
s_add_u32 m0, s34, 33824
TR a[36:37],v4,416
MC v[184:187],v[52:55],v[64:67]
TR a[38:39],v4,928
MC v[192:195],v[52:55],v[72:75]
LG 6
TR v[52:53],v6,416
MC v[192:195],a[0:3],a[40:43]
TR v[54:55],v6,928
MC v[180:183],a[4:7],v[56:59]
v_exp_f32 v39, v39
MC v[180:183],a[8:11],v[60:63]
TR a[0:1],v5,384
CV v81,v38,v39
MC v[188:191],a[8:11],v[68:71]
TR a[2:3],v5,896
MC v[188:191],a[4:7],v[64:67]
v_exp_f32 v40, v40
MC v[196:199],a[4:7],v[72:75]
TR a[4:5],v7,384
MC v[196:199],a[8:11],a[40:43]
TR a[6:7],v7,896
MC v[200:203],a[12:15],v[56:59]
s_waitcnt vmcnt(4)
buffer_load_dwordx4 v12, s[12:15], s41 offen offset:1024 nt lds
MC v[200:203],a[16:19],v[60:63]
s_add_u32 m0, s34, 33856
TR a[8:9],v5,416
MC v[208:211],a[16:19],v[68:71]
TR a[10:11],v5,928
MC v[208:211],a[12:15],v[64:67]
LG 5
TR a[12:13],v7,416
MC v[204:207],a[20:23],v[56:59]
TR a[14:15],v7,928
MC v[204:207],a[24:27],v[60:63]
v_exp_f32 v41, v41
MC v[212:215],a[24:27],v[68:71]
v_exp_f32 v42, v42
MC v[212:215],a[20:23],v[64:67]
v_exp_f32 v43, v43
MC v[216:219],a[28:31],v[56:59]
CV v88,v40,v41
CV v89,v42,v43
MC v[216:219],a[32:35],v[60:63]
s_barrier
MC v[224:227],a[32:35],v[68:71]
s_waitcnt vmcnt(4)
buffer_load_dwordx4 v12, s[12:15], s41 offen offset:2048 nt lds
MC v[224:227],a[28:31],v[64:67]
s_add_u32 m0, s34, 33888
RD a[16:19],v0,0
MC v[232:235],a[28:31],v[72:75]
RD a[20:23],v1,0
MC v[232:235],a[32:35],a[40:43]
RD a[24:27],v0,128
MC v[220:223],a[36:39],v[56:59]
RD a[28:31],v1,128
MC v[220:223],v[52:55],v[60:63]
RD a[32:35],v0,256
MC v[228:231],v[52:55],v[68:71]
v_exp_f32 v44, v44
MC v[228:231],a[36:39],v[64:67]
v_exp_f32 v45, v45
MC v[236:239],a[36:39],v[72:75]
RD a[36:39],v1,256
CV v82,v44,v45
MC v[236:239],v[52:55],a[40:43]
LG 5
RD v[52:55],v0,384
MC v[240:243],a[0:3],v[56:59]
s_waitcnt vmcnt(4)
buffer_load_dwordx4 v12, s[12:15], s41 offen offset:3072 nt lds
MC v[240:243],a[4:7],v[60:63]
s_add_u32 m0, s34, 38016
v_exp_f32 v46, v46
MC v[248:251],a[4:7],v[68:71]
s_xor_b32 s41, s63, 131072
v_exp_f32 v47, v47
MC v[248:251],a[0:3],v[64:67]
RD a[0:3],v1,384
CV v83,v46,v47
MC v[244:247],a[8:11],v[56:59]
v_exp_f32 v48, v48
MC v[244:247],a[12:15],v[60:63]
v_exp_f32 v49, v49
MC v[252:255],a[12:15],v[68:71]
v_exp_f32 v50, v50
MC v[252:255],a[8:11],v[64:67]
v_exp_f32 v51, v51
M v[36:39],a[16:19],a[64:67],v[32:35]
LG 1
RD a[4:7],v0,512
CV v90,v48,v49
MC v[36:39],a[20:23],a[68:71]
RD a[12:15],v0,640
CV v91,v50,v51
MC v[36:39],a[24:27],a[72:75]
RD a[8:11],v1,512
MC v[36:39],a[28:31],a[76:79]
s_waitcnt vmcnt(4)
buffer_load_dwordx4 v12, s[12:15], s40 offen offset:0 nt lds
MC v[36:39],a[32:35],a[80:83]
s_add_u32 m0, s34, 38048
RD a[44:47],v17,0
MC v[36:39],a[36:39],a[84:87]
MC v[36:39],v[52:55],a[88:91]
LG 4
MC v[36:39],a[0:3],a[92:95]
s_nop 2
M v[40:43],a[16:19],a[96:99],v[24:27]
s_nop 2
MC v[40:43],a[20:23],a[100:103]
v_exp_f32 v36, v36
MC v[40:43],a[24:27],a[104:107]
v_exp_f32 v37, v37
MC v[40:43],a[28:31],a[108:111]
v_exp_f32 v38, v38
MC v[40:43],a[32:35],a[112:115]
v_exp_f32 v39, v39
MC v[40:43],a[36:39],a[116:119]
s_waitcnt vmcnt(4)
buffer_load_dwordx4 v12, s[12:15], s40 offen offset:1024 nt lds
MC v[40:43],v[52:55],a[120:123]
s_add_u32 m0, s34, 38080
CV v72,v36,v37
CV v73,v38,v39
MC v[40:43],a[0:3],a[124:127]
s_nop 2
M v[44:47],a[16:19],a[128:131],v[28:31]
RD a[16:19],v1,640
s_nop 0
MC v[44:47],a[20:23],a[132:135]
RD a[20:23],v0,768
MC v[44:47],a[24:27],a[136:139]
RD a[24:27],v1,768
MC v[44:47],a[28:31],a[140:143]
RD a[28:31],v0,896
MC v[44:47],a[32:35],a[144:147]
RD a[32:35],v1,896
MC v[44:47],a[36:39],a[148:151]
v_exp_f32 v40, v40
MC v[44:47],v[52:55],a[152:155]
v_exp_f32 v41, v41
MC v[44:47],a[0:3],a[156:159]
s_waitcnt vmcnt(4) lgkmcnt(5)
buffer_load_dwordx4 v12, s[12:15], s40 offen offset:2048 nt lds
M v[48:51],a[4:7],a[64:67],v[32:35]
s_add_u32 m0, s34, 38112
v_exp_f32 v42, v42
MC v[48:51],a[8:11],a[68:71]
v_exp_f32 v43, v43
MC v[48:51],a[12:15],a[72:75]
LG 2
RD a[36:39],v2,0
CV v56,v40,v41
MC v[48:51],a[16:19],a[76:79]
RD v[52:55],v3,0
CV v57,v42,v43
MC v[48:51],a[20:23],a[80:83]
RD a[0:3],v2,128
MC v[48:51],a[24:27],a[84:87]
LG 3
v_exp_f32 v44, v44
MC v[48:51],a[28:31],a[88:91]
v_exp_f32 v45, v45
MC v[48:51],a[32:35],a[92:95]
v_exp_f32 v46, v46
M v[36:39],a[4:7],a[96:99],v[24:27]
v_exp_f32 v47, v47
MC v[36:39],a[8:11],a[100:103]
s_waitcnt vmcnt(4)
buffer_load_dwordx4 v12, s[12:15], s40 offen offset:3072 nt lds
MC v[36:39],a[12:15],a[104:107]
s_add_u32 m0, s34, 67584
CV v64,v44,v45
CV v65,v46,v47
MC v[36:39],a[16:19],a[108:111]
s_xor_b32 s40, s63, 4096
v_exp_f32 v48, v48
MC v[36:39],a[20:23],a[112:115]
v_exp_f32 v49, v49
MC v[36:39],a[24:27],a[116:119]
v_exp_f32 v50, v50
MC v[36:39],a[28:31],a[120:123]
v_exp_f32 v51, v51
MC v[36:39],a[32:35],a[124:127]
CV v74,v48,v49
CV v75,v50,v51
M v[40:43],a[4:7],a[128:131],v[28:31]
RD a[4:7],v3,128
s_nop 0
MC v[40:43],a[8:11],a[132:135]
RD a[8:11],v2,256
MC v[40:43],a[12:15],a[136:139]
RD a[12:15],v3,256
MC v[40:43],a[16:19],a[140:143]
RD a[16:19],v2,384
MC v[40:43],a[20:23],a[144:147]
RD a[20:23],v3,384
MC v[40:43],a[24:27],a[148:151]
s_waitcnt vmcnt(4)
buffer_load_dwordx4 v12, s[16:19], s41 offen offset:0 nt lds
MC v[40:43],a[28:31],a[152:155]
s_add_u32 m0, s34, 67616
v_exp_f32 v36, v36
MC v[40:43],a[32:35],a[156:159]
LG 5
v_exp_f32 v37, v37
M v[44:47],a[36:39],a[96:99],v[24:27]
v_exp_f32 v38, v38
MC v[44:47],v[52:55],a[100:103]
v_exp_f32 v39, v39
MC v[44:47],a[0:3],a[104:107]
LG 2
RD a[24:27],v2,512
CV v58,v36,v37
MC v[44:47],a[4:7],a[108:111]
RD a[28:31],v3,512
CV v59,v38,v39
MC v[44:47],a[8:11],a[112:115]
RD a[32:35],v2,640
MC v[44:47],a[12:15],a[116:119]
LG 3
v_exp_f32 v40, v40
MC v[44:47],a[16:19],a[120:123]
s_waitcnt vmcnt(4)
buffer_load_dwordx4 v12, s[16:19], s41 offen offset:1024 nt lds
MC v[44:47],a[20:23],a[124:127]
s_add_u32 m0, s34, 67648
v_exp_f32 v41, v41
M v[48:51],a[36:39],a[128:131],v[28:31]
RD a[36:39],v3,640
CV v66,v40,v41
MC v[48:51],v[52:55],a[132:135]
RD v[52:55],v2,768
MC v[48:51],a[0:3],a[136:139]
RD a[0:3],v3,768
MC v[48:51],a[4:7],a[140:143]
RD a[4:7],v2,896
MC v[48:51],a[8:11],a[144:147]
RD a[8:11],v3,896
MC v[48:51],a[12:15],a[148:151]
v_exp_f32 v42, v42
MC v[48:51],a[16:19],a[152:155]
v_exp_f32 v43, v43
MC v[48:51],a[20:23],a[156:159]
LG 5
CV v67,v42,v43
s_nop 0
M v[36:39],a[24:27],a[96:99],v[24:27]
s_waitcnt vmcnt(4)
buffer_load_dwordx4 v12, s[16:19], s41 offen offset:2048 nt lds
MC v[36:39],a[28:31],a[100:103]
s_barrier
MC v[36:39],a[32:35],a[104:107]
LG 2
TR a[12:13],v4,33792
s_add_u32 m0, s34, 67680
MC v[36:39],a[36:39],a[108:111]
TR a[14:15],v4,34304
MC v[36:39],v[52:55],a[112:115]
TR a[16:17],v6,33792
MC v[36:39],a[0:3],a[116:119]
LG 3
TR a[18:19],v6,34304
MC v[36:39],a[4:7],a[120:123]
TR a[20:21],v4,33824
MC v[36:39],a[8:11],a[124:127]
TR a[22:23],v4,34336
s_nop 0
M v[40:43],a[24:27],a[128:131],v[28:31]
TR a[24:25],v6,33824
s_nop 0
MC v[40:43],a[28:31],a[132:135]
TR a[26:27],v6,34336
MC v[40:43],a[32:35],a[136:139]
TR a[28:29],v5,33792
MC v[40:43],a[36:39],a[140:143]
s_waitcnt vmcnt(4)
buffer_load_dwordx4 v12, s[16:19], s41 offen offset:3072 nt lds
MC v[40:43],v[52:55],a[144:147]
s_add_u32 m0, s34, 71808
TR a[30:31],v5,34304
s_xor_b32 s41, s63, 196608
MC v[40:43],a[0:3],a[148:151]
TR a[32:33],v7,33792
MC v[40:43],a[4:7],a[152:155]
TR a[34:35],v7,34304
MC v[40:43],a[8:11],a[156:159]
TR a[36:37],v5,33824
s_nop 0
MC a[60:63],a[48:51],v[76:79]
TR a[38:39],v5,34336
s_nop 0
MC a[60:63],a[48:51],v[80:83]
LG 6
TR v[52:53],v7,33824
MC a[60:63],a[52:55],v[84:87]
TR v[54:55],v7,34336
MC a[60:63],a[52:55],v[88:91]
TR a[0:1],v4,33920
MC a[60:63],a[56:59],v[92:95]
TR a[2:3],v4,34432
MC a[60:63],a[56:59],a[44:47]
s_waitcnt vmcnt(4)
buffer_load_dwordx4 v12, s[16:19], s40 offen offset:0 nt lds
MC v[96:99],a[12:15],v[76:79]
s_add_u32 m0, s34, 71840
TR a[4:5],v6,33920
MC v[96:99],a[16:19],v[80:83]
TR a[6:7],v6,34432
MC v[104:107],a[16:19],v[88:91]
ds_write_b128 v16, v[72:75] offset:1024
MC v[104:107],a[12:15],v[84:87]
TR a[8:9],v4,33952
MC v[112:115],a[12:15],v[92:95]
LG 6
TR a[10:11],v4,34464
MC v[112:115],a[16:19],a[44:47]
TR a[12:13],v6,33952
MC v[100:103],a[20:23],v[76:79]
TR a[14:15],v6,34464
MC v[100:103],a[24:27],v[80:83]
v_exp_f32 v44, v44
MC v[108:111],a[24:27],v[88:91]
TR a[16:17],v5,33920
MC v[108:111],a[20:23],v[84:87]
s_waitcnt vmcnt(4)
buffer_load_dwordx4 v12, s[16:19], s40 offen offset:1024 nt lds
MC v[116:119],a[20:23],v[92:95]
s_add_u32 m0, s34, 71872
TR a[18:19],v5,34432
MC v[116:119],a[24:27],a[44:47]
TR a[20:21],v7,33920
MC v[120:123],a[28:31],v[76:79]
TR a[22:23],v7,34432
MC v[120:123],a[32:35],v[80:83]
TR a[24:25],v5,33952
MC v[128:131],a[32:35],v[88:91]
LG 5
TR a[26:27],v5,34464
MC v[128:131],a[28:31],v[84:87]
TR a[28:29],v7,33952
MC v[124:127],a[36:39],v[76:79]
TR a[30:31],v7,34464
MC v[124:127],v[52:55],v[80:83]
TR a[32:33],v4,34048
MC v[132:135],v[52:55],v[88:91]
TR a[34:35],v4,34560
MC v[132:135],a[36:39],v[84:87]
s_waitcnt vmcnt(4)
buffer_load_dwordx4 v12, s[16:19], s40 offen offset:2048 nt lds
MC v[136:139],a[0:3],v[76:79]
s_add_u32 m0, s34, 71904
TR a[36:37],v6,34048
MC v[136:139],a[4:7],v[80:83]
TR a[38:39],v6,34560
MC v[144:147],a[4:7],v[88:91]
v_exp_f32 v45, v45
MC v[144:147],a[0:3],v[84:87]
TR v[52:53],v4,34080
CV v60,v44,v45
MC v[152:155],a[0:3],v[92:95]
TR v[54:55],v4,34592
MC v[152:155],a[4:7],a[44:47]
LG 5
TR a[0:1],v6,34080
MC v[140:143],a[8:11],v[76:79]
TR a[2:3],v6,34592
MC v[140:143],a[12:15],v[80:83]
v_exp_f32 v46, v46
MC v[148:151],a[12:15],v[88:91]
TR a[4:5],v5,34048
MC v[148:151],a[8:11],v[84:87]
TR a[6:7],v5,34560
MC v[156:159],a[8:11],v[92:95]
s_waitcnt vmcnt(4)
buffer_load_dwordx4 v12, s[16:19], s40 offen offset:3072 nt lds
MC v[156:159],a[12:15],a[44:47]
s_add_u32 m0, s34, 0
TR a[8:9],v7,34048
s_xor_b32 s40, s63, 69632
MC v[160:163],a[16:19],v[76:79]
TR a[10:11],v7,34560
MC v[160:163],a[20:23],v[80:83]
TR a[12:13],v5,34080
MC v[168:171],a[20:23],v[88:91]
TR a[14:15],v5,34592
MC v[168:171],a[16:19],v[84:87]
TR a[16:17],v7,34080
MC v[164:167],a[24:27],v[76:79]
LG 6
TR a[18:19],v7,34592
MC v[164:167],a[28:31],v[80:83]
TR a[20:21],v4,34176
MC v[172:175],a[28:31],v[88:91]
TR a[22:23],v4,34688
MC v[172:175],a[24:27],v[84:87]
TR a[24:25],v6,34176
MC v[176:179],a[32:35],v[76:79]
s_waitcnt vmcnt(4)
buffer_load_dwordx4 v12, s[12:15], s41 offen offset:0 nt lds
MC v[176:179],a[36:39],v[80:83]
s_add_u32 m0, s34, 32
TR a[26:27],v6,34688
MC v[184:187],a[36:39],v[88:91]
v_exp_f32 v47, v47
MC v[184:187],a[32:35],v[84:87]
TR a[28:29],v4,34208
CV v61,v46,v47
MC v[192:195],a[32:35],v[92:95]
TR a[30:31],v4,34720
MC v[192:195],a[36:39],a[44:47]
TR a[32:33],v6,34208
MC v[180:183],v[52:55],v[76:79]
LG 5
TR a[34:35],v6,34720
MC v[180:183],a[0:3],v[80:83]
v_exp_f32 v48, v48
MC v[188:191],a[0:3],v[88:91]
TR a[36:37],v5,34176
MC v[188:191],v[52:55],v[84:87]
TR a[38:39],v5,34688
MC v[196:199],v[52:55],v[92:95]
s_waitcnt vmcnt(4)
buffer_load_dwordx4 v12, s[12:15], s41 offen offset:1024 nt lds
MC v[196:199],a[0:3],a[44:47]
s_add_u32 m0, s34, 64
TR v[52:53],v7,34176
MC v[200:203],a[4:7],v[76:79]
TR v[54:55],v7,34688
MC v[200:203],a[8:11],v[80:83]
TR a[0:1],v5,34208
MC v[208:211],a[8:11],v[88:91]
TR a[2:3],v5,34720
MC v[208:211],a[4:7],v[84:87]
TR a[4:5],v7,34208
MC v[204:207],a[12:15],v[76:79]
TR a[6:7],v7,34720
MC v[204:207],a[16:19],v[80:83]
v_exp_f32 v49, v49
MC v[212:215],a[16:19],v[88:91]
v_exp_f32 v50, v50
MC v[212:215],a[12:15],v[84:87]
v_exp_f32 v51, v51
MC v[216:219],a[20:23],v[76:79]
LG 4
CV v68,v48,v49
CV v69,v50,v51
MC v[216:219],a[24:27],v[80:83]
s_waitcnt vmcnt(4)
buffer_load_dwordx4 v12, s[12:15], s41 offen offset:2048 nt lds
MC v[224:227],a[24:27],v[88:91]
s_barrier
MC v[224:227],a[20:23],v[84:87]
s_add_u32 m0, s34, 96
RD a[8:11],v0,33792
MC v[232:235],a[20:23],v[92:95]
RD a[12:15],v1,33792
MC v[232:235],a[24:27],a[44:47]
RD a[16:19],v0,33920
MC v[220:223],a[28:31],v[76:79]
RD a[20:23],v1,33920
MC v[220:223],a[32:35],v[80:83]
RD a[24:27],v0,34048
MC v[228:231],a[32:35],v[88:91]
v_exp_f32 v36, v36
MC v[228:231],a[28:31],v[84:87]
v_exp_f32 v37, v37
MC v[236:239],a[28:31],v[92:95]
RD a[28:31],v1,34048
CV v62,v36,v37
MC v[236:239],a[32:35],a[44:47]
s_waitcnt vmcnt(4)
buffer_load_dwordx4 v12, s[12:15], s41 offen offset:3072 nt lds
MC v[240:243],a[36:39],v[76:79]
s_add_u32 m0, s34, 4224
RD a[32:35],v0,34176
s_xor_b32 s41, s63, 163840
MC v[240:243],v[52:55],v[80:83]
v_exp_f32 v38, v38
MC v[248:251],v[52:55],v[88:91]
v_exp_f32 v39, v39
MC v[248:251],a[36:39],v[84:87]
LG 2
RD a[36:39],v1,34176
CV v63,v38,v39
MC v[244:247],a[0:3],v[76:79]
v_exp_f32 v40, v40
MC v[244:247],a[4:7],v[80:83]
v_exp_f32 v41, v41
MC v[252:255],a[4:7],v[88:91]
v_exp_f32 v42, v42
MC v[252:255],a[0:3],v[84:87]
v_exp_f32 v43, v43
M v[44:47],a[8:11],a[64:67],v[32:35]
RD v[52:55],v0,34304
CV v70,v40,v41
MC v[44:47],a[12:15],a[68:71]
s_waitcnt vmcnt(4)
buffer_load_dwordx4 v12, s[12:15], s40 offen offset:0 nt lds
MC v[44:47],a[16:19],a[72:75]
s_add_u32 m0, s34, 4256
RD a[4:7],v0,34432
CV v71,v42,v43
MC v[44:47],a[20:23],a[76:79]
RD a[0:3],v1,34304
MC v[44:47],a[24:27],a[80:83]
LG 3
RD a[40:43],v17,1024
MC v[44:47],a[28:31],a[84:87]
MC v[44:47],a[32:35],a[88:91]
MC v[44:47],a[36:39],a[92:95]
s_nop 2
M v[48:51],a[8:11],a[96:99],v[24:27]
s_nop 2
MC v[48:51],a[12:15],a[100:103]
v_exp_f32 v44, v44
MC v[48:51],a[16:19],a[104:107]
v_exp_f32 v45, v45
MC v[48:51],a[20:23],a[108:111]
s_waitcnt vmcnt(4)
buffer_load_dwordx4 v12, s[12:15], s40 offen offset:1024 nt lds
MC v[48:51],a[24:27],a[112:115]
s_add_u32 m0, s34, 4288
v_exp_f32 v46, v46
MC v[48:51],a[28:31],a[116:119]
v_exp_f32 v47, v47
MC v[48:51],a[32:35],a[120:123]
CV v92,v44,v45
CV v93,v46,v47
MC v[48:51],a[36:39],a[124:127]
s_nop 2
M v[36:39],a[8:11],a[128:131],v[28:31]
RD a[8:11],v1,34432
s_nop 0
MC v[36:39],a[12:15],a[132:135]
RD a[12:15],v0,34560
MC v[36:39],a[16:19],a[136:139]
Y_pg10:
s_cbranch_execz Y_wr1
RD a[16:19],v1,34560
MC v[36:39],a[20:23],a[140:143]
RD a[20:23],v0,34688
MC v[36:39],a[24:27],a[144:147]
s_mov_b64 exec, 0
s_cmp_eq_u32 s32, 0
s_cbranch_scc1 Y_pg13
s_cmp_eq_u32 s32, 1
s_cbranch_scc1 Y_pg14
s_cmp_eq_u32 s32, 2
s_cbranch_scc1 Y_pg15
s_branch Y_pg16
Y_wr2:
s_mov_b64 exec, -1
RD a[24:27],v1,34688
MC v[36:39],a[28:31],a[148:151]
v_exp_f32 v48, v48
MC v[36:39],a[32:35],a[152:155]
s_waitcnt vmcnt(4)
buffer_load_dwordx4 v12, s[12:15], s40 offen offset:2048 nt lds
MC v[36:39],a[36:39],a[156:159]
LG 5
v_exp_f32 v49, v49
M v[40:43],v[52:55],a[64:67],v[32:35]
s_add_u32 m0, s34, 4320
v_exp_f32 v50, v50
MC v[40:43],a[0:3],a[68:71]
v_exp_f32 v51, v51
MC v[40:43],a[4:7],a[72:75]
LG 2
RD a[28:31],v2,33792
CV v76,v48,v49
MC v[40:43],a[8:11],a[76:79]
RD a[32:35],v3,33792
CV v77,v50,v51
MC v[40:43],a[12:15],a[80:83]
s_getpc_b64 s[54:55]
RD a[36:39],v2,33920
MC v[40:43],a[16:19],a[84:87]
LG 3
v_exp_f32 v36, v36
MC v[40:43],a[20:23],a[88:91]
global_load_dword v14, v23, s[54:55]
MC v[40:43],a[24:27],a[92:95]
v_exp_f32 v37, v37
M v[44:47],v[52:55],a[96:99],v[24:27]
v_exp_f32 v38, v38
MC v[44:47],a[0:3],a[100:103]
v_exp_f32 v39, v39
MC v[44:47],a[4:7],a[104:107]
s_waitcnt vmcnt(5)
buffer_load_dwordx4 v12, s[12:15], s40 offen offset:3072 nt lds
MC v[44:47],a[8:11],a[108:111]
s_add_u32 m0, s34, 101376
v_exp_f32 v40, v40
MC v[44:47],a[12:15],a[112:115]
s_xor_b32 s40, s63, 36864
CV v84,v36,v37
CV v85,v38,v39
MC v[44:47],a[16:19],a[116:119]
v_exp_f32 v41, v41
MC v[44:47],a[20:23],a[120:123]
v_exp_f32 v42, v42
MC v[44:47],a[24:27],a[124:127]
v_exp_f32 v43, v43
M v[48:51],v[52:55],a[128:131],v[28:31]
RD v[52:55],v3,33920
CV v94,v40,v41
MC v[48:51],a[0:3],a[132:135]
RD a[0:3],v2,34048
CV v95,v42,v43
MC v[48:51],a[4:7],a[136:139]
RD a[4:7],v3,34048
v_lshrrev_b32 v23, 9, v15
MC v[48:51],a[8:11],a[140:143]
RD a[8:11],v2,34176
v_lshlrev_b32 v23, 7, v23
MC v[48:51],a[12:15],a[144:147]
s_waitcnt vmcnt(5)
buffer_load_dwordx4 v12, s[16:19], s41 offen offset:0 nt lds
MC v[48:51],a[16:19],a[148:151]
s_add_u32 m0, s34, 101408
RD a[12:15],v3,34176
v_add_u32 v23, 27000, v23
MC v[48:51],a[20:23],a[152:155]
v_exp_f32 v44, v44
MC v[48:51],a[24:27],a[156:159]
LG 5
v_exp_f32 v45, v45
M v[36:39],a[28:31],a[96:99],v[24:27]
v_exp_f32 v46, v46
MC v[36:39],a[32:35],a[100:103]
v_exp_f32 v47, v47
MC v[36:39],a[36:39],a[104:107]
LG 2
RD a[16:19],v2,34304
CV v78,v44,v45
MC v[36:39],v[52:55],a[108:111]
RD a[20:23],v3,34304
CV v79,v46,v47
MC v[36:39],a[0:3],a[112:115]
RD a[24:27],v2,34432
MC v[36:39],a[4:7],a[116:119]
s_waitcnt vmcnt(5) lgkmcnt(3)
buffer_load_dwordx4 v12, s[16:19], s41 offen offset:1024 nt lds
MC v[36:39],a[8:11],a[120:123]
s_add_u32 m0, s34, 101440
v_exp_f32 v48, v48
MC v[36:39],a[12:15],a[124:127]
v_exp_f32 v49, v49
M v[40:43],a[28:31],a[128:131],v[28:31]
RD a[28:31],v3,34432
CV v86,v48,v49
MC v[40:43],a[32:35],a[132:135]
RD a[32:35],v2,34560
s_nop 0
MC v[40:43],a[36:39],a[136:139]
RD a[36:39],v3,34560
MC v[40:43],v[52:55],a[140:143]
RD v[52:55],v2,34688
MC v[40:43],a[0:3],a[144:147]
RD a[0:3],v3,34688
MC v[40:43],a[4:7],a[148:151]
v_exp_f32 v50, v50
MC v[40:43],a[8:11],a[152:155]
v_exp_f32 v51, v51
MC v[40:43],a[12:15],a[156:159]
s_waitcnt vmcnt(5) lgkmcnt(5)
buffer_load_dwordx4 v12, s[16:19], s41 offen offset:2048 nt lds
M v[44:47],a[16:19],a[96:99],v[24:27]
s_add_u32 m0, s34, 101472
CV v87,v50,v51
s_nop 0
MC v[44:47],a[20:23],a[100:103]
s_barrier
MC v[44:47],a[24:27],a[104:107]
LG 2
TR a[4:5],v4,0
MC v[44:47],a[28:31],a[108:111]
TR a[6:7],v4,512
MC v[44:47],a[32:35],a[112:115]
TR a[8:9],v6,0
MC v[44:47],a[36:39],a[116:119]
LG 3
TR a[10:11],v6,512
MC v[44:47],v[52:55],a[120:123]
TR a[12:13],v4,32
MC v[44:47],a[0:3],a[124:127]
TR a[14:15],v4,544
s_nop 0
M v[48:51],a[16:19],a[128:131],v[28:31]
TR a[16:17],v6,32
s_nop 0
MC v[48:51],a[20:23],a[132:135]
s_waitcnt vmcnt(5)
buffer_load_dwordx4 v12, s[16:19], s41 offen offset:3072 nt lds
MC v[48:51],a[24:27],a[136:139]
s_add_u32 m0, s34, 105600
TR a[18:19],v6,544
s_xor_b32 s41, s63, 229376
MC v[48:51],a[28:31],a[140:143]
TR a[20:21],v5,0
MC v[48:51],a[32:35],a[144:147]
TR a[22:23],v5,512
MC v[48:51],a[36:39],a[148:151]
TR a[24:25],v7,0
MC v[48:51],v[52:55],a[152:155]
TR a[26:27],v7,512
MC v[48:51],a[0:3],a[156:159]
TR a[28:29],v5,32
s_nop 0
MC a[60:63],a[48:51],v[56:59]
TR a[30:31],v5,544
s_nop 0
MC a[60:63],a[48:51],v[60:63]
LG 7
TR a[32:33],v7,32
MC a[60:63],a[52:55],v[64:67]
TR a[34:35],v7,544
MC a[60:63],a[52:55],v[68:71]
s_waitcnt vmcnt(4)
buffer_load_dwordx4 v12, s[16:19], s40 offen offset:0 nt lds
MC a[60:63],a[56:59],v[72:75]
s_add_u32 m0, s34, 105632
TR a[36:37],v4,128
MC a[60:63],a[56:59],a[40:43]
TR a[38:39],v4,640
MC v[96:99],a[4:7],v[56:59]
TR v[52:53],v6,128
MC v[96:99],a[8:11],v[60:63]
TR v[54:55],v6,640
MC v[104:107],a[8:11],v[68:71]
ds_write_b128 v16, v[92:95] offset:0
MC v[104:107],a[4:7],v[64:67]
LG 6
TR a[0:1],v4,160
MC v[112:115],a[4:7],v[72:75]
TR a[2:3],v4,672
MC v[112:115],a[8:11],a[40:43]
TR a[4:5],v6,160
MC v[100:103],a[12:15],v[56:59]
TR a[6:7],v6,672
MC v[100:103],a[16:19],v[60:63]
TR a[8:9],v5,128
MC v[108:111],a[16:19],v[68:71]
s_waitcnt vmcnt(4)
buffer_load_dwordx4 v12, s[16:19], s40 offen offset:1024 nt lds
MC v[108:111],a[12:15],v[64:67]
s_add_u32 m0, s34, 105664
TR a[10:11],v5,640
MC v[116:119],a[12:15],v[72:75]
TR a[12:13],v7,128
MC v[116:119],a[16:19],a[40:43]
TR a[14:15],v7,640
MC v[120:123],a[20:23],v[56:59]
LG 6
TR a[16:17],v5,160
MC v[120:123],a[24:27],v[60:63]
TR a[18:19],v5,672
MC v[128:131],a[24:27],v[68:71]
TR a[24:25],v4,256
MC v[128:131],a[20:23],v[64:67]
TR a[20:21],v7,160
MC v[124:127],a[28:31],v[56:59]
TR a[22:23],v7,672
MC v[124:127],a[32:35],v[60:63]
TR a[26:27],v4,768
MC v[132:135],a[32:35],v[68:71]
s_waitcnt vmcnt(4)
buffer_load_dwordx4 v12, s[16:19], s40 offen offset:2048 nt lds
MC v[132:135],a[28:31],v[64:67]
s_add_u32 m0, s34, 105696
TR a[28:29],v6,256
MC v[136:139],a[36:39],v[56:59]
TR a[30:31],v6,768
MC v[136:139],v[52:55],v[60:63]
v_exp_f32 v36, v36
MC v[144:147],v[52:55],v[68:71]
v_exp_f32 v37, v37
MC v[144:147],a[36:39],v[64:67]
LG 4
TR a[32:33],v4,288
CV v80,v36,v37
MC v[152:155],a[36:39],v[72:75]
TR a[34:35],v4,800
MC v[152:155],v[52:55],a[40:43]
TR a[36:37],v6,288
MC v[140:143],a[0:3],v[56:59]
TR a[38:39],v6,800
MC v[140:143],a[4:7],v[60:63]
TR v[52:53],v5,256
MC v[148:151],a[4:7],v[68:71]
s_waitcnt vmcnt(4)
buffer_load_dwordx4 v12, s[16:19], s40 offen offset:3072 nt lds
MC v[148:151],a[0:3],v[64:67]
s_add_u32 m0, s34, 33792
TR v[54:55],v5,768
s_xor_b32 s40, s63, 102400
MC v[156:159],a[0:3],v[72:75]
TR a[0:1],v7,256
MC v[156:159],a[4:7],a[40:43]
TR a[2:3],v7,768
MC v[160:163],a[8:11],v[56:59]
TR a[4:5],v5,288
MC v[160:163],a[12:15],v[60:63]
TR a[6:7],v5,800
MC v[168:171],a[12:15],v[68:71]
LG 6
TR a[12:13],v4,384
MC v[168:171],a[8:11],v[64:67]
TR a[8:9],v7,288
MC v[164:167],a[16:19],v[56:59]
TR a[10:11],v7,800
MC v[164:167],a[20:23],v[60:63]
TR a[14:15],v4,896
MC v[172:175],a[20:23],v[68:71]
s_waitcnt vmcnt(4)
buffer_load_dwordx4 v12, s[12:15], s41 offen offset:0 nt lds
MC v[172:175],a[16:19],v[64:67]
s_add_u32 m0, s34, 33824
TR a[16:17],v6,384
MC v[176:179],a[24:27],v[56:59]
TR a[18:19],v6,896
MC v[176:179],a[28:31],v[60:63]
v_exp_f32 v38, v38
MC v[184:187],a[28:31],v[68:71]
v_exp_f32 v39, v39
MC v[184:187],a[24:27],v[64:67]
TR a[20:21],v4,416
CV v81,v38,v39
MC v[192:195],a[24:27],v[72:75]
TR a[22:23],v4,928
MC v[192:195],a[28:31],a[40:43]
LG 4
TR a[24:25],v6,416
MC v[180:183],a[32:35],v[56:59]
TR a[26:27],v6,928
MC v[180:183],a[36:39],v[60:63]
v_exp_f32 v40, v40
MC v[188:191],a[36:39],v[68:71]
TR a[28:29],v5,384
MC v[188:191],a[32:35],v[64:67]
s_waitcnt vmcnt(4)
buffer_load_dwordx4 v12, s[12:15], s41 offen offset:1024 nt lds
MC v[196:199],a[32:35],v[72:75]
s_add_u32 m0, s34, 33856
TR a[30:31],v5,896
MC v[196:199],a[36:39],a[40:43]
TR a[32:33],v7,384
MC v[200:203],v[52:55],v[56:59]
TR a[34:35],v7,896
MC v[200:203],a[0:3],v[60:63]
TR a[36:37],v5,416
MC v[208:211],a[0:3],v[68:71]
TR a[38:39],v5,928
MC v[208:211],v[52:55],v[64:67]
TR v[52:53],v7,416
MC v[204:207],a[4:7],v[56:59]
TR v[54:55],v7,928
MC v[204:207],a[8:11],v[60:63]
v_exp_f32 v41, v41
MC v[212:215],a[8:11],v[68:71]
v_exp_f32 v42, v42
MC v[212:215],a[4:7],v[64:67]
s_waitcnt vmcnt(4)
buffer_load_dwordx4 v12, s[12:15], s41 offen offset:2048 nt lds
MC v[216:219],a[12:15],v[56:59]
LG 4
v_exp_f32 v43, v43
MC v[216:219],a[16:19],v[60:63]
s_barrier
CV v88,v40,v41
CV v89,v42,v43
MC v[224:227],a[16:19],v[68:71]
s_add_u32 m0, s34, 33888
RD a[0:3],v0,0
MC v[224:227],a[12:15],v[64:67]
RD a[4:7],v1,0
MC v[232:235],a[12:15],v[72:75]
RD a[8:11],v0,128
MC v[232:235],a[16:19],a[40:43]
RD a[12:15],v1,128
MC v[220:223],a[20:23],v[56:59]
RD a[16:19],v0,256
MC v[220:223],a[24:27],v[60:63]
v_exp_f32 v44, v44
MC v[228:231],a[24:27],v[68:71]
v_exp_f32 v45, v45
MC v[228:231],a[20:23],v[64:67]
s_waitcnt vmcnt(4)
buffer_load_dwordx4 v12, s[12:15], s41 offen offset:3072 nt lds
MC v[236:239],a[20:23],v[72:75]
s_add_u32 m0, s34, 38016
RD a[20:23],v1,256
CV v82,v44,v45
MC v[236:239],a[24:27],a[40:43]
s_xor_b32 s41, s63, 196608
RD a[24:27],v0,384
MC v[240:243],a[28:31],v[56:59]
v_exp_f32 v46, v46
MC v[240:243],a[32:35],v[60:63]
v_exp_f32 v47, v47
MC v[248:251],a[32:35],v[68:71]
v_exp_f32 v48, v48
MC v[248:251],a[28:31],v[64:67]
LG 2
RD a[28:31],v1,384
CV v83,v46,v47
MC v[244:247],a[36:39],v[56:59]
v_exp_f32 v49, v49
MC v[244:247],v[52:55],v[60:63]
v_exp_f32 v50, v50
MC v[252:255],v[52:55],v[68:71]
v_exp_f32 v51, v51
MC v[252:255],a[36:39],v[64:67]
RD a[32:35],v0,512
CV v90,v48,v49
M v[36:39],a[0:3],a[64:67],v[32:35]
s_waitcnt vmcnt(4)
buffer_load_dwordx4 v12, s[12:15], s40 offen offset:0 nt lds
MC v[36:39],a[4:7],a[68:71]
s_add_u32 m0, s34, 38048
RD v[52:55],v0,640
CV v91,v50,v51
MC v[36:39],a[8:11],a[72:75]
RD a[36:39],v1,512
MC v[36:39],a[12:15],a[76:79]
RD a[44:47],v17,0
MC v[36:39],a[16:19],a[80:83]
LG 4
MC v[36:39],a[20:23],a[84:87]
MC v[36:39],a[24:27],a[88:91]
MC v[36:39],a[28:31],a[92:95]
s_nop 2
M v[40:43],a[0:3],a[96:99],v[24:27]
s_nop 2
MC v[40:43],a[4:7],a[100:103]
v_exp_f32 v36, v36
MC v[40:43],a[8:11],a[104:107]
s_waitcnt vmcnt(4)
buffer_load_dwordx4 v12, s[12:15], s40 offen offset:1024 nt lds
MC v[40:43],a[12:15],a[108:111]
s_add_u32 m0, s34, 38080
v_exp_f32 v37, v37
MC v[40:43],a[16:19],a[112:115]
v_exp_f32 v38, v38
MC v[40:43],a[20:23],a[116:119]
v_exp_f32 v39, v39
MC v[40:43],a[24:27],a[120:123]
CV v72,v36,v37
CV v73,v38,v39
MC v[40:43],a[28:31],a[124:127]
s_nop 2
M v[44:47],a[0:3],a[128:131],v[28:31]
RD a[0:3],v1,640
s_nop 0
MC v[44:47],a[4:7],a[132:135]
RD a[4:7],v0,768
MC v[44:47],a[8:11],a[136:139]
RD a[8:11],v1,768
MC v[44:47],a[12:15],a[140:143]
RD a[12:15],v0,896
MC v[44:47],a[16:19],a[144:147]
RD a[16:19],v1,896
MC v[44:47],a[20:23],a[148:151]
s_waitcnt vmcnt(4)
buffer_load_dwordx4 v12, s[12:15], s40 offen offset:2048 nt lds
MC v[44:47],a[24:27],a[152:155]
s_add_u32 m0, s34, 38112
v_exp_f32 v40, v40
MC v[44:47],a[28:31],a[156:159]
LG 5
v_exp_f32 v41, v41
M v[48:51],a[32:35],a[64:67],v[32:35]
v_exp_f32 v42, v42
MC v[48:51],a[36:39],a[68:71]
v_exp_f32 v43, v43
MC v[48:51],v[52:55],a[72:75]
LG 2
RD a[20:23],v2,0
CV v56,v40,v41
MC v[48:51],a[0:3],a[76:79]
RD a[24:27],v3,0
CV v57,v42,v43
MC v[48:51],a[4:7],a[80:83]
RD a[28:31],v2,128
MC v[48:51],a[8:11],a[84:87]
LG 3
v_exp_f32 v44, v44
MC v[48:51],a[12:15],a[88:91]
s_waitcnt vmcnt(4)
buffer_load_dwordx4 v12, s[12:15], s40 offen offset:3072 nt lds
MC v[48:51],a[16:19],a[92:95]
s_add_u32 m0, s34, 67584
v_exp_f32 v45, v45
M v[36:39],a[32:35],a[96:99],v[24:27]
s_xor_b32 s40, s63, 69632
v_exp_f32 v46, v46
MC v[36:39],a[36:39],a[100:103]
v_exp_f32 v47, v47
MC v[36:39],v[52:55],a[104:107]
v_exp_f32 v48, v48
MC v[36:39],a[0:3],a[108:111]
v_exp_f32 v49, v49
MC v[36:39],a[4:7],a[112:115]
CV v64,v44,v45
CV v65,v46,v47
MC v[36:39],a[8:11],a[116:119]
v_exp_f32 v50, v50
MC v[36:39],a[12:15],a[120:123]
v_exp_f32 v51, v51
MC v[36:39],a[16:19],a[124:127]
CV v74,v48,v49
CV v75,v50,v51
M v[40:43],a[32:35],a[128:131],v[28:31]
RD a[32:35],v3,128
s_nop 0
MC v[40:43],a[36:39],a[132:135]
RD a[36:39],v2,256
MC v[40:43],v[52:55],a[136:139]
RD v[52:55],v3,256
MC v[40:43],a[0:3],a[140:143]
s_waitcnt vmcnt(4)
buffer_load_dwordx4 v12, s[16:19], s41 offen offset:0 nt lds
MC v[40:43],a[4:7],a[144:147]
s_add_u32 m0, s34, 67616
RD a[0:3],v2,384
MC v[40:43],a[8:11],a[148:151]
RD a[4:7],v3,384
MC v[40:43],a[12:15],a[152:155]
v_exp_f32 v36, v36
MC v[40:43],a[16:19],a[156:159]
LG 5
v_exp_f32 v37, v37
M v[44:47],a[20:23],a[96:99],v[24:27]
v_exp_f32 v38, v38
MC v[44:47],a[24:27],a[100:103]
v_exp_f32 v39, v39
MC v[44:47],a[28:31],a[104:107]
LG 2
RD a[8:11],v2,512
CV v58,v36,v37
MC v[44:47],a[32:35],a[108:111]
s_waitcnt vmcnt(4)
buffer_load_dwordx4 v12, s[16:19], s41 offen offset:1024 nt lds
MC v[44:47],a[36:39],a[112:115]
s_add_u32 m0, s34, 67648
RD a[12:15],v3,512
CV v59,v38,v39
MC v[44:47],v[52:55],a[116:119]
LG 2
RD a[16:19],v2,640
MC v[44:47],a[0:3],a[120:123]
v_exp_f32 v40, v40
MC v[44:47],a[4:7],a[124:127]
v_exp_f32 v41, v41
M v[48:51],a[20:23],a[128:131],v[28:31]
RD a[20:23],v3,640
CV v66,v40,v41
MC v[48:51],a[24:27],a[132:135]
RD a[24:27],v2,768
s_nop 0
MC v[48:51],a[28:31],a[136:139]
RD a[28:31],v3,768
MC v[48:51],a[32:35],a[140:143]
RD a[32:35],v2,896
MC v[48:51],a[36:39],a[144:147]
RD a[36:39],v3,896
MC v[48:51],v[52:55],a[148:151]
s_waitcnt vmcnt(4)
buffer_load_dwordx4 v12, s[16:19], s41 offen offset:2048 nt lds
MC v[48:51],a[0:3],a[152:155]
s_add_u32 m0, s34, 67680
v_exp_f32 v42, v42
MC v[48:51],a[4:7],a[156:159]
LG 5
v_exp_f32 v43, v43
M v[36:39],a[8:11],a[96:99],v[24:27]
CV v67,v42,v43
s_nop 0
MC v[36:39],a[12:15],a[100:103]
s_barrier
MC v[36:39],a[16:19],a[104:107]
LG 2
TR v[52:53],v4,33792
MC v[36:39],a[20:23],a[108:111]
TR v[54:55],v4,34304
MC v[36:39],a[24:27],a[112:115]
TR a[0:1],v6,33792
MC v[36:39],a[28:31],a[116:119]
LG 3
TR a[2:3],v6,34304
MC v[36:39],a[32:35],a[120:123]
ds_write_b128 v16, v[72:75] offset:1024
MC v[36:39],a[36:39],a[124:127]
TR a[4:5],v4,33824
s_nop 0
M v[40:43],a[8:11],a[128:131],v[28:31]
s_waitcnt vmcnt(4)
buffer_load_dwordx4 v12, s[16:19], s41 offen offset:3072 nt lds
MC v[40:43],a[12:15],a[132:135]
s_add_u32 m0, s34, 71808
TR a[6:7],v4,34336
s_xor_b32 s41, s63, 262144
MC v[40:43],a[16:19],a[136:139]
TR a[8:9],v6,33824
MC v[40:43],a[20:23],a[140:143]
TR a[10:11],v6,34336
MC v[40:43],a[24:27],a[144:147]
TR a[12:13],v5,33792
MC v[40:43],a[28:31],a[148:151]
TR a[14:15],v5,34304
MC v[40:43],a[32:35],a[152:155]
TR a[16:17],v7,33792
MC v[40:43],a[36:39],a[156:159]
TR a[18:19],v7,34304
s_nop 0
MC a[60:63],a[48:51],v[76:79]
TR a[20:21],v5,33824
s_nop 0
MC a[60:63],a[48:51],v[80:83]
LG 7
TR a[22:23],v5,34336
MC a[60:63],a[52:55],v[84:87]
s_waitcnt vmcnt(4)
buffer_load_dwordx4 v12, s[16:19], s40 offen offset:0 nt lds
MC a[60:63],a[52:55],v[88:91]
Y_pg11:
s_cbranch_execz Y_wr1
s_add_u32 m0, s34, 71840
TR a[24:25],v7,33824
MC a[60:63],a[56:59],v[92:95]
TR a[26:27],v7,34336
MC a[60:63],a[56:59],a[44:47]
TR a[28:29],v4,33920
MC v[96:99],v[52:55],v[76:79]
TR a[30:31],v4,34432
MC v[96:99],a[0:3],v[80:83]
TR a[32:33],v6,33920
MC v[104:107],a[0:3],v[88:91]
TR a[34:35],v6,34432
MC v[104:107],v[52:55],v[84:87]
v_exp_f32 v44, v44
MC v[112:115],v[52:55],v[92:95]
v_exp_f32 v45, v45
MC v[112:115],a[0:3],a[44:47]
LG 5
TR a[36:37],v4,33952
CV v60,v44,v45
MC v[100:103],a[4:7],v[76:79]
s_waitcnt vmcnt(4)
buffer_load_dwordx4 v12, s[16:19], s40 offen offset:1024 nt lds
MC v[100:103],a[8:11],v[80:83]
s_add_u32 m0, s34, 71872
TR a[38:39],v4,34464
MC v[108:111],a[8:11],v[88:91]
TR v[52:53],v6,33952
MC v[108:111],a[4:7],v[84:87]
TR v[54:55],v6,34464
MC v[116:119],a[4:7],v[92:95]
TR a[0:1],v5,33920
MC v[116:119],a[8:11],a[44:47]
TR a[2:3],v5,34432
MC v[120:123],a[12:15],v[76:79]
TR a[4:5],v7,33920
MC v[120:123],a[16:19],v[80:83]
TR a[6:7],v7,34432
MC v[128:131],a[16:19],v[88:91]
TR a[8:9],v5,33952
MC v[128:131],a[12:15],v[84:87]
LG 7
TR a[10:11],v5,34464
MC v[124:127],a[20:23],v[76:79]
s_waitcnt vmcnt(4)
buffer_load_dwordx4 v12, s[16:19], s40 offen offset:2048 nt lds
MC v[124:127],a[24:27],v[80:83]
s_add_u32 m0, s34, 71904
TR a[16:17],v4,34048
MC v[132:135],a[24:27],v[88:91]
TR a[12:13],v7,33952
MC v[132:135],a[20:23],v[84:87]
TR a[14:15],v7,34464
MC v[136:139],a[28:31],v[76:79]
TR a[18:19],v4,34560
MC v[136:139],a[32:35],v[80:83]
TR a[20:21],v6,34048
MC v[144:147],a[32:35],v[88:91]
TR a[22:23],v6,34560
MC v[144:147],a[28:31],v[84:87]
v_exp_f32 v46, v46
MC v[152:155],a[28:31],v[92:95]
v_exp_f32 v47, v47
MC v[152:155],a[32:35],a[44:47]
LG 5
TR a[24:25],v4,34080
CV v61,v46,v47
MC v[140:143],a[36:39],v[76:79]
TR a[26:27],v4,34592
MC v[140:143],v[52:55],v[80:83]
s_waitcnt vmcnt(4)
buffer_load_dwordx4 v12, s[16:19], s40 offen offset:3072 nt lds
MC v[148:151],v[52:55],v[88:91]
s_add_u32 m0, s34, 0
TR a[28:29],v6,34080
s_xor_b32 s40, s63, 397312
MC v[148:151],a[36:39],v[84:87]
TR a[30:31],v6,34592
MC v[156:159],a[36:39],v[92:95]
TR a[32:33],v5,34048
MC v[156:159],v[52:55],a[44:47]
TR a[34:35],v5,34560
MC v[160:163],a[0:3],v[76:79]
TR a[36:37],v7,34048
MC v[160:163],a[4:7],v[80:83]
TR a[38:39],v7,34560
MC v[168:171],a[4:7],v[88:91]
TR v[52:53],v5,34080
MC v[168:171],a[0:3],v[84:87]
LG 7
TR v[54:55],v5,34592
MC v[164:167],a[8:11],v[76:79]
TR a[4:5],v4,34176
MC v[164:167],a[12:15],v[80:83]
s_waitcnt vmcnt(4)
buffer_load_dwordx4 v12, s[12:15], s41 offen offset:0 nt lds
MC v[172:175],a[12:15],v[88:91]
s_add_u32 m0, s34, 32
TR a[0:1],v7,34080
MC v[172:175],a[8:11],v[84:87]
TR a[2:3],v7,34592
MC v[176:179],a[16:19],v[76:79]
TR a[6:7],v4,34688
MC v[176:179],a[20:23],v[80:83]
TR a[8:9],v6,34176
MC v[184:187],a[20:23],v[88:91]
TR a[10:11],v6,34688
MC v[184:187],a[16:19],v[84:87]
v_exp_f32 v48, v48
MC v[192:195],a[16:19],v[92:95]
v_exp_f32 v49, v49
MC v[192:195],a[20:23],a[44:47]
LG 5
TR a[12:13],v4,34208
CV v68,v48,v49
MC v[180:183],a[24:27],v[76:79]
TR a[14:15],v4,34720
MC v[180:183],a[28:31],v[80:83]
s_waitcnt vmcnt(4)
buffer_load_dwordx4 v12, s[12:15], s41 offen offset:1024 nt lds
MC v[188:191],a[28:31],v[88:91]
s_add_u32 m0, s34, 64
TR a[16:17],v6,34208
MC v[188:191],a[24:27],v[84:87]
TR a[18:19],v6,34720
MC v[196:199],a[24:27],v[92:95]
v_exp_f32 v50, v50
MC v[196:199],a[28:31],a[44:47]
TR a[20:21],v5,34176
MC v[200:203],a[32:35],v[76:79]
TR a[22:23],v5,34688
MC v[200:203],a[36:39],v[80:83]
TR a[24:25],v7,34176
MC v[208:211],a[36:39],v[88:91]
TR a[26:27],v7,34688
MC v[208:211],a[32:35],v[84:87]
TR a[28:29],v5,34208
MC v[204:207],v[52:55],v[76:79]
LG 6
TR a[30:31],v5,34720
MC v[204:207],a[0:3],v[80:83]
TR a[32:33],v7,34208
MC v[212:215],a[0:3],v[88:91]
s_waitcnt vmcnt(4)
buffer_load_dwordx4 v12, s[12:15], s41 offen offset:2048 nt lds
MC v[212:215],v[52:55],v[84:87]
s_add_u32 m0, s34, 96
TR a[34:35],v7,34720
MC v[216:219],a[4:7],v[76:79]
v_exp_f32 v51, v51
MC v[216:219],a[8:11],v[80:83]
s_barrier
CV v69,v50,v51
MC v[224:227],a[8:11],v[88:91]
RD a[36:39],v0,33792
MC v[224:227],a[4:7],v[84:87]
RD v[52:55],v1,33792
MC v[232:235],a[4:7],v[92:95]
RD a[0:3],v0,33920
MC v[232:235],a[8:11],a[44:47]
RD a[4:7],v1,33920
MC v[220:223],a[12:15],v[76:79]
LG 5
RD a[8:11],v0,34048
MC v[220:223],a[16:19],v[80:83]
v_exp_f32 v36, v36
MC v[228:231],a[16:19],v[88:91]
s_waitcnt vmcnt(4)
buffer_load_dwordx4 v12, s[12:15], s41 offen offset:3072 nt lds
MC v[228:231],a[12:15],v[84:87]
s_add_u32 m0, s34, 4224
v_exp_f32 v37, v37
MC v[236:239],a[12:15],v[92:95]
s_xor_b32 s41, s63, 229376
RD a[12:15],v1,34048
CV v62,v36,v37
MC v[236:239],a[16:19],a[44:47]
RD a[16:19],v0,34176
MC v[240:243],a[20:23],v[76:79]
v_exp_f32 v38, v38
MC v[240:243],a[24:27],v[80:83]
v_exp_f32 v39, v39
MC v[248:251],a[24:27],v[88:91]
v_exp_f32 v40, v40
MC v[248:251],a[20:23],v[84:87]
RD a[20:23],v1,34176
CV v63,v38,v39
MC v[244:247],a[28:31],v[76:79]
LG 3
v_exp_f32 v41, v41
MC v[244:247],a[32:35],v[80:83]
v_exp_f32 v42, v42
MC v[252:255],a[32:35],v[88:91]
s_waitcnt vmcnt(4)
buffer_load_dwordx4 v12, s[12:15], s40 offen offset:0 nt lds
MC v[252:255],a[28:31],v[84:87]
s_add_u32 m0, s34, 4256
v_exp_f32 v43, v43
M v[44:47],a[36:39],a[64:67],v[32:35]
RD a[24:27],v0,34304
CV v70,v40,v41
MC v[44:47],v[52:55],a[68:71]
RD a[32:35],v0,34432
CV v71,v42,v43
MC v[44:47],a[0:3],a[72:75]
RD a[28:31],v1,34304
MC v[44:47],a[4:7],a[76:79]
RD a[40:43],v17,1024
MC v[44:47],a[8:11],a[80:83]
LG 4
MC v[44:47],a[12:15],a[84:87]
MC v[44:47],a[16:19],a[88:91]
MC v[44:47],a[20:23],a[92:95]
s_nop 2
M v[48:51],a[36:39],a[96:99],v[24:27]
s_waitcnt vmcnt(4)
buffer_load_dwordx4 v12, s[12:15], s40 offen offset:1024 nt lds
MC v[48:51],v[52:55],a[100:103]
s_add_u32 m0, s34, 4288
MC v[48:51],a[0:3],a[104:107]
v_exp_f32 v44, v44
MC v[48:51],a[4:7],a[108:111]
v_exp_f32 v45, v45
MC v[48:51],a[8:11],a[112:115]
v_exp_f32 v46, v46
MC v[48:51],a[12:15],a[116:119]
v_exp_f32 v47, v47
MC v[48:51],a[16:19],a[120:123]
CV v92,v44,v45
CV v93,v46,v47
MC v[48:51],a[20:23],a[124:127]
s_nop 2
M v[36:39],a[36:39],a[128:131],v[28:31]
RD a[36:39],v1,34432
s_nop 0
MC v[36:39],v[52:55],a[132:135]
RD v[52:55],v0,34560
MC v[36:39],a[0:3],a[136:139]
RD a[0:3],v1,34560
MC v[36:39],a[4:7],a[140:143]
RD a[4:7],v0,34688
MC v[36:39],a[8:11],a[144:147]
RD a[8:11],v1,34688
MC v[36:39],a[12:15],a[148:151]
s_waitcnt vmcnt(4)
buffer_load_dwordx4 v12, s[12:15], s40 offen offset:2048 nt lds
MC v[36:39],a[16:19],a[152:155]
s_add_u32 m0, s34, 4320
v_exp_f32 v48, v48
MC v[36:39],a[20:23],a[156:159]
LG 5
v_exp_f32 v49, v49
M v[40:43],a[24:27],a[64:67],v[32:35]
v_exp_f32 v50, v50
MC v[40:43],a[28:31],a[68:71]
v_exp_f32 v51, v51
MC v[40:43],a[32:35],a[72:75]
LG 2
RD a[12:15],v2,33792
CV v76,v48,v49
MC v[40:43],a[36:39],a[76:79]
RD a[16:19],v3,33792
CV v77,v50,v51
MC v[40:43],v[52:55],a[80:83]
s_getpc_b64 s[54:55]
RD a[20:23],v2,33920
MC v[40:43],a[0:3],a[84:87]
s_waitcnt vmcnt(4) lgkmcnt(3)
buffer_load_dwordx4 v12, s[12:15], s40 offen offset:3072 nt lds
MC v[40:43],a[4:7],a[88:91]
s_add_u32 m0, s34, 101376
v_exp_f32 v36, v36
MC v[40:43],a[8:11],a[92:95]
s_xor_b32 s40, s63, 102400
v_exp_f32 v37, v37
M v[44:47],a[24:27],a[96:99],v[24:27]
v_exp_f32 v38, v38
MC v[44:47],a[28:31],a[100:103]
global_load_dword v14, v23, s[54:55]
MC v[44:47],a[32:35],a[104:107]
v_exp_f32 v39, v39
MC v[44:47],a[36:39],a[108:111]
v_exp_f32 v40, v40
MC v[44:47],v[52:55],a[112:115]
v_exp_f32 v41, v41
MC v[44:47],a[0:3],a[116:119]
v_exp_f32 v42, v42
MC v[44:47],a[4:7],a[120:123]
CV v84,v36,v37
CV v85,v38,v39
MC v[44:47],a[8:11],a[124:127]
s_waitcnt vmcnt(5)
buffer_load_dwordx4 v12, s[16:19], s41 offen offset:0 nt lds
M v[48:51],a[24:27],a[128:131],v[28:31]
s_add_u32 m0, s34, 101408
RD a[24:27],v3,33920
CV v94,v40,v41
MC v[48:51],a[28:31],a[132:135]
RD a[28:31],v2,34048
MC v[48:51],a[32:35],a[136:139]
RD a[32:35],v3,34048
MC v[48:51],a[36:39],a[140:143]
RD a[36:39],v2,34176
MC v[48:51],v[52:55],a[144:147]
RD v[52:55],v3,34176
MC v[48:51],a[0:3],a[148:151]
v_exp_f32 v43, v43
MC v[48:51],a[4:7],a[152:155]
RD a[0:3],v2,34304
CV v95,v42,v43
MC v[48:51],a[8:11],a[156:159]
LG 6
ds_write_b128 v16, v[92:95] offset:0
M v[36:39],a[12:15],a[96:99],v[24:27]
v_exp_f32 v44, v44
MC v[36:39],a[16:19],a[100:103]
v_exp_f32 v45, v45
MC v[36:39],a[20:23],a[104:107]
LG 4
v_exp_f32 v46, v46
MC v[36:39],a[24:27],a[108:111]
s_waitcnt vmcnt(5)
buffer_load_dwordx4 v12, s[16:19], s41 offen offset:1024 nt lds
MC v[36:39],a[28:31],a[112:115]
s_add_u32 m0, s34, 101440
v_exp_f32 v47, v47
MC v[36:39],a[32:35],a[116:119]
LG 2
RD a[4:7],v3,34304
CV v78,v44,v45
MC v[36:39],a[36:39],a[120:123]
RD a[8:11],v2,34432
CV v79,v46,v47
MC v[36:39],v[52:55],a[124:127]
v_exp_f32 v48, v48
M v[40:43],a[12:15],a[128:131],v[28:31]
RD a[12:15],v3,34432
s_nop 0
MC v[40:43],a[16:19],a[132:135]
RD a[16:19],v2,34560
s_nop 0
MC v[40:43],a[20:23],a[136:139]
RD a[20:23],v3,34560
MC v[40:43],a[24:27],a[140:143]
RD a[24:27],v2,34688
MC v[40:43],a[28:31],a[144:147]
RD a[28:31],v3,34688
MC v[40:43],a[32:35],a[148:151]
s_waitcnt vmcnt(5)
buffer_load_dwordx4 v12, s[16:19], s41 offen offset:2048 nt lds
MC v[40:43],a[36:39],a[152:155]
s_add_u32 m0, s34, 101472
v_exp_f32 v49, v49
MC v[40:43],v[52:55],a[156:159]
LG 5
v_exp_f32 v50, v50
M v[44:47],a[0:3],a[96:99],v[24:27]
v_exp_f32 v51, v51
MC v[44:47],a[4:7],a[100:103]
CV v86,v48,v49
CV v87,v50,v51
MC v[44:47],a[8:11],a[104:107]
LG 2
v_exp_f32 v36, v36
MC v[44:47],a[12:15],a[108:111]
v_exp_f32 v37, v37
MC v[44:47],a[16:19],a[112:115]
v_exp_f32 v38, v38
MC v[44:47],a[20:23],a[116:119]
LG 0
s_barrier
CV v80,v36,v37
MC v[44:47],a[24:27],a[120:123]
s_waitcnt vmcnt(5)
buffer_load_dwordx4 v12, s[16:19], s41 offen offset:3072 nt lds
MC v[44:47],a[28:31],a[124:127]
s_add_u32 m0, s34, 105600
TR a[32:33],v4,0
s_xor_b32 s41, s63, 294912
M v[48:51],a[0:3],a[128:131],v[28:31]
TR a[34:35],v4,512
s_nop 0
MC v[48:51],a[4:7],a[132:135]
TR a[36:37],v6,0
MC v[48:51],a[8:11],a[136:139]
TR a[38:39],v6,512
MC v[48:51],a[12:15],a[140:143]
v_exp_f32 v39, v39
MC v[48:51],a[16:19],a[144:147]
TR v[52:53],v4,32
CV v81,v38,v39
MC v[48:51],a[20:23],a[148:151]
TR v[54:55],v4,544
MC v[48:51],a[24:27],a[152:155]
TR a[0:1],v6,32
MC v[48:51],a[28:31],a[156:159]
TR a[2:3],v6,544
s_nop 0
MC a[60:63],a[48:51],v[56:59]
s_waitcnt vmcnt(5)
buffer_load_dwordx4 v12, s[16:19], s40 offen offset:0 nt lds
MC a[60:63],a[48:51],v[60:63]
s_add_u32 m0, s34, 105632
v_exp_f32 v40, v40
MC a[60:63],a[52:55],v[64:67]
TR a[4:5],v5,0
MC a[60:63],a[52:55],v[68:71]
TR a[6:7],v5,512
MC a[60:63],a[56:59],v[72:75]
TR a[8:9],v7,0
MC a[60:63],a[56:59],a[40:43]
LG 5
TR a[10:11],v7,512
MC v[96:99],a[32:35],v[56:59]
TR a[12:13],v5,32
MC v[96:99],a[36:39],v[60:63]
TR a[14:15],v5,544
MC v[104:107],a[36:39],v[68:71]
TR a[16:17],v7,32
MC v[104:107],a[32:35],v[64:67]
TR a[18:19],v7,544
MC v[112:115],a[32:35],v[72:75]
TR a[20:21],v4,128
MC v[112:115],a[36:39],a[40:43]
s_waitcnt vmcnt(4)
buffer_load_dwordx4 v12, s[16:19], s40 offen offset:1024 nt lds
MC v[100:103],v[52:55],v[56:59]
LG 6
TR a[22:23],v4,640
s_add_u32 m0, s34, 105664
MC v[100:103],a[0:3],v[60:63]
TR a[24:25],v6,128
MC v[108:111],a[0:3],v[68:71]
TR a[26:27],v6,640
MC v[108:111],v[52:55],v[64:67]
v_exp_f32 v41, v41
MC v[116:119],v[52:55],v[72:75]
TR a[28:29],v4,160
CV v88,v40,v41
MC v[116:119],a[0:3],a[40:43]
TR a[30:31],v4,672
MC v[120:123],a[4:7],v[56:59]
LG 5
TR a[32:33],v6,160
MC v[120:123],a[8:11],v[60:63]
TR a[34:35],v6,672
MC v[128:131],a[8:11],v[68:71]
v_exp_f32 v42, v42
MC v[128:131],a[4:7],v[64:67]
s_waitcnt vmcnt(4)
buffer_load_dwordx4 v12, s[16:19], s40 offen offset:2048 nt lds
MC v[124:127],a[12:15],v[56:59]
s_add_u32 m0, s34, 105696
TR a[36:37],v5,128
MC v[124:127],a[16:19],v[60:63]
TR a[38:39],v5,640
MC v[132:135],a[16:19],v[68:71]
TR v[52:53],v7,128
MC v[132:135],a[12:15],v[64:67]
LG 5
TR v[54:55],v7,640
MC v[136:139],a[20:23],v[56:59]
TR a[0:1],v5,160
MC v[136:139],a[24:27],v[60:63]
TR a[2:3],v5,672
MC v[144:147],a[24:27],v[68:71]
TR a[4:5],v7,160
MC v[144:147],a[20:23],v[64:67]
TR a[6:7],v7,672
MC v[152:155],a[20:23],v[72:75]
TR a[8:9],v4,256
MC v[152:155],a[24:27],a[40:43]
s_waitcnt vmcnt(4)
buffer_load_dwordx4 v12, s[16:19], s40 offen offset:3072 nt lds
MC v[140:143],a[28:31],v[56:59]
LG 6
TR a[10:11],v4,768
s_add_u32 m0, s34, 33792
MC v[140:143],a[32:35],v[60:63]
s_xor_b32 s40, s63, 430080
TR a[12:13],v6,256
MC v[148:151],a[32:35],v[68:71]
TR a[14:15],v6,768
MC v[148:151],a[28:31],v[64:67]
v_exp_f32 v43, v43
MC v[156:159],a[28:31],v[72:75]
v_exp_f32 v44, v44
MC v[156:159],a[32:35],a[40:43]
TR a[16:17],v4,288
CV v89,v42,v43
MC v[160:163],a[36:39],v[56:59]
LG 4
TR a[18:19],v4,800
MC v[160:163],v[52:55],v[60:63]
TR a[20:21],v6,288
MC v[168:171],v[52:55],v[68:71]
TR a[22:23],v6,800
MC v[168:171],a[36:39],v[64:67]
s_waitcnt vmcnt(4)
buffer_load_dwordx4 v12, s[12:15], s41 offen offset:0 nt lds
MC v[164:167],a[0:3],v[56:59]
s_add_u32 m0, s34, 33824
TR a[24:25],v5,256
MC v[164:167],a[4:7],v[60:63]
TR a[26:27],v5,768
MC v[172:175],a[4:7],v[68:71]
TR a[28:29],v7,256
MC v[172:175],a[0:3],v[64:67]
LG 6
TR a[30:31],v7,768
MC v[176:179],a[8:11],v[56:59]
TR a[32:33],v5,288
MC v[176:179],a[12:15],v[60:63]
TR a[34:35],v5,800
MC v[184:187],a[12:15],v[68:71]
TR v[52:53],v4,384
MC v[184:187],a[8:11],v[64:67]
TR a[36:37],v7,288
MC v[192:195],a[8:11],v[72:75]
TR a[38:39],v7,800
MC v[192:195],a[12:15],a[40:43]
LG 7
TR v[54:55],v4,896
MC v[180:183],a[16:19],v[56:59]
s_waitcnt vmcnt(4)
buffer_load_dwordx4 v12, s[12:15], s41 offen offset:1024 nt lds
MC v[180:183],a[20:23],v[60:63]
s_add_u32 m0, s34, 33856
TR a[0:1],v6,384
MC v[188:191],a[20:23],v[68:71]
TR a[2:3],v6,896
MC v[188:191],a[16:19],v[64:67]
v_exp_f32 v45, v45
MC v[196:199],a[16:19],v[72:75]
v_exp_f32 v46, v46
MC v[196:199],a[20:23],a[40:43]
TR a[4:5],v4,416
CV v82,v44,v45
MC v[200:203],a[24:27],v[56:59]
LG 4
TR a[6:7],v4,928
MC v[200:203],a[28:31],v[60:63]
TR a[8:9],v6,416
MC v[208:211],a[28:31],v[68:71]
TR a[10:11],v6,928
MC v[208:211],a[24:27],v[64:67]
v_exp_f32 v47, v47
MC v[204:207],a[32:35],v[56:59]
s_waitcnt vmcnt(4)
buffer_load_dwordx4 v12, s[12:15], s41 offen offset:2048 nt lds
MC v[204:207],a[36:39],v[60:63]
s_add_u32 m0, s34, 33888
TR a[12:13],v5,384
CV v83,v46,v47
MC v[212:215],a[36:39],v[68:71]
s_cmp_lg_u32 s43, 0
s_cbranch_scc1 Y_hook1
Y_ret1:
TR a[14:15],v5,896
s_add_u32 s56, s38, 0
MC v[212:215],a[32:35],v[64:67]
LG 5
TR a[16:17],v7,384
s_mul_i32 s50, s56, 52
MC v[216:219],v[52:55],v[56:59]
s_lshr_b32 s50, s50, 8
TR a[18:19],v7,896
s_mul_i32 s101, s50, 5
MC v[216:219],a[0:3],v[60:63]
s_sub_u32 s101, s56, s101
TR a[20:21],v5,416
s_lshl_b32 s50, s50, 7
MC v[224:227],a[0:3],v[68:71]
Y_pg12:
s_cbranch_execz Y_wr1
s_cmp_ge_u32 s56, 8
s_cselect_b32 s56, 0x40000000, s100
TR a[22:23],v5,928
s_add_u32 s56, s56, s50
MC v[224:227],v[52:55],v[64:67]
s_cmp_ge_u32 s101, 3
s_cselect_b32 s50, 1, 0
s_cselect_b32 s53, 3, 0
TR a[24:25],v7,416
s_sub_u32 s101, s101, s53
MC v[232:235],v[52:55],v[72:75]
s_xor_b32 s50, s50, s33
TR a[26:27],v7,928
s_lshl_b32 s50, s50, 6
MC v[232:235],a[0:3],a[40:43]
LG 7
s_barrier
MC v[220:223],a[4:7],v[56:59]
s_waitcnt vmcnt(4)
buffer_load_dwordx4 v12, s[12:15], s41 offen offset:3072 nt lds
MC v[220:223],a[8:11],v[60:63]
s_add_u32 m0, s34, 38016
RD a[28:31],v0,0
s_xor_b32 s41, s63, 262144
MC v[228:231],a[8:11],v[68:71]
s_add_u32 s56, s56, s50
RD a[32:35],v1,0
s_lshl_b32 s50, s33, 1
MC v[228:231],a[4:7],v[64:67]
s_add_u32 s50, s50, s101
RD a[36:39],v0,128
s_cmp_eq_u32 s101, 2
s_cselect_b32 s50, 4, s50
MC v[236:239],a[4:7],v[72:75]
s_mul_i32 s50, s50, 28672
RD v[52:55],v1,128
s_add_u32 s56, s56, s50
MC v[236:239],a[8:11],a[40:43]
LG 5
RD a[0:3],v0,256
s_add_u32 s57, s38, 8
MC v[240:243],a[12:15],v[56:59]
s_mul_i32 s50, s57, 52
RD a[4:7],v1,256
s_lshr_b32 s50, s50, 8
MC v[240:243],a[16:19],v[60:63]
s_mul_i32 s101, s50, 5
RD a[8:11],v0,384
s_sub_u32 s101, s57, s101
MC v[248:251],a[16:19],v[68:71]
s_lshl_b32 s50, s50, 7
v_exp_f32 v48, v48
MC v[248:251],a[12:15],v[64:67]
s_cmp_ge_u32 s57, 15
s_cselect_b32 s57, 0x40000000, s100
RD a[12:15],v1,384
s_add_u32 s57, s57, s50
MC v[244:247],a[20:23],v[56:59]
LG 6
v_exp_f32 v49, v49
MC v[244:247],a[24:27],v[60:63]
s_waitcnt vmcnt(4)
buffer_load_dwordx4 v12, s[12:15], s40 offen offset:0 nt lds
MC v[252:255],a[24:27],v[68:71]
s_add_u32 m0, s34, 38048
v_exp_f32 v50, v50
MC v[252:255],a[20:23],v[64:67]
s_cmp_ge_u32 s101, 3
s_cselect_b32 s50, 1, 0
s_cselect_b32 s53, 3, 0
v_exp_f32 v51, v51
M v[36:39],a[28:31],a[160:163],v[32:35]
s_sub_u32 s101, s101, s53
RD a[16:19],v0,512
CV v90,v48,v49
MC v[36:39],a[32:35],a[164:167]
LG 2
RD a[24:27],v0,640
CV v91,v50,v51
MC v[36:39],a[36:39],a[168:171]
s_xor_b32 s50, s50, s33
RD a[20:23],v1,512
s_lshl_b32 s50, s50, 6
MC v[36:39],v[52:55],a[172:175]
s_add_u32 s57, s57, s50
RD a[44:47],v17,0
s_lshl_b32 s50, s33, 1
MC v[36:39],a[0:3],a[176:179]
s_add_u32 s50, s50, s101
s_cmp_eq_u32 s101, 2
s_cselect_b32 s50, 4, s50
s_mul_i32 s50, s50, 28672
MC v[36:39],a[4:7],a[180:183]
s_add_u32 s57, s57, s50
s_add_u32 s58, s38, 15
s_mul_i32 s50, s58, 52
MC v[36:39],a[8:11],a[184:187]
LG 4
s_lshr_b32 s50, s50, 8
s_mul_i32 s101, s50, 5
MC v[36:39],a[12:15],a[188:191]
s_waitcnt vmcnt(4)
buffer_load_dwordx4 v12, s[12:15], s40 offen offset:1024 nt lds
M v[40:43],a[28:31],a[192:195],v[24:27]
s_add_u32 m0, s34, 38080
s_sub_u32 s101, s58, s101
s_lshl_b32 s50, s50, 7
MC v[40:43],a[32:35],a[196:199]
s_cmp_ge_u32 s58, 23
s_cselect_b32 s58, 0x40000000, s100
s_add_u32 s58, s58, s50
s_cmp_ge_u32 s101, 3
s_cselect_b32 s50, 1, 0
s_cselect_b32 s53, 3, 0
MC v[40:43],a[36:39],a[200:203]
s_sub_u32 s101, s101, s53
v_exp_f32 v36, v36
MC v[40:43],v[52:55],a[204:207]
s_xor_b32 s50, s50, s33
v_exp_f32 v37, v37
MC v[40:43],a[0:3],a[208:211]
s_lshl_b32 s50, s50, 6
v_exp_f32 v38, v38
MC v[40:43],a[4:7],a[212:215]
s_add_u32 s58, s58, s50
v_exp_f32 v39, v39
MC v[40:43],a[8:11],a[216:219]
s_lshl_b32 s50, s33, 1
CV v72,v36,v37
CV v73,v38,v39
MC v[40:43],a[12:15],a[220:223]
s_add_u32 s50, s50, s101
s_cmp_eq_u32 s101, 2
s_cselect_b32 s50, 4, s50
s_mul_i32 s50, s50, 28672
M v[44:47],a[28:31],a[224:227],v[28:31]
s_add_u32 s58, s58, s50
RD a[28:31],v1,640
s_add_u32 s59, s38, 23
MC v[44:47],a[32:35],a[228:231]
s_mul_i32 s50, s59, 52
RD a[32:35],v0,768
s_lshr_b32 s50, s50, 8
MC v[44:47],a[36:39],a[232:235]
s_mul_i32 s101, s50, 5
RD a[36:39],v1,768
s_sub_u32 s101, s59, s101
MC v[44:47],v[52:55],a[236:239]
s_waitcnt vmcnt(4)
buffer_load_dwordx4 v12, s[12:15], s40 offen offset:2048 nt lds
MC v[44:47],a[0:3],a[240:243]
s_add_u32 m0, s34, 38112
RD v[52:55],v0,896
s_lshl_b32 s50, s50, 7
MC v[44:47],a[4:7],a[244:247]
s_cmp_ge_u32 s59, 30
s_cselect_b32 s59, 0x40000000, s100
RD a[0:3],v1,896
s_add_u32 s59, s59, s50
MC v[44:47],a[8:11],a[248:251]
s_cmp_ge_u32 s101, 3
s_cselect_b32 s50, 1, 0
s_cselect_b32 s53, 3, 0
v_exp_f32 v40, v40
MC v[44:47],a[12:15],a[252:255]
LG 5
v_exp_f32 v41, v41
M v[48:51],a[16:19],a[160:163],v[32:35]
s_sub_u32 s101, s101, s53
v_exp_f32 v42, v42
MC v[48:51],a[20:23],a[164:167]
s_xor_b32 s50, s50, s33
v_exp_f32 v43, v43
MC v[48:51],a[24:27],a[168:171]
LG 2
RD a[4:7],v2,0
CV v56,v40,v41
MC v[48:51],a[28:31],a[172:175]
s_lshl_b32 s50, s50, 6
RD a[8:11],v3,0
CV v57,v42,v43
MC v[48:51],a[32:35],a[176:179]
s_add_u32 s59, s59, s50
v_exp_f32 v44, v44
MC v[48:51],a[36:39],a[180:183]
s_waitcnt vmcnt(4) lgkmcnt(2)
buffer_load_dwordx4 v12, s[12:15], s40 offen offset:3072 nt lds
MC v[48:51],v[52:55],a[184:187]
s_add_u32 m0, s34, 67584
v_exp_f32 v45, v45
MC v[48:51],a[0:3],a[188:191]
s_xor_b32 s40, s63, 397312
v_exp_f32 v46, v46
M v[36:39],a[16:19],a[192:195],v[24:27]
s_lshl_b32 s50, s33, 1
v_exp_f32 v47, v47
MC v[36:39],a[20:23],a[196:199]
s_add_u32 s50, s50, s101
RD a[12:15],v2,128
CV v64,v44,v45
MC v[36:39],a[24:27],a[200:203]
s_cmp_eq_u32 s101, 2
s_cselect_b32 s50, 4, s50
v_exp_f32 v48, v48
MC v[36:39],a[28:31],a[204:207]
s_mul_i32 s50, s50, 28672
v_exp_f32 v49, v49
MC v[36:39],a[32:35],a[208:211]
s_add_u32 s59, s59, s50
v_exp_f32 v50, v50
MC v[36:39],a[36:39],a[212:215]
s_add_u32 s60, s38, 30
v_exp_f32 v51, v51
MC v[36:39],v[52:55],a[216:219]
s_mul_i32 s50, s60, 52
CV v74,v48,v49
CV v75,v50,v51
MC v[36:39],a[0:3],a[220:223]
s_lshr_b32 s50, s50, 8
ds_write_b128 v16, v[72:75] offset:1024
M v[40:43],a[16:19],a[224:227],v[28:31]
s_mul_i32 s101, s50, 5
RD a[16:19],v3,128
CV v65,v46,v47
MC v[40:43],a[20:23],a[228:231]
s_waitcnt vmcnt(3)
buffer_load_dwordx4 v12, s[16:19], s41 offen offset:0 nt lds
MC v[40:43],a[24:27],a[232:235]
s_add_u32 m0, s34, 67616
RD a[20:23],v2,256
s_sub_u32 s101, s60, s101
MC v[40:43],a[28:31],a[236:239]
s_lshl_b32 s50, s50, 7
RD a[24:27],v3,256
v_exp_f32 v36, v36
MC v[40:43],a[32:35],a[240:243]
s_cmp_ge_u32 s60, 35
s_cselect_b32 s60, 0x40000000, s100
v_exp_f32 v37, v37
MC v[40:43],a[36:39],a[244:247]
s_add_u32 s60, s60, s50
v_exp_f32 v38, v38
MC v[40:43],v[52:55],a[248:251]
s_cmp_ge_u32 s101, 3
s_cselect_b32 s50, 1, 0
s_cselect_b32 s53, 3, 0
RD a[28:31],v2,384
CV v58,v36,v37
MC v[40:43],a[0:3],a[252:255]
LG 4
RD a[32:35],v3,384
s_sub_u32 s101, s101, s53
M v[44:47],a[4:7],a[192:195],v[24:27]
s_xor_b32 s50, s50, s33
v_exp_f32 v39, v39
MC v[44:47],a[8:11],a[196:199]
s_lshl_b32 s50, s50, 6
RD a[36:39],v2,512
CV v59,v38,v39
MC v[44:47],a[12:15],a[200:203]
LG 4
RD v[52:55],v3,512
s_add_u32 s60, s60, s50
MC v[44:47],a[16:19],a[204:207]
s_lshl_b32 s50, s33, 1
RD a[0:3],v2,640
buffer_load_dwordx4 v12, s[16:19], s41 offen offset:1024 nt lds
MC v[44:47],a[20:23],a[208:211]
LG 5
v_exp_f32 v40, v40
MC v[44:47],a[24:27],a[212:215]
LG 4
v_exp_f32 v41, v41
MC v[44:47],a[28:31],a[216:219]
LG 3
v_exp_f32 v42, v42
MC v[44:47],a[32:35],a[220:223]
s_add_u32 m0, s34, 67648
v_exp_f32 v43, v43
M v[48:51],a[4:7],a[224:227],v[28:31]
s_add_u32 s50, s50, s101
RD a[4:7],v3,640
CV v66,v40,v41
MC v[48:51],a[8:11],a[228:231]
s_cmp_eq_u32 s101, 2
s_cselect_b32 s50, 4, s50
RD a[8:11],v2,768
CV v67,v42,v43
MC v[48:51],a[12:15],a[232:235]
s_mul_i32 s50, s50, 28672
v_exp_f32 v44, v44
MC v[48:51],a[16:19],a[236:239]
s_add_u32 s60, s60, s50
RD a[12:15],v3,768
v_exp_f32 v45, v45
MC v[48:51],a[20:23],a[240:243]
s_mul_i32 s50, s33, 4224
RD a[16:19],v2,896
v_exp_f32 v46, v46
MC v[48:51],a[24:27],a[244:247]
s_sub_u32 s101, 4224, s50
RD a[20:23],v3,896
v_exp_f32 v47, v47
MC v[48:51],a[28:31],a[248:251]
s_barrier
CV v60,v44,v45
CV v61,v46,v47
MC v[48:51],a[32:35],a[252:255]
s_waitcnt vmcnt(4) lgkmcnt(5)
TR a[24:25],v4,33792
buffer_load_dwordx4 v12, s[16:19], s41 offen offset:2048 nt lds
M v[36:39],a[36:39],a[192:195],v[24:27]
s_add_u32 m0, s34, 67680
TR a[26:27],v4,34304
v_add_u32 v10, s101, v8
MC v[36:39],v[52:55],a[196:199]
TR a[28:29],v6,33792
v_add_u32 v8, s50, v8
MC v[36:39],a[0:3],a[200:203]
LG 6
TR a[30:31],v6,34304
v_add_u32 v11, s101, v9
MC v[36:39],a[4:7],a[204:207]
TR a[32:33],v4,33824
v_add_u32 v9, s50, v9
MC v[36:39],a[8:11],a[208:211]
LG 6
TR a[34:35],v4,34336
s_lshl_b32 s50, s38, 10
MC v[36:39],a[12:15],a[212:215]
v_exp_f32 v48, v48
MC v[36:39],a[16:19],a[216:219]
LG 6
v_exp_f32 v49, v49
MC v[36:39],a[20:23],a[220:223]
v_exp_f32 v50, v50
M v[40:43],a[36:39],a[224:227],v[28:31]
v_exp_f32 v51, v51
MC v[40:43],v[52:55],a[228:231]
s_waitcnt vmcnt(4)
TR a[36:37],v6,33824
buffer_load_dwordx4 v12, s[16:19], s41 offen offset:3072 nt lds
MC v[40:43],a[0:3],a[232:235]
s_add_u32 m0, s34, 71808
TR a[38:39],v6,34336
TR v[52:53],v5,33792
MC v[40:43],a[4:7],a[236:239]
s_xor_b32 s41, s63, 327680
TR v[54:55],v5,34304
v_exp_f32 v36, v36
MC v[40:43],a[8:11],a[240:243]
TR a[0:1],v7,33792
v_exp_f32 v37, v37
MC v[40:43],a[12:15],a[244:247]
TR a[2:3],v7,34304
v_exp_f32 v38, v38
MC v[40:43],a[16:19],a[248:251]
TR a[4:5],v5,33824
v_exp_f32 v39, v39
MC v[40:43],a[20:23],a[252:255]
TR a[6:7],v5,34336
TR a[8:9],v7,33824
MC a[60:63],a[48:51],v[76:79]
LG 9
TR a[10:11],v7,34336
TR a[12:13],v4,33920
MC a[60:63],a[48:51],v[80:83]
TR a[14:15],v4,34432
CV v68,v48,v49
MC a[60:63],a[52:55],v[84:87]
s_waitcnt vmcnt(3)
TR a[16:17],v6,33920
buffer_load_dwordx4 v12, s[16:19], s40 offen offset:0 nt lds
MC a[60:63],a[52:55],v[88:91]
s_add_u32 m0, s34, 71840
v_exp_f32 v40, v40
MC a[60:63],a[56:59],v[92:95]
v_exp_f32 v41, v41
MC a[60:63],a[56:59],a[44:47]
v_exp_f32 v42, v42
MC v[96:99],a[24:27],v[76:79]
v_exp_f32 v43, v43
MC v[96:99],a[28:31],v[80:83]
TR a[18:19],v6,34432
CV v69,v50,v51
MC v[104:107],a[28:31],v[88:91]
LG 3
TR a[20:21],v4,33952
CV v62,v36,v37
MC v[104:107],a[24:27],v[84:87]
TR a[22:23],v4,34464
CV v63,v38,v39
AR v18,a60
MC v[112:115],a[24:27],v[92:95]
TR a[24:25],v6,33952
CV v70,v40,v41
AR v19,a61
MC v[112:115],a[28:31],a[44:47]
TR a[26:27],v6,34464
CV v71,v42,v43
AR v20,a62
MC v[100:103],a[32:35],v[76:79]
TR a[28:29],v5,33920
buffer_load_dwordx4 v12, s[16:19], s40 offen offset:1024 nt lds
v_min3_f32 v22, v18, v19, v20
MC v[100:103],a[36:39],v[80:83]
s_add_u32 m0, s34, 71872
TR a[30:31],v5,34432
v_max3_f32 v23, v18, v19, v20
MC v[108:111],a[36:39],v[88:91]
v_rcp_f32 v18, v18
v_rcp_f32 v20, v20
MC v[108:111],a[32:35],v[84:87]
v_rcp_f32 v19, v19
v_mul_f32 v112, v20, v112
MC v[116:119],a[32:35],v[92:95]
TR a[32:33],v7,33920
v_cmp_nle_f32 s[48:49], s44, v22
v_mul_f32 v113, v20, v113
MC v[116:119],a[36:39],a[44:47]
s_or_b64 s[46:47], s[46:47], s[48:49]
TR a[34:35],v7,34432
v_mul_f32 v96, v18, v96
v_mul_f32 v114, v20, v114
MC v[120:123],v[52:55],v[76:79]
TR a[36:37],v5,33952
v_cmp_nge_f32 s[48:49], s45, v23
v_mul_f32 v115, v20, v115
MC v[120:123],a[0:3],v[80:83]
s_or_b64 s[46:47], s[46:47], s[48:49]
TR a[38:39],v5,34464
v_lshrrev_b32 v23, 9, v15
CV v112,v112,v113
MC v[128:131],a[0:3],v[88:91]
TR a[0:1],v4,34048
v_mul_f32 v97, v18, v97
CV v113,v114,v115
MC v[128:131],v[52:55],v[84:87]
LG 5
TR v[52:53],v7,33952
v_mul_f32 v98, v18, v98
v_mul_f32 v116, v20, v116
MC v[124:127],a[4:7],v[76:79]
s_waitcnt vmcnt(4)
TR v[54:55],v7,34464
buffer_load_dwordx4 v12, s[16:19], s40 offen offset:2048 nt lds
v_mul_f32 v117, v20, v117
MC v[124:127],a[8:11],v[80:83]
s_add_u32 m0, s34, 71904
TR a[2:3],v4,34560
v_mul_f32 v99, v18, v99
v_mul_f32 v118, v20, v118
MC v[132:135],a[8:11],v[88:91]
TR a[8:9],v4,34080
CV v96,v96,v97
v_mul_f32 v119, v20, v119
MC v[132:135],a[4:7],v[84:87]
TR a[4:5],v6,34048
v_lshlrev_b32 v23, 7, v23
CV v114,v116,v117
MC v[136:139],a[12:15],v[76:79]
TR a[6:7],v6,34560
v_add_u32 v23, 27000, v23
CV v115,v118,v119
MC v[136:139],a[16:19],v[80:83]
ds_write_b128 v16, v[112:115] offset:2048
MC v[144:147],a[16:19],v[88:91]
TR a[10:11],v4,34592
CV v97,v98,v99
MC v[144:147],a[12:15],v[84:87]
v_mul_f32 v104, v19, v104
v_mul_f32 v105, v19, v105
MC v[152:155],a[12:15],v[92:95]
TR a[12:13],v6,34080
v_mul_f32 v106, v19, v106
MC v[152:155],a[16:19],a[44:47]
LG 6
TR a[14:15],v6,34592
v_mul_f32 v107, v19, v107
MC v[140:143],a[20:23],v[76:79]
TR a[16:17],v5,34048
CV v104,v104,v105
MC v[140:143],a[24:27],v[80:83]
s_waitcnt vmcnt(4)
TR a[18:19],v5,34560
buffer_load_dwordx4 v12, s[16:19], s40 offen offset:3072 nt lds
MC v[148:151],a[24:27],v[88:91]
s_add_u32 m0, s34, 0
CV v105,v106,v107
v_mul_f32 v100, v18, v100
MC v[148:151],a[20:23],v[84:87]
s_xor_b32 s40, s63, 462848
v_mul_f32 v101, v18, v101
v_mul_f32 v102, v18, v102
MC v[156:159],a[20:23],v[92:95]
TR a[20:21],v7,34048
v_mul_f32 v103, v18, v103
MC v[156:159],a[24:27],a[44:47]
TR a[22:23],v7,34560
CV v98,v100,v101
MC v[160:163],a[28:31],v[76:79]
TR a[24:25],v5,34080
CV v99,v102,v103
MC v[160:163],a[32:35],v[80:83]
TR a[26:27],v5,34592
v_mul_f32 v108, v19, v108
MC v[168:171],a[32:35],v[88:91]
TR a[32:33],v4,34176
v_mul_f32 v109, v19, v109
MC v[168:171],a[28:31],v[84:87]
LG 5
TR a[28:29],v7,34080
v_mul_f32 v110, v19, v110
MC v[164:167],a[36:39],v[76:79]
TR a[30:31],v7,34592
v_mul_f32 v111, v19, v111
MC v[164:167],v[52:55],v[80:83]
s_waitcnt vmcnt(3)
TR a[34:35],v4,34688
buffer_load_dwordx4 v12, s[12:15], s41 offen offset:0 nt lds
MC v[172:175],v[52:55],v[88:91]
s_add_u32 m0, s34, 32
TR v[52:53],v4,34208
CV v106,v108,v109
MC v[172:175],a[36:39],v[84:87]
TR a[36:37],v6,34176
CV v107,v110,v111
MC v[176:179],a[0:3],v[76:79]
TR a[38:39],v6,34688
v_mul_f32 v120, v18, v120
MC v[176:179],a[4:7],v[80:83]
TR v[54:55],v4,34720
v_mul_f32 v121, v18, v121
MC v[184:187],a[4:7],v[88:91]
v_mul_f32 v122, v18, v122
v_mul_f32 v123, v18, v123
MC v[184:187],a[0:3],v[84:87]
CV v120,v120,v121
v_mul_f32 v128, v19, v128
MC v[192:195],a[0:3],v[92:95]
TR a[0:1],v6,34208
CV v121,v122,v123
MC v[192:195],a[4:7],a[44:47]
TR a[2:3],v6,34720
v_mul_f32 v129, v19, v129
MC v[180:183],a[8:11],v[76:79]
LG 5
TR a[4:5],v5,34176
v_mul_f32 v130, v19, v130
MC v[180:183],a[12:15],v[80:83]
TR a[6:7],v5,34688
buffer_load_dwordx4 v12, s[12:15], s41 offen offset:1024 nt lds
v_mul_f32 v156, v20, v156
MC v[188:191],a[12:15],v[88:91]
s_add_u32 m0, s34, 64
v_mul_f32 v131, v19, v131
CV v128,v128,v129
MC v[188:191],a[8:11],v[84:87]
CV v129,v130,v131
v_mul_f32 v124, v18, v124
v_mul_f32 v157, v20, v157
MC v[196:199],a[8:11],v[92:95]
TR a[8:9],v7,34176
v_mul_f32 v125, v18, v125
v_mul_f32 v158, v20, v158
MC v[196:199],a[12:15],a[44:47]
TR a[10:11],v7,34688
v_mul_f32 v126, v18, v126
v_mul_f32 v159, v20, v159
MC v[200:203],a[16:19],v[76:79]
TR a[12:13],v5,34208
v_mul_f32 v127, v18, v127
MC v[200:203],a[20:23],v[80:83]
TR a[14:15],v5,34720
CV v122,v124,v125
MC v[208:211],a[20:23],v[88:91]
CV v123,v126,v127
v_mul_f32 v132, v19, v132
MC v[208:211],a[16:19],v[84:87]
TR a[16:17],v7,34208
v_mul_f32 v133, v19, v133
MC v[204:207],a[24:27],v[76:79]
TR a[18:19],v7,34720
v_mul_f32 v134, v19, v134
MC v[204:207],a[28:31],v[80:83]
v_mul_f32 v135, v19, v135
CV v130,v132,v133
MC v[212:215],a[28:31],v[88:91]
CV v131,v134,v135
v_mul_f32 v136, v18, v136
MC v[212:215],a[24:27],v[84:87]
s_waitcnt vmcnt(4)
buffer_load_dwordx4 v12, s[12:15], s41 offen offset:2048 nt lds
MC v[216:219],a[32:35],v[76:79]
LG 3
v_mul_f32 v137, v18, v137
v_mul_f32 v138, v18, v138
MC v[216:219],a[36:39],v[80:83]
s_barrier
v_mul_f32 v139, v18, v139
CV v136,v136,v137
MC v[224:227],a[36:39],v[88:91]
s_add_u32 m0, s34, 96
RD a[20:23],v0,33792
CV v137,v138,v139
MC v[224:227],a[32:35],v[84:87]
RD a[24:27],v1,33792
v_mul_f32 v144, v19, v144
MC v[232:235],a[32:35],v[92:95]
RD a[28:31],v0,33920
v_mul_f32 v145, v19, v145
MC v[232:235],a[36:39],a[44:47]
RD a[32:35],v1,33920
v_mul_f32 v146, v19, v146
MC v[220:223],v[52:55],v[76:79]
RD a[36:39],v0,34048
v_mul_f32 v147, v19, v147
MC v[220:223],a[0:3],v[80:83]
RD a[40:43],v17,1024
CV v144,v144,v145
MC v[228:231],a[0:3],v[88:91]
CV v145,v146,v147
v_mul_f32 v152, v20, v152
MC v[228:231],v[52:55],v[84:87]
s_waitcnt vmcnt(4)
buffer_load_dwordx4 v12, s[12:15], s41 offen offset:3072 nt lds
MC v[236:239],v[52:55],v[92:95]
s_add_u32 m0, s34, 4224
RD v[52:55],v1,34048
v_mul_f32 v153, v20, v153
MC v[236:239],a[0:3],a[44:47]
s_xor_b32 s41, s63, 294912
RD a[0:3],v0,34176
v_mul_f32 v154, v20, v154
MC v[240:243],a[4:7],v[76:79]
Y_pg13:
s_cbranch_execz Y_wr2
v_mul_f32 v155, v20, v155
CV v152,v152,v153
MC v[240:243],a[8:11],v[80:83]
CV v153,v154,v155
v_mul_f32 v140, v18, v140
MC v[248:251],a[8:11],v[88:91]
RD a[8:11],v0,34304
v_mul_f32 v141, v18, v141
CV v154,v156,v157
MC v[248:251],a[4:7],v[84:87]
LG 3
RD a[4:7],v1,34176
v_mul_f32 v142, v18, v142
CV v155,v158,v159
MC v[244:247],a[12:15],v[76:79]
ds_write_b128 v16, v[152:155] offset:3072
MC v[244:247],a[16:19],v[80:83]
v_mul_f32 v143, v18, v143
CV v138,v140,v141
MC v[252:255],a[16:19],v[88:91]
s_waitcnt vmcnt(3)
RD a[16:19],v0,34432
buffer_load_dwordx4 v12, s[12:15], s40 offen offset:0 nt lds
MC v[252:255],a[12:15],v[84:87]
s_add_u32 m0, s34, 4256
RD a[12:15],v1,34304
CV v139,v142,v143
M v[44:47],a[20:23],a[160:163],v[32:35]
v_mul_f32 v148, v19, v148
v_mul_f32 v149, v19, v149
MC v[44:47],a[24:27],a[164:167]
v_mul_f32 v150, v19, v150
v_mul_f32 v151, v19, v151
MC v[44:47],a[28:31],a[168:171]
CV v146,v148,v149
CV v147,v150,v151
MC v[44:47],a[32:35],a[172:175]
v_mul_f32 v160, v18, v160
v_mul_f32 v161, v18, v161
MC v[44:47],a[36:39],a[176:179]
LG 2
v_mul_f32 v162, v18, v162
v_mul_f32 v163, v18, v163
MC v[44:47],v[52:55],a[180:183]
CV v160,v160,v161
v_mul_f32 v168, v19, v168
v_mul_f32 v192, v20, v192
MC v[44:47],a[0:3],a[184:187]
CV v161,v162,v163
v_mul_f32 v169, v19, v169
v_mul_f32 v193, v20, v193
MC v[44:47],a[4:7],a[188:191]
v_mul_f32 v170, v19, v170
v_mul_f32 v171, v19, v171
v_mul_f32 v194, v20, v194
M v[48:51],a[20:23],a[192:195],v[24:27]
CV v168,v168,v169
v_mul_f32 v164, v18, v164
v_mul_f32 v195, v20, v195
MC v[48:51],a[24:27],a[196:199]
buffer_load_dwordx4 v12, s[12:15], s40 offen offset:1024 nt lds
CV v192,v192,v193
MC v[48:51],a[28:31],a[200:203]
s_add_u32 m0, s34, 4288
CV v169,v170,v171
v_mul_f32 v165, v18, v165
CV v193,v194,v195
MC v[48:51],a[32:35],a[204:207]
v_mul_f32 v166, v18, v166
v_mul_f32 v167, v18, v167
v_mul_f32 v196, v20, v196
MC v[48:51],a[36:39],a[208:211]
CV v162,v164,v165
CV v163,v166,v167
v_mul_f32 v197, v20, v197
MC v[48:51],v[52:55],a[212:215]
v_mul_f32 v172, v19, v172
v_mul_f32 v173, v19, v173
v_mul_f32 v198, v20, v198
MC v[48:51],a[0:3],a[216:219]
v_mul_f32 v174, v19, v174
v_mul_f32 v175, v19, v175
v_mul_f32 v199, v20, v199
MC v[48:51],a[4:7],a[220:223]
CV v170,v172,v173
CV v171,v174,v175
CV v194,v196,v197
M v[36:39],a[20:23],a[224:227],v[28:31]
v_exp_f32 v44, v44
CV v195,v198,v199
MC v[36:39],a[24:27],a[228:231]
ds_write_b128 v16, v[192:195] offset:4096
MC v[36:39],a[28:31],a[232:235]
RD a[20:23],v1,34432
v_exp_f32 v45, v45
MC v[36:39],a[32:35],a[236:239]
s_waitcnt vmcnt(4)
RD a[24:27],v0,34560
buffer_load_dwordx4 v12, s[12:15], s40 offen offset:2048 nt lds
MC v[36:39],a[36:39],a[240:243]
s_add_u32 m0, s34, 4320
RD a[28:31],v1,34560
v_mul_f32 v176, v18, v176
MC v[36:39],v[52:55],a[244:247]
RD a[32:35],v0,34688
v_mul_f32 v177, v18, v177
MC v[36:39],a[0:3],a[248:251]
RD a[36:39],v1,34688
v_mul_f32 v178, v18, v178
MC v[36:39],a[4:7],a[252:255]
RD v[52:55],v2,33792
v_mul_f32 v179, v18, v179
M v[40:43],a[8:11],a[160:163],v[32:35]
LG 7
v_exp_f32 v46, v46
MC v[40:43],a[12:15],a[164:167]
v_exp_f32 v47, v47
MC v[40:43],a[16:19],a[168:171]
s_waitcnt vmcnt(4) lgkmcnt(5)
RD a[0:3],v3,33792
buffer_load_dwordx4 v12, s[12:15], s40 offen offset:3072 nt lds
MC v[40:43],a[20:23],a[172:175]
LG 5
RD a[4:7],v2,33920
CV v176,v176,v177
MC v[40:43],a[24:27],a[176:179]
LG 5
v_exp_f32 v48, v48
MC v[40:43],a[28:31],a[180:183]
LG 4
v_exp_f32 v49, v49
MC v[40:43],a[32:35],a[184:187]
LG 3
v_exp_f32 v50, v50
s_getpc_b64 s[54:55]
MC v[40:43],a[36:39],a[188:191]
s_add_u32 m0, s34, 101376
global_load_dword v14, v23, s[54:55]
CV v92,v44,v45
CV v93,v46,v47
M v[44:47],a[8:11],a[192:195],v[24:27]
s_xor_b32 s40, s63, 430080
v_exp_f32 v51, v51
MC v[44:47],a[12:15],a[196:199]
CV v177,v178,v179
v_mul_f32 v184, v19, v184
MC v[44:47],a[16:19],a[200:203]
v_mul_f32 v185, v19, v185
v_mul_f32 v186, v19, v186
MC v[44:47],a[20:23],a[204:207]
v_mul_f32 v187, v19, v187
CV v184,v184,v185
MC v[44:47],a[24:27],a[208:211]
v_exp_f32 v36, v36
MC v[44:47],a[28:31],a[212:215]
v_exp_f32 v37, v37
MC v[44:47],a[32:35],a[216:219]
v_exp_f32 v38, v38
MC v[44:47],a[36:39],a[220:223]
v_exp_f32 v39, v39
CV v76,v48,v49
CV v77,v50,v51
M v[48:51],a[8:11],a[224:227],v[28:31]
s_waitcnt vmcnt(4)
buffer_load_dwordx4 v12, s[16:19], s41 offen offset:0 nt lds
MC v[48:51],a[12:15],a[228:231]
s_add_u32 m0, s34, 101408
v_exp_f32 v40, v40
MC v[48:51],a[16:19],a[232:235]
v_exp_f32 v41, v41
MC v[48:51],a[20:23],a[236:239]
RD a[8:11],v3,33920
CV v185,v186,v187
MC v[48:51],a[24:27],a[240:243]
RD a[12:15],v2,34048
v_mul_f32 v180, v18, v180
MC v[48:51],a[28:31],a[244:247]
RD a[16:19],v3,34048
v_mul_f32 v181, v18, v181
MC v[48:51],a[32:35],a[248:251]
RD a[20:23],v2,34176
v_mul_f32 v182, v18, v182
MC v[48:51],a[36:39],a[252:255]
LG 4
RD a[24:27],v3,34176
v_mul_f32 v183, v18, v183
CV v84,v36,v37
CV v85,v38,v39
M v[36:39],v[52:55],a[192:195],v[24:27]
v_exp_f32 v42, v42
MC v[36:39],a[0:3],a[196:199]
v_exp_f32 v43, v43
MC v[36:39],a[4:7],a[200:203]
LG 4
v_exp_f32 v44, v44
MC v[36:39],a[8:11],a[204:207]
LG 3
buffer_load_dwordx4 v12, s[16:19], s41 offen offset:1024 nt lds
MC v[36:39],a[12:15],a[208:211]
LG 2
v_exp_f32 v45, v45
MC v[36:39],a[16:19],a[212:215]
LG 1
v_exp_f32 v46, v46
MC v[36:39],a[20:23],a[216:219]
LG 0
v_exp_f32 v47, v47
MC v[36:39],a[24:27],a[220:223]
s_add_u32 m0, s34, 101440
RD a[28:31],v2,34304
CV v178,v180,v181
CV v94,v40,v41
CV v95,v42,v43
M v[40:43],v[52:55],a[224:227],v[28:31]
RD a[32:35],v3,34304
CV v179,v182,v183
MC v[40:43],a[0:3],a[228:231]
RD a[36:39],v2,34432
v_mul_f32 v188, v19, v188
MC v[40:43],a[4:7],a[232:235]
RD v[52:55],v3,34432
v_mul_f32 v189, v19, v189
MC v[40:43],a[8:11],a[236:239]
RD a[0:3],v2,34560
v_mul_f32 v190, v19, v190
MC v[40:43],a[12:15],a[240:243]
s_waitcnt vmcnt(5)
RD a[4:7],v3,34560
buffer_load_dwordx4 v12, s[16:19], s41 offen offset:2048 nt lds
MC v[40:43],a[16:19],a[244:247]
s_add_u32 m0, s34, 101472
RD a[8:11],v2,34688
v_mul_f32 v191, v19, v191
MC v[40:43],a[20:23],a[248:251]
RD a[12:15],v3,34688
CV v186,v188,v189
MC v[40:43],a[24:27],a[252:255]
LG 7
CV v187,v190,v191
v_mul_f32 v200, v18, v200
CV v78,v44,v45
CV v79,v46,v47
M v[44:47],a[28:31],a[192:195],v[24:27]
LG 6
v_mul_f32 v201, v18, v201
v_mul_f32 v202, v18, v202
MC v[44:47],a[32:35],a[196:199]
LG 5
v_mul_f32 v203, v18, v203
CV v200,v200,v201
MC v[44:47],a[36:39],a[200:203]
LG 4
v_exp_f32 v48, v48
MC v[44:47],v[52:55],a[204:207]
LG 3
v_exp_f32 v49, v49
MC v[44:47],a[0:3],a[208:211]
LG 2
v_exp_f32 v50, v50
MC v[44:47],a[4:7],a[212:215]
LG 1
v_exp_f32 v51, v51
MC v[44:47],a[8:11],a[216:219]
s_waitcnt vmcnt(5) lgkmcnt(0)
buffer_load_dwordx4 v12, s[16:19], s41 offen offset:3072 nt lds
MC v[44:47],a[12:15],a[220:223]
s_barrier
CV v86,v48,v49
CV v87,v50,v51
M v[48:51],a[28:31],a[224:227],v[28:31]
s_add_u32 m0, s34, 105600
TR a[16:17],v4,0
CV v201,v202,v203
MC v[48:51],a[32:35],a[228:231]
s_xor_b32 s41, s63, 360448
TR a[18:19],v4,512
v_mul_f32 v208, v19, v208
MC v[48:51],a[36:39],a[232:235]
TR a[20:21],v6,0
v_mul_f32 v209, v19, v209
MC v[48:51],v[52:55],a[236:239]
TR a[22:23],v6,512
v_mul_f32 v210, v19, v210
MC v[48:51],a[0:3],a[240:243]
TR a[24:25],v4,32
v_mul_f32 v211, v19, v211
MC v[48:51],a[4:7],a[244:247]
TR a[26:27],v4,544
CV v208,v208,v209
MC v[48:51],a[8:11],a[248:251]
TR a[28:29],v6,32
CV v209,v210,v211
MC v[48:51],a[12:15],a[252:255]
TR a[30:31],v6,544
v_mul_f32 v204, v18, v204
M a[60:63],a[48:51],v[56:59],0
s_waitcnt vmcnt(3)
TR a[32:33],v5,0
buffer_load_dwordx4 v12, s[16:19], s40 offen offset:0 nt lds
MC a[60:63],a[48:51],v[60:63]
s_add_u32 m0, s34, 105632
TR a[34:35],v5,512
v_mul_f32 v205, v18, v205
MC a[60:63],a[52:55],v[64:67]
TR a[36:37],v7,0
v_mul_f32 v206, v18, v206
MC a[60:63],a[52:55],v[68:71]
TR a[38:39],v7,512
v_mul_f32 v207, v18, v207
MC a[60:63],a[56:59],v[72:75]
TR v[52:53],v5,32
CV v202,v204,v205
MC a[60:63],a[56:59],a[40:43]
LG 7
TR v[54:55],v5,544
CV v203,v206,v207
M v[100:103],a[16:19],v[56:59],0
TR a[0:1],v7,32
v_mul_f32 v212, v19, v212
MC v[100:103],a[20:23],v[60:63]
TR a[2:3],v7,544
v_mul_f32 v213, v19, v213
M v[108:111],a[20:23],v[68:71],0
TR a[4:5],v4,128
v_mul_f32 v214, v19, v214
MC v[108:111],a[16:19],v[64:67]
TR a[6:7],v4,640
v_mul_f32 v215, v19, v215
M v[116:119],a[16:19],v[72:75],0
TR a[8:9],v6,128
CV v210,v212,v213
MC v[116:119],a[20:23],a[40:43]
TR a[10:11],v6,640
buffer_load_dwordx4 v12, s[16:19], s40 offen offset:1024 nt lds
M a[64:67],a[24:27],v[56:59],0
LG 7
TR a[12:13],v4,160
CV v211,v214,v215
MC a[64:67],a[28:31],v[60:63]
s_add_u32 m0, s34, 105664
TR a[14:15],v4,672
v_mul_f32 v216, v18, v216
M a[68:71],a[28:31],v[68:71],0
TR a[16:17],v6,160
v_mul_f32 v217, v18, v217
MC a[68:71],a[24:27],v[64:67]
TR a[18:19],v6,672
v_mul_f32 v218, v18, v218
M a[72:75],a[24:27],v[72:75],0
TR a[20:21],v5,128
v_mul_f32 v219, v18, v219
MC a[72:75],a[28:31],a[40:43]
TR a[22:23],v5,640
CV v216,v216,v217
M v[124:127],a[32:35],v[56:59],0
TR a[24:25],v7,128
CV v217,v218,v219
MC v[124:127],a[36:39],v[60:63]
LG 7
TR a[26:27],v7,640
v_mul_f32 v224, v19, v224
M v[132:135],a[36:39],v[68:71],0
TR a[28:29],v5,160
v_mul_f32 v225, v19, v225
MC v[132:135],a[32:35],v[64:67]
s_waitcnt vmcnt(4)
TR a[30:31],v5,672
buffer_load_dwordx4 v12, s[16:19], s40 offen offset:2048 nt lds
M a[76:79],v[52:55],v[56:59],0
s_add_u32 m0, s34, 105696
TR a[32:33],v7,160
v_mul_f32 v226, v19, v226
MC a[76:79],a[0:3],v[60:63]
TR a[34:35],v7,672
v_mul_f32 v227, v19, v227
M a[80:83],a[0:3],v[68:71],0
TR a[36:37],v4,256
CV v224,v224,v225
MC a[80:83],v[52:55],v[64:67]
TR a[38:39],v4,768
CV v225,v226,v227
M v[140:143],a[4:7],v[56:59],0
LG 7
ds_write_b128 v16, v[92:95] offset:0
MC v[140:143],a[8:11],v[60:63]
TR v[52:53],v6,256
v_mul_f32 v232, v20, v232
M v[148:151],a[8:11],v[68:71],0
TR v[54:55],v6,768
v_mul_f32 v233, v20, v233
MC v[148:151],a[4:7],v[64:67]
TR a[0:1],v4,288
v_mul_f32 v234, v20, v234
M v[156:159],a[4:7],v[72:75],0
TR a[2:3],v4,800
v_mul_f32 v235, v20, v235
MC v[156:159],a[8:11],a[40:43]
s_waitcnt vmcnt(4)
TR a[4:5],v6,288
buffer_load_dwordx4 v12, s[16:19], s40 offen offset:3072 nt lds
M a[84:87],a[12:15],v[56:59],0
s_add_u32 m0, s34, 33792
TR a[6:7],v6,800
CV v232,v232,v233
MC a[84:87],a[16:19],v[60:63]
LG 7
TR a[8:9],v5,256
CV v233,v234,v235
M a[88:91],a[16:19],v[68:71],0
s_xor_b32 s40, s63, 495616
TR a[10:11],v5,768
v_mul_f32 v220, v18, v220
MC a[88:91],a[12:15],v[64:67]
v_mul_f32 v221, v18, v221
v_mul_f32 v222, v18, v222
M a[92:95],a[12:15],v[72:75],0
TR a[12:13],v7,256
v_mul_f32 v223, v18, v223
MC a[92:95],a[16:19],a[40:43]
TR a[14:15],v7,768
CV v218,v220,v221
M v[164:167],a[20:23],v[56:59],0
TR a[16:17],v5,288
CV v219,v222,v223
MC v[164:167],a[24:27],v[60:63]
TR a[18:19],v5,800
v_mul_f32 v228, v19, v228
M v[172:175],a[24:27],v[68:71],0
v_exp_f32 v36, v36
MC v[172:175],a[20:23],v[64:67]
TR a[20:21],v7,288
v_mul_f32 v229, v19, v229
M a[96:99],a[28:31],v[56:59],0
s_waitcnt vmcnt(3) lgkmcnt(5)
TR a[22:23],v7,800
buffer_load_dwordx4 v12, s[12:15], s41 offen offset:0 nt lds
MC a[96:99],a[32:35],v[60:63]
s_add_u32 m0, s34, 33824
TR a[24:25],v4,384
v_mul_f32 v230, v19, v230
M a[100:103],a[32:35],v[68:71],0
TR a[26:27],v4,896
v_mul_f32 v231, v19, v231
MC a[100:103],a[28:31],v[64:67]
TR a[28:29],v6,384
CV v226,v228,v229
M v[180:183],a[36:39],v[56:59],0
v_exp_f32 v37, v37
MC v[180:183],v[52:55],v[60:63]
TR a[30:31],v6,896
CV v227,v230,v231
M v[188:191],v[52:55],v[68:71],0
TR a[32:33],v4,416
v_mul_f32 v236, v20, v236
MC v[188:191],a[36:39],v[64:67]
TR a[34:35],v4,928
v_mul_f32 v237, v20, v237
M v[196:199],a[36:39],v[72:75],0
TR a[36:37],v6,416
v_mul_f32 v238, v20, v238
MC v[196:199],v[52:55],a[40:43]
TR a[38:39],v6,928
v_mul_f32 v239, v20, v239
M a[104:107],a[0:3],v[56:59],0
LG 6
TR v[52:53],v5,384
buffer_load_dwordx4 v12, s[12:15], s41 offen offset:1024 nt lds
MC a[104:107],a[4:7],v[60:63]
s_add_u32 m0, s34, 33856
TR v[54:55],v5,896
CV v234,v236,v237
M a[108:111],a[4:7],v[68:71],0
CV v235,v238,v239
v_mul_f32 v240, v18, v240
MC a[108:111],a[0:3],v[64:67]
v_mul_f32 v241, v18, v241
v_mul_f32 v242, v18, v242
M a[112:115],a[0:3],v[72:75],0
TR a[0:1],v7,384
v_mul_f32 v243, v18, v243
MC a[112:115],a[4:7],a[40:43]
TR a[2:3],v7,896
CV v240,v240,v241
M v[204:207],a[8:11],v[56:59],0
TR a[4:5],v5,416
CV v241,v242,v243
MC v[204:207],a[12:15],v[60:63]
TR a[6:7],v5,928
v_mul_f32 v248, v19, v248
M v[212:215],a[12:15],v[68:71],0
v_exp_f32 v38, v38
MC v[212:215],a[8:11],v[64:67]
TR a[8:9],v7,416
v_mul_f32 v249, v19, v249
M a[116:119],a[16:19],v[56:59],0
s_waitcnt vmcnt(4)
TR a[10:11],v7,928
buffer_load_dwordx4 v12, s[12:15], s41 offen offset:2048 nt lds
MC a[116:119],a[20:23],v[60:63]
s_add_u32 m0, s34, 33888
v_mul_f32 v250, v19, v250
v_mul_f32 v251, v19, v251
M a[120:123],a[20:23],v[68:71],0
CV v248,v248,v249
v_mul_f32 v244, v18, v244
MC a[120:123],a[16:19],v[64:67]
v_exp_f32 v39, v39
M v[220:223],a[24:27],v[56:59],0
LG 3
CV v249,v250,v251
v_mul_f32 v245, v18, v245
MC v[220:223],a[28:31],v[60:63]
s_barrier
v_mul_f32 v246, v18, v246
v_mul_f32 v247, v18, v247
M v[228:231],a[28:31],v[68:71],0
RD a[12:15],v0,0
CV v242,v244,v245
MC v[228:231],a[24:27],v[64:67]
s_waitcnt vmcnt(4)
buffer_load_dwordx4 v12, s[12:15], s41 offen offset:3072 nt lds
M v[236:239],a[24:27],v[72:75],0
s_add_u32 m0, s34, 38016
RD a[16:19],v1,0
CV v243,v246,v247
MC v[236:239],a[28:31],a[40:43]
s_xor_b32 s41, s63, 327680
RD a[20:23],v0,128
v_mul_f32 v252, v19, v252
M a[124:127],a[32:35],v[56:59],0
RD a[24:27],v1,128
v_mul_f32 v253, v19, v253
MC a[124:127],a[36:39],v[60:63]
RD a[28:31],v0,256
v_mul_f32 v254, v19, v254
M a[128:131],a[36:39],v[68:71],0
RD a[44:47],v17,0
v_mul_f32 v255, v19, v255
MC a[128:131],a[32:35],v[64:67]
CV v250,v252,v253
CV v251,v254,v255
M a[132:135],a[32:35],v[72:75],0
RD a[32:35],v1,256
CV v80,v36,v37
MC a[132:135],a[36:39],a[40:43]
RD a[36:39],v0,384
CV v81,v38,v39
M v[244:247],v[52:55],v[56:59],0
v_exp_f32 v40, v40
MC v[244:247],a[0:3],v[60:63]
v_exp_f32 v41, v41
M v[252:255],a[0:3],v[68:71],0
s_waitcnt vmcnt(3)
buffer_load_dwordx4 v12, s[12:15], s40 offen offset:0 nt lds
MC v[252:255],v[52:55],v[64:67]
LG 3
RD v[52:55],v1,384
CV v88,v40,v41
M a[136:139],a[4:7],v[56:59],0
s_add_u32 m0, s34, 38048
v_exp_f32 v42, v42
MC a[136:139],a[8:11],v[60:63]
v_exp_f32 v43, v43
M a[140:143],a[8:11],v[68:71],0
RD a[0:3],v0,512
CV v89,v42,v43
MC a[140:143],a[4:7],v[64:67]
v_exp_f32 v44, v44
M v[36:39],a[12:15],a[160:163],v[32:35]
v_exp_f32 v45, v45
MC v[36:39],a[16:19],a[164:167]
v_exp_f32 v46, v46
MC v[36:39],a[20:23],a[168:171]
v_exp_f32 v47, v47
MC v[36:39],a[24:27],a[172:175]
v_exp_f32 v48, v48
MC v[36:39],a[28:31],a[176:179]
LG 1
buffer_load_dwordx4 v12, s[12:15], s40 offen offset:1024 nt lds
MC v[36:39],a[32:35],a[180:183]
s_add_u32 m0, s34, 38080
v_exp_f32 v49, v49
MC v[36:39],a[36:39],a[184:187]
v_exp_f32 v50, v50
MC v[36:39],v[52:55],a[188:191]
v_exp_f32 v51, v51
M v[40:43],a[12:15],a[192:195],v[24:27]
RD a[8:11],v0,640
CV v82,v44,v45
MC v[40:43],a[16:19],a[196:199]
RD a[4:7],v1,512
CV v83,v46,v47
MC v[40:43],a[20:23],a[200:203]
v_exp_f32 v36, v36
MC v[40:43],a[24:27],a[204:207]
CV v90,v48,v49
CV v91,v50,v51
MC v[40:43],a[28:31],a[208:211]
v_exp_f32 v37, v37
MC v[40:43],a[32:35],a[212:215]
v_exp_f32 v38, v38
MC v[40:43],a[36:39],a[216:219]
s_waitcnt vmcnt(4)
buffer_load_dwordx4 v12, s[12:15], s40 offen offset:2048 nt lds
MC v[40:43],v[52:55],a[220:223]
s_add_u32 m0, s34, 38112
v_exp_f32 v39, v39
M v[44:47],a[12:15],a[224:227],v[28:31]
Y_pg14:
s_cbranch_execz Y_wr2
RD a[12:15],v1,640
CV v72,v36,v37
MC v[44:47],a[16:19],a[228:231]
RD a[16:19],v0,768
CV v73,v38,v39
MC v[44:47],a[20:23],a[232:235]
RD a[20:23],v1,768
v_lshrrev_b32 v23, 9, v15
MC v[44:47],a[24:27],a[236:239]
RD a[24:27],v0,896
v_lshlrev_b32 v23, 7, v23
MC v[44:47],a[28:31],a[240:243]
RD a[28:31],v1,896
v_add_u32 v23, 27000, v23
MC v[44:47],a[32:35],a[244:247]
v_exp_f32 v40, v40
MC v[44:47],a[36:39],a[248:251]
v_exp_f32 v41, v41
MC v[44:47],v[52:55],a[252:255]
LG 5
v_exp_f32 v42, v42
M v[48:51],a[0:3],a[160:163],v[32:35]
s_waitcnt vmcnt(4)
buffer_load_dwordx4 v12, s[12:15], s40 offen offset:3072 nt lds
MC v[48:51],a[4:7],a[164:167]
s_add_u32 m0, s34, 67584
v_exp_f32 v43, v43
MC v[48:51],a[8:11],a[168:171]
LG 2
RD a[32:35],v2,0
CV v56,v40,v41
MC v[48:51],a[12:15],a[172:175]
s_xor_b32 s40, s63, 462848
RD a[36:39],v3,0
CV v57,v42,v43
MC v[48:51],a[16:19],a[176:179]
RD v[52:55],v2,128
v_and_b32 v22, 16, v21
MC v[48:51],a[20:23],a[180:183]
LG 3
v_exp_f32 v44, v44
MC v[48:51],a[24:27],a[184:187]
v_exp_f32 v45, v45
MC v[48:51],a[28:31],a[188:191]
v_exp_f32 v46, v46
M v[36:39],a[0:3],a[192:195],v[24:27]
v_exp_f32 v47, v47
MC v[36:39],a[4:7],a[196:199]
CV v64,v44,v45
CV v65,v46,v47
MC v[36:39],a[8:11],a[200:203]
ds_write_b128 v16, v[232:235] offset:5120
MC v[36:39],a[12:15],a[204:207]
s_waitcnt vmcnt(4)
buffer_load_dwordx4 v12, s[16:19], s41 offen offset:0 nt lds
MC v[36:39],a[16:19],a[208:211]
s_add_u32 m0, s34, 67616
v_exp_f32 v48, v48
MC v[36:39],a[20:23],a[212:215]
v_exp_f32 v49, v49
MC v[36:39],a[24:27],a[216:219]
v_exp_f32 v50, v50
MC v[36:39],a[28:31],a[220:223]
v_exp_f32 v51, v51
M v[40:43],a[0:3],a[224:227],v[28:31]
RD a[0:3],v3,128
CV v74,v48,v49
MC v[40:43],a[4:7],a[228:231]
RD a[4:7],v2,256
CV v75,v50,v51
MC v[40:43],a[8:11],a[232:235]
RD a[8:11],v3,256
MC v[40:43],a[12:15],a[236:239]
RD a[12:15],v2,384
MC v[40:43],a[16:19],a[240:243]
RD a[16:19],v3,384
MC v[40:43],a[20:23],a[244:247]
s_waitcnt vmcnt(4)
buffer_load_dwordx4 v12, s[16:19], s41 offen offset:1024 nt lds
MC v[40:43],a[24:27],a[248:251]
s_add_u32 m0, s34, 67648
v_exp_f32 v36, v36
MC v[40:43],a[28:31],a[252:255]
LG 5
v_exp_f32 v37, v37
M v[44:47],a[32:35],a[192:195],v[24:27]
v_exp_f32 v38, v38
MC v[44:47],a[36:39],a[196:199]
v_exp_f32 v39, v39
MC v[44:47],v[52:55],a[200:203]
LG 2
RD a[20:23],v2,512
CV v58,v36,v37
MC v[44:47],a[0:3],a[204:207]
RD a[24:27],v3,512
CV v59,v38,v39
MC v[44:47],a[4:7],a[208:211]
RD a[28:31],v2,640
MC v[44:47],a[8:11],a[212:215]
LG 3
v_exp_f32 v40, v40
MC v[44:47],a[12:15],a[216:219]
v_exp_f32 v41, v41
MC v[44:47],a[16:19],a[220:223]
s_waitcnt vmcnt(4)
buffer_load_dwordx4 v12, s[16:19], s41 offen offset:2048 nt lds
M v[48:51],a[32:35],a[224:227],v[28:31]
s_add_u32 m0, s34, 67680
RD a[32:35],v3,640
CV v66,v40,v41
MC v[48:51],a[36:39],a[228:231]
RD a[36:39],v2,768
MC v[48:51],v[52:55],a[232:235]
RD v[52:55],v3,768
MC v[48:51],a[0:3],a[236:239]
RD a[0:3],v2,896
MC v[48:51],a[4:7],a[240:243]
RD a[4:7],v3,896
MC v[48:51],a[8:11],a[244:247]
v_exp_f32 v42, v42
MC v[48:51],a[12:15],a[248:251]
v_exp_f32 v43, v43
MC v[48:51],a[16:19],a[252:255]
LG 5
CV v67,v42,v43
s_nop 0
M v[36:39],a[20:23],a[192:195],v[24:27]
ds_write_b128 v16, v[72:75] offset:1024
MC v[36:39],a[24:27],a[196:199]
v_exp_f32 v44, v44
MC v[36:39],a[28:31],a[200:203]
s_waitcnt vmcnt(4) lgkmcnt(3)
buffer_load_dwordx4 v12, s[16:19], s41 offen offset:3072 nt lds
MC v[36:39],a[32:35],a[204:207]
s_barrier
MC v[36:39],a[36:39],a[208:211]
s_add_u32 m0, s34, 71808
TR a[8:9],v4,33792
s_xor_b32 s41, s63, 393216
MC v[36:39],v[52:55],a[212:215]
LG 2
TR a[10:11],v4,34304
MC v[36:39],a[0:3],a[216:219]
TR a[12:13],v6,33792
MC v[36:39],a[4:7],a[220:223]
TR a[14:15],v6,34304
s_nop 0
M v[40:43],a[20:23],a[224:227],v[28:31]
v_exp_f32 v45, v45
MC v[40:43],a[24:27],a[228:231]
TR a[16:17],v4,33824
CV v60,v44,v45
MC v[40:43],a[28:31],a[232:235]
TR a[18:19],v4,34336
MC v[40:43],a[32:35],a[236:239]
TR a[20:21],v6,33824
MC v[40:43],a[36:39],a[240:243]
s_waitcnt vmcnt(4)
buffer_load_dwordx4 v12, s[16:19], s40 offen offset:0 nt lds
MC v[40:43],v[52:55],a[244:247]
s_add_u32 m0, s34, 71840
TR a[22:23],v6,34336
MC v[40:43],a[0:3],a[248:251]
v_exp_f32 v46, v46
MC v[40:43],a[4:7],a[252:255]
TR a[24:25],v5,33792
s_nop 0
MC a[60:63],a[48:51],v[76:79]
TR a[26:27],v5,34304
s_nop 0
MC a[60:63],a[48:51],v[80:83]
TR a[28:29],v7,33792
MC a[60:63],a[52:55],v[84:87]
TR a[30:31],v7,34304
MC a[60:63],a[52:55],v[88:91]
TR a[32:33],v5,33824
MC a[60:63],a[56:59],v[92:95]
LG 6
TR a[34:35],v5,34336
MC a[60:63],a[56:59],a[44:47]
TR a[36:37],v7,33824
MC v[100:103],a[8:11],v[76:79]
s_waitcnt vmcnt(4)
buffer_load_dwordx4 v12, s[16:19], s40 offen offset:1024 nt lds
MC v[100:103],a[12:15],v[80:83]
s_add_u32 m0, s34, 71872
TR a[38:39],v7,34336
MC v[108:111],a[12:15],v[88:91]
TR v[52:53],v4,33920
MC v[108:111],a[8:11],v[84:87]
TR v[54:55],v4,34432
MC v[116:119],a[8:11],v[92:95]
TR a[0:1],v6,33920
MC v[116:119],a[12:15],a[44:47]
TR a[2:3],v6,34432
MC a[64:67],a[16:19],v[76:79]
LG 6
v_exp_f32 v47, v47
MC a[64:67],a[20:23],v[80:83]
TR a[4:5],v4,33952
CV v61,v46,v47
MC a[68:71],a[20:23],v[88:91]
TR a[6:7],v4,34464
MC a[68:71],a[16:19],v[84:87]
TR a[8:9],v6,33952
MC a[72:75],a[16:19],v[92:95]
s_waitcnt vmcnt(4)
buffer_load_dwordx4 v12, s[16:19], s40 offen offset:2048 nt lds
MC a[72:75],a[20:23],a[44:47]
s_add_u32 m0, s34, 71904
TR a[10:11],v6,34464
MC v[124:127],a[24:27],v[76:79]
RD a[144:147],v17,2048
MC v[124:127],a[28:31],v[80:83]
TR a[12:13],v5,33920
MC v[132:135],a[28:31],v[88:91]
TR a[14:15],v5,34432
MC v[132:135],a[24:27],v[84:87]
TR a[16:17],v7,33920
MC a[76:79],a[32:35],v[76:79]
LG 6
TR a[18:19],v7,34432
MC a[76:79],a[36:39],v[80:83]
TR a[20:21],v5,33952
MC a[80:83],a[36:39],v[88:91]
TR a[22:23],v5,34464
MC a[80:83],a[32:35],v[84:87]
TR a[24:25],v7,33952
MC v[140:143],v[52:55],v[76:79]
TR a[26:27],v7,34464
MC v[140:143],a[0:3],v[80:83]
s_waitcnt vmcnt(4)
buffer_load_dwordx4 v12, s[16:19], s40 offen offset:3072 nt lds
MC v[148:151],a[0:3],v[88:91]
s_add_u32 m0, s34, 0
TR a[28:29],v4,34048
s_xor_b32 s40, s63, 266240
MC v[148:151],v[52:55],v[84:87]
TR a[30:31],v4,34560
MC v[156:159],v[52:55],v[92:95]
TR a[32:33],v6,34048
MC v[156:159],a[0:3],a[44:47]
LG 6
TR a[34:35],v6,34560
MC a[84:87],a[4:7],v[76:79]
RD a[148:151],v17,3072
MC a[84:87],a[8:11],v[80:83]
TR a[36:37],v4,34080
MC a[88:91],a[8:11],v[88:91]
TR a[38:39],v4,34592
MC a[88:91],a[4:7],v[84:87]
TR v[52:53],v6,34080
MC a[92:95],a[4:7],v[92:95]
TR v[54:55],v6,34592
MC a[92:95],a[8:11],a[44:47]
s_waitcnt vmcnt(4)
buffer_load_dwordx4 v12, s[12:15], s41 offen offset:0 nt lds
MC v[164:167],a[12:15],v[76:79]
s_add_u32 m0, s34, 32
RD a[152:155],v17,4096
MC v[164:167],a[16:19],v[80:83]
TR a[0:1],v5,34048
MC v[172:175],a[16:19],v[88:91]
LG 6
TR a[2:3],v5,34560
MC v[172:175],a[12:15],v[84:87]
TR a[4:5],v7,34048
MC a[96:99],a[20:23],v[76:79]
TR a[6:7],v7,34560
MC a[96:99],a[24:27],v[80:83]
TR a[8:9],v5,34080
MC a[100:103],a[24:27],v[88:91]
TR a[10:11],v5,34592
MC a[100:103],a[20:23],v[84:87]
TR a[12:13],v7,34080
MC v[180:183],a[28:31],v[76:79]
TR a[14:15],v7,34592
MC v[180:183],a[32:35],v[80:83]
s_waitcnt vmcnt(4)
buffer_load_dwordx4 v12, s[12:15], s41 offen offset:1024 nt lds
MC v[188:191],a[32:35],v[88:91]
s_add_u32 m0, s34, 64
TR a[16:17],v4,34176
MC v[188:191],a[28:31],v[84:87]
LG 6
TR a[18:19],v4,34688
MC v[196:199],a[28:31],v[92:95]
TR a[20:21],v6,34176
MC v[196:199],a[32:35],a[44:47]
TR a[22:23],v6,34688
MC a[104:107],a[36:39],v[76:79]
RD a[156:159],v17,5120
MC a[104:107],v[52:55],v[80:83]
TR a[24:25],v4,34208
MC a[108:111],v[52:55],v[88:91]
TR a[26:27],v4,34720
MC a[108:111],a[36:39],v[84:87]
TR a[28:29],v6,34208
MC a[112:115],a[36:39],v[92:95]
TR a[30:31],v6,34720
MC a[112:115],v[52:55],a[44:47]
v_exp_f32 v48, v48
MC v[204:207],a[0:3],v[76:79]
s_waitcnt vmcnt(4) lgkmcnt(6)
buffer_load_dwordx4 v12, s[12:15], s41 offen offset:2048 nt lds
MC v[204:207],a[4:7],v[80:83]
s_add_u32 m0, s34, 96
TR a[32:33],v5,34176
MC v[212:215],a[4:7],v[88:91]
TR a[34:35],v5,34688
MC v[212:215],a[0:3],v[84:87]
TR a[36:37],v7,34176
MC a[116:119],a[8:11],v[76:79]
TR a[38:39],v7,34688
MC a[116:119],a[12:15],v[80:83]
TR v[52:53],v5,34208
MC a[120:123],a[12:15],v[88:91]
TR v[54:55],v5,34720
MC a[120:123],a[8:11],v[84:87]
TR a[0:1],v7,34208
MC v[220:223],a[16:19],v[76:79]
LG 7
TR a[2:3],v7,34720
MC v[220:223],a[20:23],v[80:83]
s_barrier
MC v[228:231],a[20:23],v[88:91]
s_waitcnt vmcnt(4)
buffer_load_dwordx4 v12, s[12:15], s41 offen offset:3072 nt lds
MC v[228:231],a[16:19],v[84:87]
s_add_u32 m0, s34, 4224
RD a[4:7],v0,33792
s_xor_b32 s41, s63, 360448
MC v[236:239],a[16:19],v[92:95]
RD a[8:11],v1,33792
MC v[236:239],a[20:23],a[44:47]
RD a[12:15],v0,33920
MC a[124:127],a[24:27],v[76:79]
RD a[16:19],v1,33920
MC a[124:127],a[28:31],v[80:83]
RD a[20:23],v0,34048
MC a[128:131],a[28:31],v[88:91]
v_exp_f32 v49, v49
MC a[128:131],a[24:27],v[84:87]
v_exp_f32 v50, v50
MC a[132:135],a[24:27],v[92:95]
RD a[24:27],v1,34048
CV v68,v48,v49
MC a[132:135],a[28:31],a[44:47]
LG 5
RD a[28:31],v0,34176
MC v[244:247],a[32:35],v[76:79]
s_waitcnt vmcnt(4)
buffer_load_dwordx4 v12, s[12:15], s40 offen offset:0 nt lds
MC v[244:247],a[36:39],v[80:83]
s_add_u32 m0, s34, 4256
v_exp_f32 v51, v51
MC v[252:255],a[36:39],v[88:91]
RD a[36:39],v0,34304
CV v69,v50,v51
MC v[252:255],a[32:35],v[84:87]
RD a[32:35],v1,34176
MC a[136:139],v[52:55],v[76:79]
v_exp_f32 v36, v36
MC a[136:139],a[0:3],v[80:83]
v_exp_f32 v37, v37
MC a[140:143],a[0:3],v[88:91]
v_exp_f32 v38, v38
MC a[140:143],v[52:55],v[84:87]
v_exp_f32 v39, v39
M v[44:47],a[4:7],a[160:163],v[32:35]
LG 2
v_exp_f32 v40, v40
MC v[44:47],a[8:11],a[164:167]
v_exp_f32 v41, v41
MC v[44:47],a[12:15],a[168:171]
s_waitcnt vmcnt(4)
buffer_load_dwordx4 v12, s[12:15], s40 offen offset:1024 nt lds
MC v[44:47],a[16:19],a[172:175]
s_add_u32 m0, s34, 4288
v_exp_f32 v42, v42
MC v[44:47],a[20:23],a[176:179]
v_exp_f32 v43, v43
MC v[44:47],a[24:27],a[180:183]
RD a[0:3],v0,34432
CV v62,v36,v37
MC v[44:47],a[28:31],a[184:187]
LG 1
RD v[52:55],v1,34304
CV v63,v38,v39
MC v[44:47],a[32:35],a[188:191]
RD a[40:43],v17,1024
CV v70,v40,v41
M v[48:51],a[4:7],a[192:195],v[24:27]
CV v71,v42,v43
s_nop 0
MC v[48:51],a[8:11],a[196:199]
s_nop 2
MC v[48:51],a[12:15],a[200:203]
v_exp_f32 v44, v44
MC v[48:51],a[16:19],a[204:207]
v_exp_f32 v45, v45
MC v[48:51],a[20:23],a[208:211]
v_exp_f32 v46, v46
MC v[48:51],a[24:27],a[212:215]
s_waitcnt vmcnt(4)
buffer_load_dwordx4 v12, s[12:15], s40 offen offset:2048 nt lds
MC v[48:51],a[28:31],a[216:219]
s_add_u32 m0, s34, 4320
v_exp_f32 v47, v47
MC v[48:51],a[32:35],a[220:223]
CV v92,v44,v45
CV v93,v46,v47
M v[36:39],a[4:7],a[224:227],v[28:31]
RD a[4:7],v1,34432
s_nop 0
MC v[36:39],a[8:11],a[228:231]
RD a[8:11],v0,34560
MC v[36:39],a[12:15],a[232:235]
RD a[12:15],v1,34560
MC v[36:39],a[16:19],a[236:239]
RD a[16:19],v0,34688
MC v[36:39],a[20:23],a[240:243]
s_mov_b64 exec, 0
s_cmp_eq_u32 s32, 0
s_cbranch_scc1 Y_pg17
s_cmp_eq_u32 s32, 1
s_cbranch_scc1 Y_pg18
s_cmp_eq_u32 s32, 2
s_cbranch_scc1 Y_pg19
s_branch Y_pg20
Y_wr3:
s_mov_b64 exec, -1
RD a[20:23],v1,34688
MC v[36:39],a[24:27],a[244:247]
v_exp_f32 v48, v48
MC v[36:39],a[28:31],a[248:251]
v_exp_f32 v49, v49
MC v[36:39],a[32:35],a[252:255]
s_waitcnt vmcnt(4)
buffer_load_dwordx4 v12, s[12:15], s40 offen offset:3072 nt lds
M v[40:43],a[36:39],a[160:163],v[32:35]
LG 4
v_exp_f32 v50, v50
MC v[40:43],v[52:55],a[164:167]
s_add_u32 m0, s34, 101376
v_exp_f32 v51, v51
MC v[40:43],a[0:3],a[168:171]
s_xor_b32 s40, s63, 495616
RD a[24:27],v2,33792
CV v76,v48,v49
MC v[40:43],a[4:7],a[172:175]
LG 2
RD a[28:31],v3,33792
CV v77,v50,v51
MC v[40:43],a[8:11],a[176:179]
s_getpc_b64 s[54:55]
RD a[32:35],v2,33920
MC v[40:43],a[12:15],a[180:183]
v_exp_f32 v36, v36
MC v[40:43],a[16:19],a[184:187]
LG 3
global_load_dword v14, v23, s[54:55]
MC v[40:43],a[20:23],a[188:191]
v_exp_f32 v37, v37
M v[44:47],a[36:39],a[192:195],v[24:27]
v_exp_f32 v38, v38
MC v[44:47],v[52:55],a[196:199]
v_exp_f32 v39, v39
MC v[44:47],a[0:3],a[200:203]
s_waitcnt vmcnt(5)
buffer_load_dwordx4 v12, s[16:19], s41 offen offset:0 nt lds
MC v[44:47],a[4:7],a[204:207]
s_add_u32 m0, s34, 101408
v_exp_f32 v40, v40
MC v[44:47],a[8:11],a[208:211]
v_exp_f32 v41, v41
MC v[44:47],a[12:15],a[212:215]
CV v84,v36,v37
CV v85,v38,v39
MC v[44:47],a[16:19],a[216:219]
v_exp_f32 v42, v42
MC v[44:47],a[20:23],a[220:223]
v_exp_f32 v43, v43
M v[48:51],a[36:39],a[224:227],v[28:31]
RD a[36:39],v3,33920
CV v94,v40,v41
MC v[48:51],v[52:55],a[228:231]
RD v[52:55],v2,34048
CV v95,v42,v43
MC v[48:51],a[0:3],a[232:235]
RD a[0:3],v3,34048
v_bfe_u32 v23, v21, 5, 1
MC v[48:51],a[4:7],a[236:239]
RD a[4:7],v2,34176
v_lshl_add_u32 v22, v23, 3, v22
MC v[48:51],a[8:11],a[240:243]
RD a[8:11],v3,34176
v_bfe_u32 v23, v21, 3, 1
MC v[48:51],a[12:15],a[244:247]
s_waitcnt vmcnt(5)
buffer_load_dwordx4 v12, s[16:19], s41 offen offset:1024 nt lds
MC v[48:51],a[16:19],a[248:251]
s_add_u32 m0, s34, 101440
v_exp_f32 v44, v44
MC v[48:51],a[20:23],a[252:255]
LG 5
v_exp_f32 v45, v45
M v[36:39],a[24:27],a[192:195],v[24:27]
v_exp_f32 v46, v46
MC v[36:39],a[28:31],a[196:199]
v_exp_f32 v47, v47
MC v[36:39],a[32:35],a[200:203]
LG 2
RD a[12:15],v2,34304
CV v78,v44,v45
MC v[36:39],a[36:39],a[204:207]
RD a[16:19],v3,34304
CV v79,v46,v47
MC v[36:39],v[52:55],a[208:211]
RD a[20:23],v2,34432
v_add_u32 v22, v22, v23
MC v[36:39],a[0:3],a[212:215]
LG 3
v_exp_f32 v48, v48
MC v[36:39],a[4:7],a[216:219]
s_waitcnt vmcnt(5)
buffer_load_dwordx4 v12, s[16:19], s41 offen offset:2048 nt lds
MC v[36:39],a[8:11],a[220:223]
s_add_u32 m0, s34, 101472
v_exp_f32 v49, v49
M v[40:43],a[24:27],a[224:227],v[28:31]
RD a[24:27],v3,34432
CV v86,v48,v49
MC v[40:43],a[28:31],a[228:231]
RD a[28:31],v2,34560
v_lshrrev_b32 v23, 9, v15
MC v[40:43],a[32:35],a[232:235]
RD a[32:35],v3,34560
v_lshlrev_b32 v23, 7, v23
MC v[40:43],a[36:39],a[236:239]
RD a[36:39],v2,34688
v_add_u32 v23, 27000, v23
MC v[40:43],v[52:55],a[240:243]
RD v[52:55],v3,34688
v_and_b32 v21, 7, v21
MC v[40:43],a[0:3],a[244:247]
v_exp_f32 v50, v50
MC v[40:43],a[4:7],a[248:251]
v_exp_f32 v51, v51
MC v[40:43],a[8:11],a[252:255]
LG 5
CV v87,v50,v51
v_lshl_add_u32 v22, s32, 1, v22
M v[44:47],a[12:15],a[192:195],v[24:27]
s_waitcnt vmcnt(5)
buffer_load_dwordx4 v12, s[16:19], s41 offen offset:3072 nt lds
MC v[44:47],a[16:19],a[196:199]
s_barrier
v_mul_u32_u24 v22, 896, v22
MC v[44:47],a[20:23],a[200:203]
LG 2
TR a[0:1],v4,0
v_lshl_add_u32 v13, v21, 4, v22
MC v[44:47],a[24:27],a[204:207]
s_add_u32 m0, s34, 105600
TR a[2:3],v4,512
v_bfe_u32 v21, v12, 4, 6
MC v[44:47],a[28:31],a[208:211]
s_xor_b32 s41, s63, 425984
TR a[4:5],v6,0
MC v[44:47],a[32:35],a[212:215]
LG 3
TR a[6:7],v6,512
MC v[44:47],a[36:39],a[216:219]
TR a[8:9],v4,32
MC v[44:47],v[52:55],a[220:223]
TR a[10:11],v4,544
s_nop 0
M v[48:51],a[12:15],a[224:227],v[28:31]
TR a[12:13],v6,32
s_nop 0
MC v[48:51],a[16:19],a[228:231]
Y_pg15:
s_cbranch_execz Y_wr2
TR a[14:15],v6,544
MC v[48:51],a[20:23],a[232:235]
s_waitcnt vmcnt(5)
buffer_load_dwordx4 v12, s[16:19], s40 offen offset:0 nt lds
MC v[48:51],a[24:27],a[236:239]
s_add_u32 m0, s34, 105632
TR a[16:17],v5,0
MC v[48:51],a[28:31],a[240:243]
TR a[18:19],v5,512
MC v[48:51],a[32:35],a[244:247]
TR a[20:21],v7,0
MC v[48:51],a[36:39],a[248:251]
TR a[22:23],v7,512
MC v[48:51],v[52:55],a[252:255]
TR a[24:25],v5,32
s_nop 0
MC a[60:63],a[48:51],v[56:59]
TR a[26:27],v5,544
s_nop 0
MC a[60:63],a[48:51],v[60:63]
LG 6
TR a[28:29],v7,32
MC a[60:63],a[52:55],v[64:67]
TR a[30:31],v7,544
MC a[60:63],a[52:55],v[68:71]
TR a[32:33],v4,128
MC a[60:63],a[56:59],v[72:75]
TR a[34:35],v4,640
MC a[60:63],a[56:59],a[40:43]
s_waitcnt vmcnt(4)
buffer_load_dwordx4 v12, s[16:19], s40 offen offset:1024 nt lds
MC v[100:103],a[0:3],v[56:59]
s_add_u32 m0, s34, 105664
TR a[36:37],v6,128
MC v[100:103],a[4:7],v[60:63]
TR a[38:39],v6,640
MC v[108:111],a[4:7],v[68:71]
TR v[52:53],v4,160
MC v[108:111],a[0:3],v[64:67]
TR v[54:55],v4,672
MC v[116:119],a[0:3],v[72:75]
LG 6
TR a[0:1],v6,160
MC v[116:119],a[4:7],a[40:43]
TR a[2:3],v6,672
MC a[64:67],a[8:11],v[56:59]
TR a[4:5],v5,128
MC a[64:67],a[12:15],v[60:63]
TR a[6:7],v5,640
MC a[68:71],a[12:15],v[68:71]
ds_write_b128 v16, v[92:95] offset:0
MC a[68:71],a[8:11],v[64:67]
s_waitcnt vmcnt(4)
buffer_load_dwordx4 v12, s[16:19], s40 offen offset:2048 nt lds
MC a[72:75],a[8:11],v[72:75]
s_add_u32 m0, s34, 105696
TR a[8:9],v7,128
MC a[72:75],a[12:15],a[40:43]
TR a[10:11],v7,640
MC v[124:127],a[16:19],v[56:59]
TR a[12:13],v5,160
MC v[124:127],a[20:23],v[60:63]
LG 6
TR a[14:15],v5,672
MC v[132:135],a[20:23],v[68:71]
TR a[20:21],v4,256
MC v[132:135],a[16:19],v[64:67]
TR a[16:17],v7,160
MC a[76:79],a[24:27],v[56:59]
TR a[18:19],v7,672
MC a[76:79],a[28:31],v[60:63]
TR a[22:23],v4,768
MC a[80:83],a[28:31],v[68:71]
TR a[28:29],v4,288
MC a[80:83],a[24:27],v[64:67]
s_waitcnt vmcnt(4)
buffer_load_dwordx4 v12, s[16:19], s40 offen offset:3072 nt lds
MC v[140:143],a[32:35],v[56:59]
s_add_u32 m0, s34, 33792
TR a[24:25],v6,256
s_xor_b32 s40, s63, 299008
MC v[140:143],a[36:39],v[60:63]
TR a[26:27],v6,768
MC v[148:151],a[36:39],v[68:71]
LG 6
TR a[30:31],v4,800
MC v[148:151],a[32:35],v[64:67]
v_exp_f32 v36, v36
MC v[156:159],a[32:35],v[72:75]
TR a[32:33],v6,288
MC v[156:159],a[36:39],a[40:43]
TR a[34:35],v6,800
MC a[84:87],v[52:55],v[56:59]
TR a[36:37],v5,256
MC a[84:87],a[0:3],v[60:63]
TR a[38:39],v5,768
MC a[88:91],a[0:3],v[68:71]
v_exp_f32 v37, v37
MC a[88:91],v[52:55],v[64:67]
s_waitcnt vmcnt(4)
buffer_load_dwordx4 v12, s[12:15], s41 offen offset:0 nt lds
MC a[92:95],v[52:55],v[72:75]
s_add_u32 m0, s34, 33824
TR v[52:53],v7,256
CV v80,v36,v37
MC a[92:95],a[0:3],a[40:43]
TR v[54:55],v7,768
MC v[164:167],a[4:7],v[56:59]
TR a[0:1],v5,288
MC v[164:167],a[8:11],v[60:63]
LG 5
TR a[2:3],v5,800
MC v[172:175],a[8:11],v[68:71]
TR a[8:9],v4,384
MC v[172:175],a[4:7],v[64:67]
TR a[4:5],v7,288
MC a[96:99],a[12:15],v[56:59]
TR a[6:7],v7,800
MC a[96:99],a[16:19],v[60:63]
TR a[10:11],v4,896
MC a[100:103],a[16:19],v[68:71]
TR a[16:17],v4,416
MC a[100:103],a[12:15],v[64:67]
TR a[12:13],v6,384
MC v[180:183],a[20:23],v[56:59]
TR a[14:15],v6,896
MC v[180:183],a[24:27],v[60:63]
s_waitcnt vmcnt(4)
buffer_load_dwordx4 v12, s[12:15], s41 offen offset:1024 nt lds
MC v[188:191],a[24:27],v[68:71]
s_add_u32 m0, s34, 33856
TR a[18:19],v4,928
MC v[188:191],a[20:23],v[64:67]
v_exp_f32 v38, v38
MC v[196:199],a[20:23],v[72:75]
LG 5
TR a[20:21],v6,416
MC v[196:199],a[24:27],a[40:43]
TR a[22:23],v6,928
MC a[104:107],a[28:31],v[56:59]
TR a[24:25],v5,384
MC a[104:107],a[32:35],v[60:63]
TR a[26:27],v5,896
MC a[108:111],a[32:35],v[68:71]
v_exp_f32 v39, v39
MC a[108:111],a[28:31],v[64:67]
CV v81,v38,v39
MC a[112:115],a[28:31],v[72:75]
TR a[28:29],v7,384
MC a[112:115],a[32:35],a[40:43]
TR a[30:31],v7,896
MC v[204:207],a[36:39],v[56:59]
TR a[32:33],v5,416
MC v[204:207],v[52:55],v[60:63]
s_waitcnt vmcnt(4)
buffer_load_dwordx4 v12, s[12:15], s41 offen offset:2048 nt lds
MC v[212:215],v[52:55],v[68:71]
s_add_u32 m0, s34, 33888
TR a[34:35],v5,928
MC v[212:215],a[36:39],v[64:67]
TR a[36:37],v7,416
MC a[116:119],a[0:3],v[56:59]
LG 5
TR a[38:39],v7,928
MC a[116:119],a[4:7],v[60:63]
v_exp_f32 v40, v40
MC a[120:123],a[4:7],v[68:71]
v_exp_f32 v41, v41
MC a[120:123],a[0:3],v[64:67]
v_exp_f32 v42, v42
MC v[220:223],a[8:11],v[56:59]
v_exp_f32 v43, v43
MC v[220:223],a[12:15],v[60:63]
CV v88,v40,v41
CV v89,v42,v43
MC v[228:231],a[12:15],v[68:71]
s_barrier
MC v[228:231],a[8:11],v[64:67]
RD v[52:55],v0,0
MC v[236:239],a[8:11],v[72:75]
RD a[0:3],v1,0
MC v[236:239],a[12:15],a[40:43]
s_waitcnt vmcnt(4)
buffer_load_dwordx4 v12, s[12:15], s41 offen offset:3072 nt lds
MC a[124:127],a[16:19],v[56:59]
s_add_u32 m0, s34, 38016
RD a[4:7],v0,128
s_xor_b32 s41, s63, 393216
MC a[124:127],a[20:23],v[60:63]
RD a[8:11],v1,128
MC a[128:131],a[20:23],v[68:71]
RD a[12:15],v0,256
MC a[128:131],a[16:19],v[64:67]
v_exp_f32 v44, v44
MC a[132:135],a[16:19],v[72:75]
RD a[16:19],v1,256
MC a[132:135],a[20:23],a[40:43]
RD a[20:23],v0,384
MC v[244:247],a[24:27],v[56:59]
LG 5
v_exp_f32 v45, v45
MC v[244:247],a[28:31],v[60:63]
v_exp_f32 v46, v46
MC v[252:255],a[28:31],v[68:71]
v_exp_f32 v47, v47
MC v[252:255],a[24:27],v[64:67]
RD a[24:27],v1,384
CV v82,v44,v45
MC a[136:139],a[32:35],v[56:59]
v_exp_f32 v48, v48
MC a[136:139],a[36:39],v[60:63]
s_waitcnt vmcnt(4)
buffer_load_dwordx4 v12, s[12:15], s40 offen offset:0 nt lds
MC a[140:143],a[36:39],v[68:71]
s_add_u32 m0, s34, 38048
v_exp_f32 v49, v49
MC a[140:143],a[32:35],v[64:67]
v_exp_f32 v50, v50
M v[36:39],v[52:55],a[160:163],v[32:35]
v_exp_f32 v51, v51
MC v[36:39],a[0:3],a[164:167]
LG 1
RD a[28:31],v0,512
CV v83,v46,v47
MC v[36:39],a[4:7],a[168:171]
RD a[36:39],v0,640
CV v90,v48,v49
MC v[36:39],a[8:11],a[172:175]
RD a[32:35],v1,512
CV v91,v50,v51
MC v[36:39],a[12:15],a[176:179]
RD a[44:47],v17,0
MC v[36:39],a[16:19],a[180:183]
MC v[36:39],a[20:23],a[184:187]
LG 4
MC v[36:39],a[24:27],a[188:191]
s_nop 2
M v[40:43],v[52:55],a[192:195],v[24:27]
s_nop 2
MC v[40:43],a[0:3],a[196:199]
s_waitcnt vmcnt(4)
buffer_load_dwordx4 v12, s[12:15], s40 offen offset:1024 nt lds
MC v[40:43],a[4:7],a[200:203]
s_add_u32 m0, s34, 38080
v_exp_f32 v36, v36
MC v[40:43],a[8:11],a[204:207]
v_exp_f32 v37, v37
MC v[40:43],a[12:15],a[208:211]
v_exp_f32 v38, v38
MC v[40:43],a[16:19],a[212:215]
v_exp_f32 v39, v39
MC v[40:43],a[20:23],a[216:219]
CV v72,v36,v37
CV v73,v38,v39
MC v[40:43],a[24:27],a[220:223]
s_nop 2
M v[44:47],v[52:55],a[224:227],v[28:31]
RD v[52:55],v1,640
s_nop 0
MC v[44:47],a[0:3],a[228:231]
RD a[0:3],v0,768
MC v[44:47],a[4:7],a[232:235]
RD a[4:7],v1,768
MC v[44:47],a[8:11],a[236:239]
RD a[8:11],v0,896
MC v[44:47],a[12:15],a[240:243]
RD a[12:15],v1,896
MC v[44:47],a[16:19],a[244:247]
s_waitcnt vmcnt(4)
buffer_load_dwordx4 v12, s[12:15], s40 offen offset:2048 nt lds
MC v[44:47],a[20:23],a[248:251]
s_add_u32 m0, s34, 38112
v_exp_f32 v40, v40
MC v[44:47],a[24:27],a[252:255]
LG 5
v_exp_f32 v41, v41
M v[48:51],a[28:31],a[160:163],v[32:35]
v_exp_f32 v42, v42
MC v[48:51],a[32:35],a[164:167]
v_exp_f32 v43, v43
MC v[48:51],a[36:39],a[168:171]
LG 2
RD a[16:19],v2,0
CV v56,v40,v41
MC v[48:51],v[52:55],a[172:175]
RD a[20:23],v3,0
CV v57,v42,v43
MC v[48:51],a[0:3],a[176:179]
RD a[24:27],v2,128
MC v[48:51],a[4:7],a[180:183]
LG 3
v_exp_f32 v44, v44
MC v[48:51],a[8:11],a[184:187]
v_exp_f32 v45, v45
MC v[48:51],a[12:15],a[188:191]
v_exp_f32 v46, v46
M v[36:39],a[28:31],a[192:195],v[24:27]
v_exp_f32 v47, v47
MC v[36:39],a[32:35],a[196:199]
s_waitcnt vmcnt(4)
buffer_load_dwordx4 v12, s[12:15], s40 offen offset:3072 nt lds
MC v[36:39],a[36:39],a[200:203]
s_add_u32 m0, s34, 67584
CV v64,v44,v45
CV v65,v46,v47
MC v[36:39],v[52:55],a[204:207]
s_xor_b32 s40, s63, 266240
v_exp_f32 v48, v48
MC v[36:39],a[0:3],a[208:211]
v_exp_f32 v49, v49
MC v[36:39],a[4:7],a[212:215]
v_exp_f32 v50, v50
MC v[36:39],a[8:11],a[216:219]
v_exp_f32 v51, v51
MC v[36:39],a[12:15],a[220:223]
CV v74,v48,v49
CV v75,v50,v51
M v[40:43],a[28:31],a[224:227],v[28:31]
RD a[28:31],v3,128
s_nop 0
MC v[40:43],a[32:35],a[228:231]
RD a[32:35],v2,256
MC v[40:43],a[36:39],a[232:235]
RD a[36:39],v3,256
MC v[40:43],v[52:55],a[236:239]
RD v[52:55],v2,384
MC v[40:43],a[0:3],a[240:243]
RD a[0:3],v3,384
MC v[40:43],a[4:7],a[244:247]
s_waitcnt vmcnt(4)
buffer_load_dwordx4 v12, s[16:19], s41 offen offset:0 nt lds
MC v[40:43],a[8:11],a[248:251]
s_add_u32 m0, s34, 67616
v_exp_f32 v36, v36
MC v[40:43],a[12:15],a[252:255]
LG 5
v_exp_f32 v37, v37
M v[44:47],a[16:19],a[192:195],v[24:27]
v_exp_f32 v38, v38
MC v[44:47],a[20:23],a[196:199]
v_exp_f32 v39, v39
MC v[44:47],a[24:27],a[200:203]
LG 2
RD a[4:7],v2,512
CV v58,v36,v37
MC v[44:47],a[28:31],a[204:207]
RD a[8:11],v3,512
CV v59,v38,v39
MC v[44:47],a[32:35],a[208:211]
RD a[12:15],v2,640
MC v[44:47],a[36:39],a[212:215]
LG 3
v_exp_f32 v40, v40
MC v[44:47],v[52:55],a[216:219]
v_exp_f32 v41, v41
MC v[44:47],a[0:3],a[220:223]
v_exp_f32 v42, v42
M v[48:51],a[16:19],a[224:227],v[28:31]
RD a[16:19],v3,640
CV v66,v40,v41
MC v[48:51],a[20:23],a[228:231]
RD a[20:23],v2,768
s_nop 0
MC v[48:51],a[24:27],a[232:235]
RD a[24:27],v3,768
MC v[48:51],a[28:31],a[236:239]
s_waitcnt vmcnt(4)
buffer_load_dwordx4 v12, s[16:19], s41 offen offset:1024 nt lds
MC v[48:51],a[32:35],a[240:243]
s_add_u32 m0, s34, 67648
RD a[28:31],v2,896
MC v[48:51],a[36:39],a[244:247]
RD a[32:35],v3,896
MC v[48:51],v[52:55],a[248:251]
v_exp_f32 v43, v43
MC v[48:51],a[0:3],a[252:255]
LG 5
CV v67,v42,v43
s_nop 0
M v[36:39],a[4:7],a[192:195],v[24:27]
ds_write_b128 v16, v[72:75] offset:1024
MC v[36:39],a[8:11],a[196:199]
v_exp_f32 v44, v44
MC v[36:39],a[12:15],a[200:203]
LG 3
s_barrier
MC v[36:39],a[16:19],a[204:207]
TR a[36:37],v4,33792
MC v[36:39],a[20:23],a[208:211]
TR a[38:39],v4,34304
MC v[36:39],a[24:27],a[212:215]
s_waitcnt vmcnt(4) lgkmcnt(3)
buffer_load_dwordx4 v12, s[16:19], s41 offen offset:2048 nt lds
MC v[36:39],a[28:31],a[216:219]
s_add_u32 m0, s34, 67680
TR v[52:53],v6,33792
MC v[36:39],a[32:35],a[220:223]
TR v[54:55],v6,34304
s_nop 0
M v[40:43],a[4:7],a[224:227],v[28:31]
TR a[0:1],v4,33824
s_nop 0
MC v[40:43],a[8:11],a[228:231]
TR a[2:3],v4,34336
MC v[40:43],a[12:15],a[232:235]
TR a[4:5],v6,33824
MC v[40:43],a[16:19],a[236:239]
TR a[6:7],v6,34336
MC v[40:43],a[20:23],a[240:243]
TR a[8:9],v5,33792
MC v[40:43],a[24:27],a[244:247]
TR a[10:11],v5,34304
MC v[40:43],a[28:31],a[248:251]
TR a[12:13],v7,33792
MC v[40:43],a[32:35],a[252:255]
TR a[14:15],v7,34304
s_nop 0
MC a[60:63],a[48:51],v[76:79]
TR a[16:17],v5,33824
s_nop 0
MC a[60:63],a[48:51],v[80:83]
s_waitcnt vmcnt(4)
buffer_load_dwordx4 v12, s[16:19], s41 offen offset:3072 nt lds
MC a[60:63],a[52:55],v[84:87]
LG 6
TR a[18:19],v5,34336
s_add_u32 m0, s34, 71808
MC a[60:63],a[52:55],v[88:91]
s_xor_b32 s41, s63, 458752
TR a[20:21],v7,33824
MC a[60:63],a[56:59],v[92:95]
TR a[22:23],v7,34336
MC a[60:63],a[56:59],a[44:47]
TR a[24:25],v4,33920
MC v[100:103],a[36:39],v[76:79]
TR a[26:27],v4,34432
MC v[100:103],v[52:55],v[80:83]
TR a[28:29],v6,33920
MC v[108:111],v[52:55],v[88:91]
TR a[30:31],v6,34432
MC v[108:111],a[36:39],v[84:87]
TR a[32:33],v4,33952
MC v[116:119],a[36:39],v[92:95]
LG 7
TR a[34:35],v4,34464
MC v[116:119],v[52:55],a[44:47]
TR a[36:37],v6,33952
MC a[64:67],a[0:3],v[76:79]
s_waitcnt vmcnt(4)
buffer_load_dwordx4 v12, s[16:19], s40 offen offset:0 nt lds
MC a[64:67],a[4:7],v[80:83]
s_add_u32 m0, s34, 71840
TR a[38:39],v6,34464
MC a[68:71],a[4:7],v[88:91]
TR v[52:53],v5,33920
MC a[68:71],a[0:3],v[84:87]
TR v[54:55],v5,34432
MC a[72:75],a[0:3],v[92:95]
TR a[0:1],v7,33920
MC a[72:75],a[4:7],a[44:47]
TR a[2:3],v7,34432
MC v[124:127],a[8:11],v[76:79]
LG 6
TR a[4:5],v5,33952
MC v[124:127],a[12:15],v[80:83]
TR a[6:7],v5,34464
MC v[132:135],a[12:15],v[88:91]
TR a[12:13],v4,34048
MC v[132:135],a[8:11],v[84:87]
TR a[8:9],v7,33952
MC a[76:79],a[16:19],v[76:79]
TR a[10:11],v7,34464
MC a[76:79],a[20:23],v[80:83]
TR a[14:15],v4,34560
MC a[80:83],a[20:23],v[88:91]
s_waitcnt vmcnt(4)
buffer_load_dwordx4 v12, s[16:19], s40 offen offset:1024 nt lds
MC a[80:83],a[16:19],v[84:87]
s_add_u32 m0, s34, 71872
TR a[16:17],v6,34048
MC v[140:143],a[24:27],v[76:79]
TR a[18:19],v6,34560
MC v[140:143],a[28:31],v[80:83]
LG 6
TR a[20:21],v4,34080
MC v[148:151],a[28:31],v[88:91]
s_getpc_b64 s[54:55]
TR a[22:23],v4,34592
MC v[148:151],a[24:27],v[84:87]
v_exp_f32 v45, v45
MC v[156:159],a[24:27],v[92:95]
global_load_dword v14, v23, s[54:55]
MC v[156:159],a[28:31],a[44:47]
TR a[24:25],v6,34080
CV v60,v44,v45
MC a[84:87],a[32:35],v[76:79]
TR a[26:27],v6,34592
v_lshrrev_b32 v23, 9, v15
MC a[84:87],a[36:39],v[80:83]
TR a[28:29],v5,34048
v_lshlrev_b32 v23, 7, v23
MC a[88:91],a[36:39],v[88:91]
TR a[30:31],v5,34560
v_add_u32 v23, 27000, v23
MC a[88:91],a[32:35],v[84:87]
v_exp_f32 v46, v46
MC a[92:95],a[32:35],v[92:95]
s_waitcnt vmcnt(5)
buffer_load_dwordx4 v12, s[16:19], s40 offen offset:2048 nt lds
MC a[92:95],a[36:39],a[44:47]
s_add_u32 m0, s34, 71904
TR a[32:33],v7,34048
MC v[164:167],v[52:55],v[76:79]
TR a[34:35],v7,34560
MC v[164:167],a[0:3],v[80:83]
LG 5
TR a[36:37],v5,34080
MC v[172:175],a[0:3],v[88:91]
TR a[38:39],v5,34592
MC v[172:175],v[52:55],v[84:87]
TR v[52:53],v7,34080
MC a[96:99],a[4:7],v[76:79]
TR v[54:55],v7,34592
MC a[96:99],a[8:11],v[80:83]
TR a[0:1],v4,34176
MC a[100:103],a[8:11],v[88:91]
TR a[2:3],v4,34688
MC a[100:103],a[4:7],v[84:87]
TR a[4:5],v6,34176
MC v[180:183],a[12:15],v[76:79]
TR a[6:7],v6,34688
MC v[180:183],a[16:19],v[80:83]
TR a[8:9],v4,34208
MC v[188:191],a[16:19],v[88:91]
s_waitcnt vmcnt(5)
buffer_load_dwordx4 v12, s[16:19], s40 offen offset:3072 nt lds
MC v[188:191],a[12:15],v[84:87]
LG 6
TR a[10:11],v4,34720
s_add_u32 m0, s34, 0
MC v[196:199],a[12:15],v[92:95]
s_xor_b32 s40, s63, 331776
TR a[12:13],v6,34208
MC v[196:199],a[16:19],a[44:47]
TR a[14:15],v6,34720
MC a[104:107],a[20:23],v[76:79]
v_exp_f32 v47, v47
MC a[104:107],a[24:27],v[80:83]
TR a[16:17],v5,34176
CV v61,v46,v47
MC a[108:111],a[24:27],v[88:91]
TR a[18:19],v5,34688
MC a[108:111],a[20:23],v[84:87]
v_exp_f32 v48, v48
MC a[112:115],a[20:23],v[92:95]
TR a[20:21],v7,34176
MC a[112:115],a[24:27],a[44:47]
TR a[22:23],v7,34688
MC v[204:207],a[28:31],v[76:79]
TR a[24:25],v5,34208
MC v[204:207],a[32:35],v[80:83]
LG 5
TR a[26:27],v5,34720
MC v[212:215],a[32:35],v[88:91]
s_waitcnt vmcnt(5)
buffer_load_dwordx4 v12, s[12:15], s41 offen offset:0 nt lds
MC v[212:215],a[28:31],v[84:87]
s_add_u32 m0, s34, 32
TR a[28:29],v7,34208
MC a[116:119],a[36:39],v[76:79]
Y_pg16:
s_cbranch_execz Y_wr2
TR a[30:31],v7,34720
MC a[116:119],v[52:55],v[80:83]
v_exp_f32 v49, v49
MC a[120:123],v[52:55],v[88:91]
v_exp_f32 v50, v50
MC a[120:123],a[36:39],v[84:87]
v_exp_f32 v51, v51
MC v[220:223],a[0:3],v[76:79]
CV v68,v48,v49
CV v69,v50,v51
MC v[220:223],a[4:7],v[80:83]
v_exp_f32 v36, v36
MC v[228:231],a[4:7],v[88:91]
s_barrier
MC v[228:231],a[0:3],v[84:87]
RD a[32:35],v0,33792
MC v[236:239],a[0:3],v[92:95]
RD a[36:39],v1,33792
MC v[236:239],a[4:7],a[44:47]
RD v[52:55],v0,33920
MC a[124:127],a[8:11],v[76:79]
s_waitcnt vmcnt(5)
buffer_load_dwordx4 v12, s[12:15], s41 offen offset:1024 nt lds
MC a[124:127],a[12:15],v[80:83]
s_add_u32 m0, s34, 64
RD a[0:3],v1,33920
MC a[128:131],a[12:15],v[88:91]
RD a[4:7],v0,34048
MC a[128:131],a[8:11],v[84:87]
v_exp_f32 v37, v37
MC a[132:135],a[8:11],v[92:95]
RD a[8:11],v1,34048
CV v62,v36,v37
MC a[132:135],a[12:15],a[44:47]
LG 5
RD a[12:15],v0,34176
MC v[244:247],a[16:19],v[76:79]
v_exp_f32 v38, v38
MC v[244:247],a[20:23],v[80:83]
v_exp_f32 v39, v39
MC v[252:255],a[20:23],v[88:91]
v_exp_f32 v40, v40
MC v[252:255],a[16:19],v[84:87]
RD a[16:19],v1,34176
CV v63,v38,v39
MC a[136:139],a[24:27],v[76:79]
v_exp_f32 v41, v41
MC a[136:139],a[28:31],v[80:83]
v_exp_f32 v42, v42
MC a[140:143],a[28:31],v[88:91]
s_waitcnt vmcnt(5)
buffer_load_dwordx4 v12, s[12:15], s41 offen offset:2048 nt lds
MC a[140:143],a[24:27],v[84:87]
s_add_u32 m0, s34, 96
v_exp_f32 v43, v43
M v[44:47],a[32:35],a[160:163],v[32:35]
LG 1
RD a[20:23],v0,34304
CV v70,v40,v41
MC v[44:47],a[36:39],a[164:167]
RD a[28:31],v0,34432
CV v71,v42,v43
MC v[44:47],v[52:55],a[168:171]
RD a[24:27],v1,34304
MC v[44:47],a[0:3],a[172:175]
RD a[40:43],v17,1024
MC v[44:47],a[4:7],a[176:179]
MC v[44:47],a[8:11],a[180:183]
MC v[44:47],a[12:15],a[184:187]
LG 4
MC v[44:47],a[16:19],a[188:191]
s_nop 2
M v[48:51],a[32:35],a[192:195],v[24:27]
s_nop 2
MC v[48:51],a[36:39],a[196:199]
v_exp_f32 v44, v44
MC v[48:51],v[52:55],a[200:203]
s_waitcnt vmcnt(4)
buffer_load_dwordx4 v12, s[12:15], s41 offen offset:3072 nt lds
MC v[48:51],a[0:3],a[204:207]
s_add_u32 m0, s34, 4224
v_exp_f32 v45, v45
MC v[48:51],a[4:7],a[208:211]
s_xor_b32 s41, s63, 425984
v_exp_f32 v46, v46
MC v[48:51],a[8:11],a[212:215]
v_exp_f32 v47, v47
MC v[48:51],a[12:15],a[216:219]
CV v92,v44,v45
CV v93,v46,v47
MC v[48:51],a[16:19],a[220:223]
s_nop 2
M v[36:39],a[32:35],a[224:227],v[28:31]
RD a[32:35],v1,34432
s_nop 0
MC v[36:39],a[36:39],a[228:231]
RD a[36:39],v0,34560
MC v[36:39],v[52:55],a[232:235]
RD v[52:55],v1,34560
MC v[36:39],a[0:3],a[236:239]
RD a[0:3],v0,34688
MC v[36:39],a[4:7],a[240:243]
RD a[4:7],v1,34688
MC v[36:39],a[8:11],a[244:247]
v_exp_f32 v48, v48
MC v[36:39],a[12:15],a[248:251]
s_waitcnt vmcnt(4)
buffer_load_dwordx4 v12, s[12:15], s40 offen offset:0 nt lds
MC v[36:39],a[16:19],a[252:255]
LG 5
v_exp_f32 v49, v49
M v[40:43],a[20:23],a[160:163],v[32:35]
s_add_u32 m0, s34, 4256
v_exp_f32 v50, v50
MC v[40:43],a[24:27],a[164:167]
v_exp_f32 v51, v51
MC v[40:43],a[28:31],a[168:171]
LG 2
RD a[8:11],v2,33792
CV v76,v48,v49
MC v[40:43],a[32:35],a[172:175]
RD a[12:15],v3,33792
CV v77,v50,v51
MC v[40:43],a[36:39],a[176:179]
RD a[16:19],v2,33920
MC v[40:43],v[52:55],a[180:183]
LG 3
v_exp_f32 v36, v36
MC v[40:43],a[0:3],a[184:187]
v_exp_f32 v37, v37
MC v[40:43],a[4:7],a[188:191]
v_exp_f32 v38, v38
M v[44:47],a[20:23],a[192:195],v[24:27]
v_exp_f32 v39, v39
MC v[44:47],a[24:27],a[196:199]
CV v84,v36,v37
CV v85,v38,v39
MC v[44:47],a[28:31],a[200:203]
s_waitcnt vmcnt(4)
buffer_load_dwordx4 v12, s[12:15], s40 offen offset:1024 nt lds
MC v[44:47],a[32:35],a[204:207]
s_add_u32 m0, s34, 4288
v_exp_f32 v40, v40
MC v[44:47],a[36:39],a[208:211]
v_exp_f32 v41, v41
MC v[44:47],v[52:55],a[212:215]
v_exp_f32 v42, v42
MC v[44:47],a[0:3],a[216:219]
v_exp_f32 v43, v43
MC v[44:47],a[4:7],a[220:223]
CV v94,v40,v41
CV v95,v42,v43
M v[48:51],a[20:23],a[224:227],v[28:31]
RD a[20:23],v3,33920
s_nop 0
MC v[48:51],a[24:27],a[228:231]
RD a[24:27],v2,34048
MC v[48:51],a[28:31],a[232:235]
RD a[28:31],v3,34048
MC v[48:51],a[32:35],a[236:239]
RD a[32:35],v2,34176
MC v[48:51],a[36:39],a[240:243]
RD a[36:39],v3,34176
MC v[48:51],v[52:55],a[244:247]
v_exp_f32 v44, v44
MC v[48:51],a[0:3],a[248:251]
s_waitcnt vmcnt(4)
buffer_load_dwordx4 v12, s[12:15], s40 offen offset:2048 nt lds
MC v[48:51],a[4:7],a[252:255]
LG 5
v_exp_f32 v45, v45
M v[36:39],a[8:11],a[192:195],v[24:27]
s_add_u32 m0, s34, 4320
v_exp_f32 v46, v46
MC v[36:39],a[12:15],a[196:199]
v_exp_f32 v47, v47
MC v[36:39],a[16:19],a[200:203]
LG 2
RD v[52:55],v2,34304
CV v78,v44,v45
MC v[36:39],a[20:23],a[204:207]
RD a[0:3],v3,34304
CV v79,v46,v47
MC v[36:39],a[24:27],a[208:211]
RD a[4:7],v2,34432
MC v[36:39],a[28:31],a[212:215]
LG 3
v_exp_f32 v48, v48
MC v[36:39],a[32:35],a[216:219]
v_exp_f32 v49, v49
MC v[36:39],a[36:39],a[220:223]
v_exp_f32 v50, v50
M v[40:43],a[8:11],a[224:227],v[28:31]
RD a[8:11],v3,34432
CV v86,v48,v49
MC v[40:43],a[12:15],a[228:231]
RD a[12:15],v2,34560
s_nop 0
MC v[40:43],a[16:19],a[232:235]
RD a[16:19],v3,34560
MC v[40:43],a[20:23],a[236:239]
RD a[20:23],v2,34688
MC v[40:43],a[24:27],a[240:243]
s_waitcnt vmcnt(4)
buffer_load_dwordx4 v12, s[12:15], s40 offen offset:3072 nt lds
MC v[40:43],a[28:31],a[244:247]
s_add_u32 m0, s34, 101376
RD a[24:27],v3,34688
s_xor_b32 s40, s63, 299008
MC v[40:43],a[32:35],a[248:251]
v_exp_f32 v51, v51
MC v[40:43],a[36:39],a[252:255]
LG 5
CV v87,v50,v51
s_nop 0
M v[44:47],v[52:55],a[192:195],v[24:27]
ds_write_b128 v16, v[92:95] offset:0
MC v[44:47],a[0:3],a[196:199]
v_exp_f32 v36, v36
MC v[44:47],a[4:7],a[200:203]
LG 3
s_barrier
MC v[44:47],a[8:11],a[204:207]
TR a[28:29],v4,0
MC v[44:47],a[12:15],a[208:211]
TR a[30:31],v4,512
MC v[44:47],a[16:19],a[212:215]
s_waitcnt vmcnt(4) lgkmcnt(3)
buffer_load_dwordx4 v12, s[16:19], s41 offen offset:0 nt lds
MC v[44:47],a[20:23],a[216:219]
s_add_u32 m0, s34, 101408
TR a[32:33],v6,0
MC v[44:47],a[24:27],a[220:223]
TR a[34:35],v6,512
s_nop 0
M v[48:51],v[52:55],a[224:227],v[28:31]
TR a[36:37],v4,32
s_nop 0
MC v[48:51],a[0:3],a[228:231]
TR a[38:39],v4,544
MC v[48:51],a[4:7],a[232:235]
TR v[52:53],v6,32
MC v[48:51],a[8:11],a[236:239]
TR v[54:55],v6,544
MC v[48:51],a[12:15],a[240:243]
TR a[0:1],v5,0
MC v[48:51],a[16:19],a[244:247]
TR a[2:3],v5,512
MC v[48:51],a[20:23],a[248:251]
TR a[4:5],v7,0
MC v[48:51],a[24:27],a[252:255]
TR a[6:7],v7,512
s_nop 0
MC a[60:63],a[48:51],v[56:59]
TR a[8:9],v5,32
s_nop 0
MC a[60:63],a[48:51],v[60:63]
s_waitcnt vmcnt(4)
buffer_load_dwordx4 v12, s[16:19], s41 offen offset:1024 nt lds
MC a[60:63],a[52:55],v[64:67]
LG 6
TR a[10:11],v5,544
s_add_u32 m0, s34, 101440
MC a[60:63],a[52:55],v[68:71]
TR a[12:13],v7,32
MC a[60:63],a[56:59],v[72:75]
TR a[14:15],v7,544
MC a[60:63],a[56:59],a[40:43]
TR a[16:17],v4,128
MC v[100:103],a[28:31],v[56:59]
TR a[18:19],v4,640
MC v[100:103],a[32:35],v[60:63]
TR a[20:21],v6,128
MC v[108:111],a[32:35],v[68:71]
TR a[22:23],v6,640
MC v[108:111],a[28:31],v[64:67]
TR a[24:25],v4,160
MC v[116:119],a[28:31],v[72:75]
LG 7
TR a[26:27],v4,672
MC v[116:119],a[32:35],a[40:43]
TR a[28:29],v6,160
MC a[64:67],a[36:39],v[56:59]
TR a[30:31],v6,672
MC a[64:67],v[52:55],v[60:63]
s_waitcnt vmcnt(4)
buffer_load_dwordx4 v12, s[16:19], s41 offen offset:2048 nt lds
MC a[68:71],v[52:55],v[68:71]
s_add_u32 m0, s34, 101472
TR a[32:33],v5,128
MC a[68:71],a[36:39],v[64:67]
TR a[34:35],v5,640
MC a[72:75],a[36:39],v[72:75]
TR a[36:37],v7,128
MC a[72:75],v[52:55],a[40:43]
TR a[38:39],v7,640
MC v[124:127],a[0:3],v[56:59]
LG 6
TR v[52:53],v5,160
MC v[124:127],a[4:7],v[60:63]
TR v[54:55],v5,672
MC v[132:135],a[4:7],v[68:71]
s_mov_b64 exec, 0
s_cmp_eq_u32 s32, 0
s_cbranch_scc1 Y_pg21
s_cmp_eq_u32 s32, 1
s_cbranch_scc1 Y_pg22
s_cmp_eq_u32 s32, 2
s_cbranch_scc1 Y_pg23
s_branch Y_pg24
Y_wr4:
s_mov_b64 exec, -1
TR a[4:5],v4,256
MC v[132:135],a[0:3],v[64:67]
TR a[0:1],v7,160
MC a[76:79],a[8:11],v[56:59]
TR a[2:3],v7,672
MC a[76:79],a[12:15],v[60:63]
TR a[6:7],v4,768
MC a[80:83],a[12:15],v[68:71]
TR a[12:13],v4,288
MC a[80:83],a[8:11],v[64:67]
s_waitcnt vmcnt(4)
buffer_load_dwordx4 v12, s[16:19], s41 offen offset:3072 nt lds
MC v[140:143],a[16:19],v[56:59]
s_add_u32 m0, s34, 105600
TR a[8:9],v6,256
s_xor_b32 s41, s63, 491520
MC v[140:143],a[20:23],v[60:63]
LG 6
TR a[10:11],v6,768
MC v[148:151],a[20:23],v[68:71]
TR a[14:15],v4,800
MC v[148:151],a[16:19],v[64:67]
v_exp_f32 v37, v37
MC v[156:159],a[16:19],v[72:75]
TR a[16:17],v6,288
CV v80,v36,v37
MC v[156:159],a[20:23],a[40:43]
TR a[18:19],v6,800
MC a[84:87],a[24:27],v[56:59]
TR a[20:21],v5,256
MC a[84:87],a[28:31],v[60:63]
TR a[22:23],v5,768
MC a[88:91],a[28:31],v[68:71]
v_exp_f32 v38, v38
MC a[88:91],a[24:27],v[64:67]
v_exp_f32 v39, v39
MC a[92:95],a[24:27],v[72:75]
TR a[24:25],v7,256
CV v81,v38,v39
MC a[92:95],a[28:31],a[40:43]
s_waitcnt vmcnt(4)
buffer_load_dwordx4 v12, s[16:19], s40 offen offset:0 nt lds
MC v[164:167],a[32:35],v[56:59]
s_add_u32 m0, s34, 105632
TR a[26:27],v7,768
MC v[164:167],a[36:39],v[60:63]
LG 4
TR a[28:29],v5,288
MC v[172:175],a[36:39],v[68:71]
TR a[30:31],v5,800
MC v[172:175],a[32:35],v[64:67]
TR a[32:33],v7,288
MC a[96:99],v[52:55],v[56:59]
TR a[34:35],v7,800
MC a[96:99],a[0:3],v[60:63]
TR a[36:37],v4,384
MC a[100:103],a[0:3],v[68:71]
TR a[38:39],v4,896
MC a[100:103],v[52:55],v[64:67]
TR v[52:53],v6,384
MC v[180:183],a[4:7],v[56:59]
TR v[54:55],v6,896
MC v[180:183],a[8:11],v[60:63]
TR a[0:1],v4,416
MC v[188:191],a[8:11],v[68:71]
TR a[2:3],v4,928
MC v[188:191],a[4:7],v[64:67]
s_waitcnt vmcnt(4)
buffer_load_dwordx4 v12, s[16:19], s40 offen offset:1024 nt lds
MC v[196:199],a[4:7],v[72:75]
LG 6
TR a[4:5],v6,416
s_add_u32 m0, s34, 105664
MC v[196:199],a[8:11],a[40:43]
TR a[6:7],v6,928
MC a[104:107],a[12:15],v[56:59]
v_exp_f32 v40, v40
MC a[104:107],a[16:19],v[60:63]
TR a[8:9],v5,384
MC a[108:111],a[16:19],v[68:71]
TR a[10:11],v5,896
MC a[108:111],a[12:15],v[64:67]
v_exp_f32 v41, v41
MC a[112:115],a[12:15],v[72:75]
TR a[12:13],v7,384
CV v88,v40,v41
MC a[112:115],a[16:19],a[40:43]
TR a[14:15],v7,896
MC v[204:207],a[20:23],v[56:59]
TR a[16:17],v5,416
MC v[204:207],a[24:27],v[60:63]
TR a[18:19],v5,928
MC v[212:215],a[24:27],v[68:71]
v_exp_f32 v42, v42
MC v[212:215],a[20:23],v[64:67]
s_waitcnt vmcnt(4)
buffer_load_dwordx4 v12, s[16:19], s40 offen offset:2048 nt lds
MC a[116:119],a[28:31],v[56:59]
LG 4
TR a[20:21],v7,416
s_add_u32 m0, s34, 105696
MC a[116:119],a[32:35],v[60:63]
TR a[22:23],v7,928
MC a[120:123],a[32:35],v[68:71]
v_exp_f32 v43, v43
MC a[120:123],a[28:31],v[64:67]
CV v89,v42,v43
MC v[220:223],a[36:39],v[56:59]
v_exp_f32 v44, v44
MC v[220:223],v[52:55],v[60:63]
s_barrier
MC v[228:231],v[52:55],v[68:71]
RD a[24:27],v0,0
MC v[228:231],a[36:39],v[64:67]
RD a[28:31],v1,0
MC v[236:239],a[36:39],v[72:75]
RD a[32:35],v0,128
MC v[236:239],v[52:55],a[40:43]
RD a[36:39],v1,128
MC a[124:127],a[0:3],v[56:59]
RD v[52:55],v0,256
MC a[124:127],a[4:7],v[60:63]
s_waitcnt vmcnt(4)
buffer_load_dwordx4 v12, s[16:19], s40 offen offset:3072 nt lds
MC a[128:131],a[4:7],v[68:71]
s_add_u32 m0, s34, 33792
v_exp_f32 v45, v45
MC a[128:131],a[0:3],v[64:67]
s_xor_b32 s40, s63, 364544
v_exp_f32 v46, v46
MC a[132:135],a[0:3],v[72:75]
RD a[0:3],v1,256
CV v82,v44,v45
MC a[132:135],a[4:7],a[40:43]
RD a[4:7],v0,384
MC v[244:247],a[8:11],v[56:59]
LG 4
v_exp_f32 v47, v47
MC v[244:247],a[12:15],v[60:63]
v_exp_f32 v48, v48
MC v[252:255],a[12:15],v[68:71]
v_exp_f32 v49, v49
MC v[252:255],a[8:11],v[64:67]
RD a[8:11],v1,384
CV v83,v46,v47
MC a[136:139],a[16:19],v[56:59]
v_exp_f32 v50, v50
MC a[136:139],a[20:23],v[60:63]
v_exp_f32 v51, v51
MC a[140:143],a[20:23],v[68:71]
RD a[12:15],v0,512
CV v90,v48,v49
MC a[140:143],a[16:19],v[64:67]
s_waitcnt vmcnt(4)
buffer_load_dwordx4 v12, s[12:15], s41 offen offset:0 nt lds
M v[36:39],a[24:27],a[160:163],v[32:35]
s_add_u32 m0, s34, 33824
RD a[20:23],v0,640
CV v91,v50,v51
MC v[36:39],a[28:31],a[164:167]
RD a[16:19],v1,512
MC v[36:39],a[32:35],a[168:171]
LG 4
RD a[44:47],v17,0
MC v[36:39],a[36:39],a[172:175]
MC v[36:39],v[52:55],a[176:179]
MC v[36:39],a[0:3],a[180:183]
MC v[36:39],a[4:7],a[184:187]
LG 3
MC v[36:39],a[8:11],a[188:191]
s_nop 2
M v[40:43],a[24:27],a[192:195],v[24:27]
s_nop 2
MC v[40:43],a[28:31],a[196:199]
v_exp_f32 v36, v36
MC v[40:43],a[32:35],a[200:203]
v_exp_f32 v37, v37
MC v[40:43],a[36:39],a[204:207]
s_waitcnt vmcnt(4)
buffer_load_dwordx4 v12, s[12:15], s41 offen offset:1024 nt lds
MC v[40:43],v[52:55],a[208:211]
s_add_u32 m0, s34, 33856
v_exp_f32 v38, v38
MC v[40:43],a[0:3],a[212:215]
v_exp_f32 v39, v39
MC v[40:43],a[4:7],a[216:219]
CV v72,v36,v37
CV v73,v38,v39
MC v[40:43],a[8:11],a[220:223]
s_nop 2
M v[44:47],a[24:27],a[224:227],v[28:31]
RD a[24:27],v1,640
s_nop 0
MC v[44:47],a[28:31],a[228:231]
RD a[28:31],v0,768
MC v[44:47],a[32:35],a[232:235]
RD a[32:35],v1,768
MC v[44:47],a[36:39],a[236:239]
RD a[36:39],v0,896
MC v[44:47],v[52:55],a[240:243]
RD v[52:55],v1,896
MC v[44:47],a[0:3],a[244:247]
v_exp_f32 v40, v40
MC v[44:47],a[4:7],a[248:251]
v_exp_f32 v41, v41
MC v[44:47],a[8:11],a[252:255]
s_waitcnt vmcnt(4)
buffer_load_dwordx4 v12, s[12:15], s41 offen offset:2048 nt lds
M v[48:51],a[12:15],a[160:163],v[32:35]
LG 4
v_exp_f32 v42, v42
MC v[48:51],a[16:19],a[164:167]
s_add_u32 m0, s34, 33888
v_exp_f32 v43, v43
MC v[48:51],a[20:23],a[168:171]
RD a[0:3],v2,0
CV v56,v40,v41
MC v[48:51],a[24:27],a[172:175]
LG 2
RD a[4:7],v3,0
CV v57,v42,v43
MC v[48:51],a[28:31],a[176:179]
s_getpc_b64 s[54:55]
RD a[8:11],v2,128
MC v[48:51],a[32:35],a[180:183]
v_exp_f32 v44, v44
MC v[48:51],a[36:39],a[184:187]
LG 3
global_load_dword v14, v23, s[54:55]
MC v[48:51],v[52:55],a[188:191]
v_exp_f32 v45, v45
M v[36:39],a[12:15],a[192:195],v[24:27]
v_exp_f32 v46, v46
MC v[36:39],a[16:19],a[196:199]
v_exp_f32 v47, v47
MC v[36:39],a[20:23],a[200:203]
CV v64,v44,v45
CV v65,v46,v47
MC v[36:39],a[24:27],a[204:207]
s_waitcnt vmcnt(5)
buffer_load_dwordx4 v12, s[12:15], s41 offen offset:3072 nt lds
MC v[36:39],a[28:31],a[208:211]
s_add_u32 m0, s34, 38016
v_exp_f32 v48, v48
MC v[36:39],a[32:35],a[212:215]
s_xor_b32 s41, s63, 458752
v_exp_f32 v49, v49
MC v[36:39],a[36:39],a[216:219]
v_exp_f32 v50, v50
MC v[36:39],v[52:55],a[220:223]
v_exp_f32 v51, v51
M v[40:43],a[12:15],a[224:227],v[28:31]
RD a[12:15],v3,128
CV v74,v48,v49
MC v[40:43],a[16:19],a[228:231]
RD a[16:19],v2,256
CV v75,v50,v51
MC v[40:43],a[20:23],a[232:235]
RD a[20:23],v3,256
MC v[40:43],a[24:27],a[236:239]
RD a[24:27],v2,384
MC v[40:43],a[28:31],a[240:243]
RD a[28:31],v3,384
MC v[40:43],a[32:35],a[244:247]
v_exp_f32 v36, v36
MC v[40:43],a[36:39],a[248:251]
s_waitcnt vmcnt(5)
buffer_load_dwordx4 v12, s[12:15], s40 offen offset:0 nt lds
MC v[40:43],v[52:55],a[252:255]
LG 5
v_exp_f32 v37, v37
M v[44:47],a[0:3],a[192:195],v[24:27]
Y_pg17:
s_cbranch_execz Y_wr3
s_add_u32 m0, s34, 38048
v_exp_f32 v38, v38
MC v[44:47],a[4:7],a[196:199]
v_exp_f32 v39, v39
MC v[44:47],a[8:11],a[200:203]
LG 2
RD a[32:35],v2,512
CV v58,v36,v37
MC v[44:47],a[12:15],a[204:207]
RD a[36:39],v3,512
CV v59,v38,v39
MC v[44:47],a[16:19],a[208:211]
RD v[52:55],v2,640
MC v[44:47],a[20:23],a[212:215]
LG 3
v_exp_f32 v40, v40
MC v[44:47],a[24:27],a[216:219]
v_exp_f32 v41, v41
MC v[44:47],a[28:31],a[220:223]
v_exp_f32 v42, v42
M v[48:51],a[0:3],a[224:227],v[28:31]
RD a[0:3],v3,640
CV v66,v40,v41
MC v[48:51],a[4:7],a[228:231]
RD a[4:7],v2,768
s_nop 0
MC v[48:51],a[8:11],a[232:235]
RD a[8:11],v3,768
MC v[48:51],a[12:15],a[236:239]
RD a[12:15],v2,896
MC v[48:51],a[16:19],a[240:243]
s_waitcnt vmcnt(5)
buffer_load_dwordx4 v12, s[12:15], s40 offen offset:1024 nt lds
MC v[48:51],a[20:23],a[244:247]
s_add_u32 m0, s34, 38080
RD a[16:19],v3,896
MC v[48:51],a[24:27],a[248:251]
v_exp_f32 v43, v43
MC v[48:51],a[28:31],a[252:255]
LG 5
CV v67,v42,v43
s_nop 0
M v[36:39],a[32:35],a[192:195],v[24:27]
ds_write_b128 v16, v[72:75] offset:1024
MC v[36:39],a[36:39],a[196:199]
v_exp_f32 v44, v44
MC v[36:39],v[52:55],a[200:203]
LG 3
s_barrier
MC v[36:39],a[0:3],a[204:207]
TR a[20:21],v4,33792
MC v[36:39],a[4:7],a[208:211]
TR a[22:23],v4,34304
MC v[36:39],a[8:11],a[212:215]
LG 3
TR a[24:25],v6,33792
MC v[36:39],a[12:15],a[216:219]
s_waitcnt vmcnt(5)
buffer_load_dwordx4 v12, s[12:15], s40 offen offset:2048 nt lds
MC v[36:39],a[16:19],a[220:223]
s_add_u32 m0, s34, 38112
TR a[26:27],v6,34304
s_nop 0
M v[40:43],a[32:35],a[224:227],v[28:31]
TR a[28:29],v4,33824
s_nop 0
MC v[40:43],a[36:39],a[228:231]
TR a[30:31],v4,34336
MC v[40:43],v[52:55],a[232:235]
TR a[32:33],v6,33824
MC v[40:43],a[0:3],a[236:239]
TR a[34:35],v6,34336
MC v[40:43],a[4:7],a[240:243]
TR a[36:37],v5,33792
MC v[40:43],a[8:11],a[244:247]
TR a[38:39],v5,34304
MC v[40:43],a[12:15],a[248:251]
TR v[52:53],v7,33792
MC v[40:43],a[16:19],a[252:255]
TR v[54:55],v7,34304
s_nop 0
MC a[60:63],a[48:51],v[76:79]
TR a[0:1],v5,33824
s_nop 0
MC a[60:63],a[48:51],v[80:83]
LG 7
TR a[2:3],v5,34336
MC a[60:63],a[52:55],v[84:87]
s_waitcnt vmcnt(5)
buffer_load_dwordx4 v12, s[12:15], s40 offen offset:3072 nt lds
MC a[60:63],a[52:55],v[88:91]
s_add_u32 m0, s34, 67584
TR a[4:5],v7,33824
s_xor_b32 s40, s63, 331776
MC a[60:63],a[56:59],v[92:95]
TR a[6:7],v7,34336
MC a[60:63],a[56:59],a[44:47]
TR a[8:9],v4,33920
MC v[100:103],a[20:23],v[76:79]
TR a[10:11],v4,34432
MC v[100:103],a[24:27],v[80:83]
TR a[12:13],v6,33920
MC v[108:111],a[24:27],v[88:91]
TR a[14:15],v6,34432
MC v[108:111],a[20:23],v[84:87]
LG 6
TR a[16:17],v4,33952
MC v[116:119],a[20:23],v[92:95]
TR a[18:19],v4,34464
MC v[116:119],a[24:27],a[44:47]
TR a[20:21],v6,33952
MC a[64:67],a[28:31],v[76:79]
TR a[22:23],v6,34464
MC a[64:67],a[32:35],v[80:83]
v_exp_f32 v45, v45
MC a[68:71],a[32:35],v[88:91]
s_waitcnt vmcnt(4)
buffer_load_dwordx4 v12, s[16:19], s41 offen offset:0 nt lds
MC a[68:71],a[28:31],v[84:87]
s_add_u32 m0, s34, 67616
TR a[24:25],v5,33920
CV v60,v44,v45
MC a[72:75],a[28:31],v[92:95]
TR a[26:27],v5,34432
MC a[72:75],a[32:35],a[44:47]
TR a[28:29],v7,33920
MC v[124:127],a[36:39],v[76:79]
TR a[30:31],v7,34432
MC v[124:127],v[52:55],v[80:83]
LG 5
TR a[32:33],v5,33952
MC v[132:135],v[52:55],v[88:91]
TR a[34:35],v5,34464
MC v[132:135],a[36:39],v[84:87]
TR a[36:37],v7,33952
MC a[76:79],a[0:3],v[76:79]
TR a[38:39],v7,34464
MC a[76:79],a[4:7],v[80:83]
TR v[52:53],v4,34048
MC a[80:83],a[4:7],v[88:91]
TR v[54:55],v4,34560
MC a[80:83],a[0:3],v[84:87]
TR a[0:1],v6,34048
MC v[140:143],a[8:11],v[76:79]
s_waitcnt vmcnt(4)
buffer_load_dwordx4 v12, s[16:19], s41 offen offset:1024 nt lds
MC v[140:143],a[12:15],v[80:83]
s_add_u32 m0, s34, 67648
TR a[2:3],v6,34560
MC v[148:151],a[12:15],v[88:91]
v_exp_f32 v46, v46
MC v[148:151],a[8:11],v[84:87]
TR a[4:5],v4,34080
MC v[156:159],a[8:11],v[92:95]
LG 5
TR a[6:7],v4,34592
MC v[156:159],a[12:15],a[44:47]
TR a[8:9],v6,34080
MC a[84:87],a[16:19],v[76:79]
TR a[10:11],v6,34592
MC a[84:87],a[20:23],v[80:83]
v_exp_f32 v47, v47
MC a[88:91],a[20:23],v[88:91]
TR a[12:13],v5,34048
CV v61,v46,v47
MC a[88:91],a[16:19],v[84:87]
TR a[14:15],v5,34560
MC a[92:95],a[16:19],v[92:95]
TR a[16:17],v7,34048
MC a[92:95],a[20:23],a[44:47]
TR a[18:19],v7,34560
MC v[164:167],a[24:27],v[76:79]
s_waitcnt vmcnt(4)
buffer_load_dwordx4 v12, s[16:19], s41 offen offset:2048 nt lds
MC v[164:167],a[28:31],v[80:83]
s_add_u32 m0, s34, 67680
TR a[20:21],v5,34080
MC v[172:175],a[28:31],v[88:91]
TR a[22:23],v5,34592
MC v[172:175],a[24:27],v[84:87]
LG 6
TR a[24:25],v7,34080
MC a[96:99],a[32:35],v[76:79]
TR a[26:27],v7,34592
MC a[96:99],a[36:39],v[80:83]
TR a[28:29],v4,34176
MC a[100:103],a[36:39],v[88:91]
TR a[30:31],v4,34688
MC a[100:103],a[32:35],v[84:87]
TR a[32:33],v6,34176
MC v[180:183],v[52:55],v[76:79]
TR a[34:35],v6,34688
MC v[180:183],a[0:3],v[80:83]
v_exp_f32 v48, v48
MC v[188:191],a[0:3],v[88:91]
v_exp_f32 v49, v49
MC v[188:191],v[52:55],v[84:87]
TR a[36:37],v4,34208
CV v68,v48,v49
MC v[196:199],v[52:55],v[92:95]
s_waitcnt vmcnt(4)
buffer_load_dwordx4 v12, s[16:19], s41 offen offset:3072 nt lds
MC v[196:199],a[0:3],a[44:47]
s_add_u32 m0, s34, 71808
TR a[38:39],v4,34720
s_mov_b32 s41, 128
MC a[104:107],a[4:7],v[76:79]
LG 4
TR v[52:53],v6,34208
MC a[104:107],a[8:11],v[80:83]
TR v[54:55],v6,34720
MC a[108:111],a[8:11],v[88:91]
v_exp_f32 v50, v50
MC a[108:111],a[4:7],v[84:87]
TR a[0:1],v5,34176
MC a[112:115],a[4:7],v[92:95]
TR a[2:3],v5,34688
MC a[112:115],a[8:11],a[44:47]
TR a[4:5],v7,34176
MC v[204:207],a[12:15],v[76:79]
TR a[6:7],v7,34688
MC v[204:207],a[16:19],v[80:83]
TR a[8:9],v5,34208
MC v[212:215],a[16:19],v[88:91]
TR a[10:11],v5,34720
MC v[212:215],a[12:15],v[84:87]
TR a[12:13],v7,34208
MC a[116:119],a[20:23],v[76:79]
s_waitcnt vmcnt(4)
buffer_load_dwordx4 v12, s[16:19], s40 offen offset:0 nt lds
MC a[116:119],a[24:27],v[80:83]
s_add_u32 m0, s34, 71840
TR a[14:15],v7,34720
MC a[120:123],a[24:27],v[88:91]
v_exp_f32 v51, v51
MC a[120:123],a[20:23],v[84:87]
CV v69,v50,v51
MC v[220:223],a[28:31],v[76:79]
LG 4
v_exp_f32 v36, v36
MC v[220:223],a[32:35],v[80:83]
v_exp_f32 v37, v37
MC v[228:231],a[32:35],v[88:91]
v_exp_f32 v38, v38
MC v[228:231],a[28:31],v[84:87]
v_exp_f32 v39, v39
MC v[236:239],a[28:31],v[92:95]
v_exp_f32 v40, v40
MC v[236:239],a[32:35],a[44:47]
v_exp_f32 v41, v41
MC a[124:127],a[36:39],v[76:79]
v_exp_f32 v42, v42
MC a[124:127],v[52:55],v[80:83]
v_exp_f32 v43, v43
MC a[128:131],v[52:55],v[88:91]
s_waitcnt vmcnt(4)
buffer_load_dwordx4 v12, s[16:19], s40 offen offset:1024 nt lds
MC a[128:131],a[36:39],v[84:87]
s_add_u32 m0, s34, 71872
CV v62,v36,v37
CV v63,v38,v39
MC a[132:135],a[36:39],v[92:95]
s_barrier
CV v70,v40,v41
CV v71,v42,v43
MC a[132:135],v[52:55],a[44:47]
RD a[16:19],v0,33792
MC v[244:247],a[0:3],v[76:79]
RD a[20:23],v1,33792
MC v[244:247],a[4:7],v[80:83]
RD a[24:27],v0,33920
MC v[252:255],a[4:7],v[88:91]
RD a[28:31],v1,33920
MC v[252:255],a[0:3],v[84:87]
LG 4
RD a[32:35],v0,34048
MC a[136:139],a[8:11],v[76:79]
RD a[36:39],v1,34048
MC a[136:139],a[12:15],v[80:83]
RD v[52:55],v0,34176
MC a[140:143],a[12:15],v[88:91]
RD a[0:3],v1,34176
MC a[140:143],a[8:11],v[84:87]
LG 7
RD a[4:7],v0,34304
M v[44:47],a[16:19],a[160:163],v[32:35]
s_waitcnt vmcnt(4) lgkmcnt(7)
buffer_load_dwordx4 v12, s[16:19], s40 offen offset:2048 nt lds
MC v[44:47],a[20:23],a[164:167]
LG 6
RD a[12:15],v0,34432
s_add_u32 m0, s34, 71904
MC v[44:47],a[24:27],a[168:171]
LG 6
RD a[8:11],v1,34304
MC v[44:47],a[28:31],a[172:175]
LG 6
RD a[40:43],v17,1024
MC v[44:47],a[32:35],a[176:179]
LG 6
MC v[44:47],a[36:39],a[180:183]
LG 5
MC v[44:47],v[52:55],a[184:187]
LG 4
MC v[44:47],a[0:3],a[188:191]
s_nop 2
M v[48:51],a[16:19],a[192:195],v[24:27]
s_nop 2
MC v[48:51],a[20:23],a[196:199]
v_exp_f32 v44, v44
MC v[48:51],a[24:27],a[200:203]
v_exp_f32 v45, v45
MC v[48:51],a[28:31],a[204:207]
v_exp_f32 v46, v46
MC v[48:51],a[32:35],a[208:211]
v_exp_f32 v47, v47
MC v[48:51],a[36:39],a[212:215]
s_waitcnt vmcnt(4)
buffer_load_dwordx4 v12, s[16:19], s40 offen offset:3072 nt lds
MC v[48:51],v[52:55],a[216:219]
s_add_u32 m0, s35, 0
CV v92,v44,v45
CV v93,v46,v47
MC v[48:51],a[0:3],a[220:223]
s_mov_b32 s40, 28800
s_nop 1
M v[36:39],a[16:19],a[224:227],v[28:31]
RD a[16:19],v1,34432
s_nop 0
MC v[36:39],a[20:23],a[228:231]
RD a[20:23],v0,34560
MC v[36:39],a[24:27],a[232:235]
v_exp_f32 v48, v48
MC v[36:39],a[28:31],a[236:239]
RD a[24:27],v1,34560
buffer_load_dwordx4 v13, s[24:27], s41 offen offset:0 lds
MC v[36:39],a[32:35],a[240:243]
s_add_u32 m0, s35, 4224
v_exp_f32 v49, v49
MC v[36:39],a[36:39],a[244:247]
s_mov_b32 s41, 57472
RD a[28:31],v0,34688
CV v76,v48,v49
MC v[36:39],v[52:55],a[248:251]
RD a[32:35],v1,34688
v_lshlrev_b32 v1, 4, v21
MC v[36:39],a[0:3],a[252:255]
LG 5
buffer_load_dwordx4 v13, s[24:27], s40 offen offset:0 lds
M v[40:43],a[4:7],a[160:163],v[32:35]
s_add_u32 m0, s35, 8448
v_exp_f32 v50, v50
MC v[40:43],a[8:11],a[164:167]
s_mov_b32 s40, 86144
v_exp_f32 v51, v51
MC v[40:43],a[12:15],a[168:171]
LG 3
RD a[36:39],v2,33792
CV v77,v50,v51
MC v[40:43],a[16:19],a[172:175]
buffer_load_dwordx4 v13, s[24:27], s41 offen offset:0 lds
MC v[40:43],a[20:23],a[176:179]
LG 3
v_exp_f32 v36, v36
MC v[40:43],a[24:27],a[180:183]
LG 2
v_exp_f32 v37, v37
MC v[40:43],a[28:31],a[184:187]
LG 1
v_exp_f32 v38, v38
MC v[40:43],a[32:35],a[188:191]
s_add_u32 m0, s35, 12672
v_exp_f32 v39, v39
M v[44:47],a[4:7],a[192:195],v[24:27]
s_mov_b32 s41, 114816
buffer_load_dwordx4 v13, s[24:27], s40 offen offset:0 lds
MC v[44:47],a[8:11],a[196:199]
s_add_u32 m0, s35, 16896
RD v[52:55],v3,33792
CV v84,v36,v37
MC v[44:47],a[12:15],a[200:203]
s_mov_b32 s40, 143488
v_exp_f32 v40, v40
MC v[44:47],a[16:19],a[204:207]
v_exp_f32 v41, v41
v_exp_f32 v42, v42
MC v[44:47],a[20:23],a[208:211]
buffer_load_dwordx4 v13, s[24:27], s41 offen offset:0 lds
v_exp_f32 v43, v43
MC v[44:47],a[24:27],a[212:215]
s_add_u32 m0, s35, 21120
RD a[0:3],v2,33920
CV v94,v40,v41
MC v[44:47],a[28:31],a[216:219]
s_mov_b32 s41, 172160
CV v95,v42,v43
CV v85,v38,v39
MC v[44:47],a[32:35],a[220:223]
ds_write_b128 v16, v[92:95] offset:0
M v[48:51],a[4:7],a[224:227],v[28:31]
buffer_load_dwordx4 v13, s[24:27], s40 offen offset:0 lds
MC v[48:51],a[8:11],a[228:231]
s_add_u32 m0, s35, 25344
RD a[4:7],v3,33920
v_add_u32 v0, s50, v1
MC v[48:51],a[12:15],a[232:235]
s_mov_b32 s40, 200832
RD a[8:11],v2,34048
MC v[48:51],a[16:19],a[236:239]
RD a[12:15],v3,34048
v_exp_f32 v44, v44
MC v[48:51],a[20:23],a[240:243]
buffer_load_dwordx4 v13, s[24:27], s41 offen offset:0 lds
v_exp_f32 v45, v45
MC v[48:51],a[24:27],a[244:247]
s_add_u32 m0, s35, 29568
v_exp_f32 v46, v46
MC v[48:51],a[28:31],a[248:251]
s_xor_b32 s41, s63, 491520
RD a[16:19],v2,34176
CV v78,v44,v45
MC v[48:51],a[32:35],a[252:255]
LG 4
RD a[20:23],v3,34176
s_nop 0
M v[36:39],a[36:39],a[192:195],v[24:27]
buffer_load_dwordx4 v13, s[24:27], s40 offen offset:0 lds
MC v[36:39],v[52:55],a[196:199]
s_add_u32 m0, s34, 101376
v_exp_f32 v47, v47
MC v[36:39],a[0:3],a[200:203]
LG 3
RD a[24:27],v2,34304
CV v79,v46,v47
MC v[36:39],a[4:7],a[204:207]
s_xor_b32 s40, s63, 364544
RD a[28:31],v3,34304
MC v[36:39],a[8:11],a[208:211]
LG 4
RD a[32:35],v2,34432
MC v[36:39],a[12:15],a[212:215]
LG 4
v_exp_f32 v48, v48
MC v[36:39],a[16:19],a[216:219]
LG 3
v_exp_f32 v49, v49
MC v[36:39],a[20:23],a[220:223]
v_exp_f32 v50, v50
M v[40:43],a[36:39],a[224:227],v[28:31]
v_exp_f32 v51, v51
MC v[40:43],v[52:55],a[228:231]
RD a[36:39],v3,34432
CV v86,v48,v49
MC v[40:43],a[0:3],a[232:235]
RD v[52:55],v2,34560
CV v87,v50,v51
MC v[40:43],a[4:7],a[236:239]
RD a[0:3],v3,34560
MC v[40:43],a[8:11],a[240:243]
v_exp_f32 v36, v36
MC v[40:43],a[12:15],a[244:247]
RD a[4:7],v2,34688
v_and_b32 v2, 15, v21
MC v[40:43],a[16:19],a[248:251]
s_waitcnt vmcnt(12)
RD a[8:11],v3,34688
buffer_load_dwordx4 v12, s[16:19], s41 offen offset:0 nt lds
MC v[40:43],a[20:23],a[252:255]
LG 5
v_exp_f32 v37, v37
M v[44:47],a[24:27],a[192:195],v[24:27]
s_add_u32 m0, s34, 101408
v_exp_f32 v38, v38
MC v[44:47],a[28:31],a[196:199]
v_exp_f32 v39, v39
MC v[44:47],a[32:35],a[200:203]
LG 3
v_exp_f32 v40, v40
MC v[44:47],a[36:39],a[204:207]
v_exp_f32 v41, v41
MC v[44:47],v[52:55],a[208:211]
LG 2
v_exp_f32 v42, v42
MC v[44:47],a[0:3],a[212:215]
LG 1
v_exp_f32 v43, v43
MC v[44:47],a[4:7],a[216:219]
s_waitcnt vmcnt(9) lgkmcnt(0)
s_barrier
CV v80,v36,v37
MC v[44:47],a[8:11],a[220:223]
RD a[44:47],v17,0
CV v81,v38,v39
M v[48:51],a[24:27],a[224:227],v[28:31]
TR a[12:13],v4,0
v_mul_u32_u24 v2, 1792, v2
MC v[48:51],a[28:31],a[228:231]
TR a[14:15],v4,512
v_and_b32 v21, 48, v21
MC v[48:51],a[32:35],a[232:235]
TR a[16:17],v6,0
v_add_u32 v2, v2, v21
MC v[48:51],a[36:39],a[236:239]
TR a[18:19],v6,512
CV v88,v40,v41
MC v[48:51],v[52:55],a[240:243]
buffer_load_dwordx4 v12, s[16:19], s41 offen offset:1024 nt lds
MC v[48:51],a[0:3],a[244:247]
s_add_u32 m0, s34, 101440
TR a[20:21],v4,32
CV v89,v42,v43
MC v[48:51],a[4:7],a[248:251]
TR a[22:23],v4,544
v_lshlrev_b32 v3, 2, v1
MC v[48:51],a[8:11],a[252:255]
TR a[24:25],v6,32
s_nop 0
MC a[60:63],a[48:51],v[56:59]
TR a[26:27],v6,544
s_nop 0
MC a[60:63],a[48:51],v[60:63]
TR a[28:29],v5,0
MC a[60:63],a[52:55],v[64:67]
TR a[30:31],v5,512
MC a[60:63],a[52:55],v[68:71]
TR a[32:33],v7,0
MC a[60:63],a[56:59],v[72:75]
TR a[34:35],v7,512
MC a[60:63],a[56:59],a[40:43]
LG 7
v_exp_f32 v44, v44
MC v[100:103],a[12:15],v[56:59]
v_exp_f32 v45, v45
MC v[100:103],a[16:19],v[60:63]
v_exp_f32 v46, v46
MC v[108:111],a[16:19],v[68:71]
v_exp_f32 v47, v47
MC v[108:111],a[12:15],v[64:67]
TR a[36:37],v5,32
CV v82,v44,v45
MC v[116:119],a[12:15],v[72:75]
TR a[38:39],v5,544
CV v83,v46,v47
MC v[116:119],a[16:19],a[40:43]
LG 3
buffer_load_dwordx4 v12, s[16:19], s41 offen offset:2048 nt lds
MC a[64:67],a[20:23],v[56:59]
s_add_u32 m0, s34, 101472
TR v[52:53],v7,32
MC a[64:67],a[24:27],v[60:63]
TR v[54:55],v7,544
MC a[68:71],a[24:27],v[68:71]
TR a[0:1],v4,128
MC a[68:71],a[20:23],v[64:67]
TR a[2:3],v4,640
MC a[72:75],a[20:23],v[72:75]
TR a[4:5],v6,128
MC a[72:75],a[24:27],a[40:43]
TR a[6:7],v6,640
MC v[124:127],a[28:31],v[56:59]
LG 6
TR a[8:9],v4,160
MC v[124:127],a[32:35],v[60:63]
TR a[10:11],v4,672
MC v[132:135],a[32:35],v[68:71]
v_exp_f32 v48, v48
MC v[132:135],a[28:31],v[64:67]
v_exp_f32 v49, v49
MC a[76:79],a[36:39],v[56:59]
LG 5
v_exp_f32 v50, v50
MC a[76:79],v[52:55],v[60:63]
TR a[12:13],v6,160
CV v90,v48,v49
MC a[80:83],v[52:55],v[68:71]
TR a[14:15],v6,672
MC a[80:83],a[36:39],v[64:67]
LG 4
v_exp_f32 v51, v51
MC v[140:143],a[0:3],v[56:59]
Y_pg18:
s_cbranch_execz Y_wr3
buffer_load_dwordx4 v12, s[16:19], s41 offen offset:3072 nt lds
MC v[140:143],a[4:7],v[60:63]
s_add_u32 m0, s34, 105600
TR a[16:17],v5,128
CV v91,v50,v51
MC v[148:151],a[4:7],v[68:71]
s_mov_b32 s41, 0
TR a[18:19],v5,640
MC v[148:151],a[0:3],v[64:67]
TR a[20:21],v7,128
MC v[156:159],a[0:3],v[72:75]
TR a[22:23],v7,640
MC v[156:159],a[4:7],a[40:43]
LG 5
TR a[24:25],v5,160
MC a[84:87],a[8:11],v[56:59]
LG 5
TR a[26:27],v5,672
MC a[84:87],a[12:15],v[60:63]
TR a[28:29],v7,160
s_nop 0
MC a[88:91],a[12:15],v[68:71]
TR a[30:31],v7,672
s_nop 0
MC a[88:91],a[8:11],v[64:67]
TR a[32:33],v4,256
s_nop 0
MC a[92:95],a[8:11],v[72:75]
TR a[34:35],v4,768
AR v36,a84
MC a[92:95],a[12:15],a[40:43]
LG 7
TR a[36:37],v6,256
AR v37,a85
MC v[164:167],a[16:19],v[56:59]
LG 7
TR a[38:39],v6,768
AR v38,a86
MC v[164:167],a[20:23],v[60:63]
TR v[52:53],v4,288
AR v39,a87
MC v[172:175],a[20:23],v[68:71]
TR v[54:55],v4,800
AR v40,a88
MC v[172:175],a[16:19],v[64:67]
LG 7
buffer_load_dwordx4 v12, s[16:19], s40 offen offset:0 nt lds
MC a[96:99],a[24:27],v[56:59]
LG 6
TR a[0:1],v6,288
AR v41,a89
MC a[96:99],a[28:31],v[60:63]
s_add_u32 m0, s34, 105632
TR a[2:3],v6,800
AR v42,a90
MC a[100:103],a[28:31],v[68:71]
TR a[4:5],v5,256
AR v43,a91
MC a[100:103],a[24:27],v[64:67]
LG 6
TR a[6:7],v5,768
AR v44,a92
MC v[180:183],a[32:35],v[56:59]
LG 6
TR a[8:9],v7,256
AR v45,a93
MC v[180:183],a[36:39],v[60:63]
TR a[10:11],v7,768
AR v46,a94
MC v[188:191],a[36:39],v[68:71]
TR a[12:13],v5,288
AR v47,a95
MC v[188:191],a[32:35],v[64:67]
TR a[14:15],v5,800
AR v48,a96
MC v[196:199],a[32:35],v[72:75]
TR a[20:21],v4,384
AR v49,a97
MC v[196:199],a[36:39],a[40:43]
LG 7
TR a[22:23],v4,896
AR v50,a98
MC a[104:107],v[52:55],v[56:59]
TR a[16:17],v7,288
AR v51,a99
MC a[104:107],a[0:3],v[60:63]
TR a[18:19],v7,800
s_nop 0
MC a[108:111],a[0:3],v[68:71]
TR a[28:29],v4,416
s_nop 0
MC a[108:111],v[52:55],v[64:67]
TR a[30:31],v4,928
MC a[112:115],v[52:55],v[72:75]
s_waitcnt vmcnt(4)
buffer_load_dwordx4 v12, s[16:19], s40 offen offset:1024 nt lds
MC a[112:115],a[0:3],a[40:43]
LG 6
TR a[24:25],v6,384
AR v32,a104
MC v[204:207],a[4:7],v[56:59]
s_add_u32 m0, s34, 105664
TR a[26:27],v6,896
AR v33,a105
MC v[204:207],a[8:11],v[60:63]
TR a[32:33],v6,416
AR v34,a106
MC v[212:215],a[8:11],v[68:71]
TR a[34:35],v6,928
AR v35,a107
MC v[212:215],a[4:7],v[64:67]
TR a[36:37],v5,384
MC a[116:119],a[12:15],v[56:59]
LG 6
TR a[38:39],v5,896
MC a[116:119],a[16:19],v[60:63]
TR v[52:53],v7,384
MC a[120:123],a[16:19],v[68:71]
TR v[54:55],v7,896
MC a[120:123],a[12:15],v[64:67]
TR a[0:1],v5,416
MC v[220:223],a[20:23],v[56:59]
LG 7
TR a[2:3],v5,928
MC v[220:223],a[24:27],v[60:63]
TR a[4:5],v7,416
MC v[228:231],a[24:27],v[68:71]
TR a[6:7],v7,928
MC v[228:231],a[20:23],v[64:67]
s_barrier
MC v[236:239],a[20:23],v[72:75]
TR a[8:9],v8,8448
MC v[236:239],a[24:27],a[40:43]
s_waitcnt vmcnt(4)
buffer_load_dwordx4 v12, s[16:19], s40 offen offset:2048 nt lds
MC a[124:127],a[28:31],v[56:59]
LG 5
TR a[10:11],v8,8704
s_add_u32 m0, s34, 105696
MC a[124:127],a[32:35],v[60:63]
TR a[16:17],v8,16896
MC a[128:131],a[32:35],v[68:71]
TR a[18:19],v8,17152
MC a[128:131],a[28:31],v[64:67]
TR a[12:13],v10,8448
MC a[132:135],a[28:31],v[72:75]
TR a[14:15],v10,8704
AR v72,a80
MC a[132:135],a[32:35],a[40:43]
TR a[20:21],v10,16896
AR v73,a81
MC v[244:247],a[36:39],v[56:59]
TR a[22:23],v10,17152
AR v74,a82
MC v[244:247],v[52:55],v[60:63]
TR a[24:25],v8,25344
AR v75,a83
MC v[252:255],v[52:55],v[68:71]
TR a[26:27],v8,25600
AR v52,a100
MC v[252:255],a[36:39],v[64:67]
LG 7
TR a[28:29],v10,25344
AR v53,a101
MC a[136:139],a[0:3],v[56:59]
TR a[30:31],v10,25600
AR v54,a102
MC a[136:139],a[4:7],v[60:63]
TR a[200:201],v8,8456
AR v55,a103
MC a[140:143],a[4:7],v[68:71]
TR a[4:5],v10,0
TR a[6:7],v10,256
MC a[140:143],a[0:3],v[64:67]
TR a[0:1],v8,0
TR a[2:3],v8,256
LG 0
M a[160:163],a[0:3],v[96:99],0
s_waitcnt vmcnt(4)
buffer_load_dwordx4 v12, s[16:19], s40 offen offset:3072 nt lds
MC a[160:163],a[4:7],v[120:123]
s_add_u32 m0, s35, 33792
TR a[202:203],v8,8712
AR v56,a64
MC a[160:163],a[8:11],v[136:139]
s_mov_b32 s40, 28672
TR a[204:205],v10,8456
AR v57,a65
MC a[160:163],a[12:15],v[160:163]
TR a[206:207],v10,8712
AR v58,a66
MC a[160:163],a[16:19],v[176:179]
buffer_load_dwordx4 v13, s[24:27], s41 offen offset:0 lds
MC a[160:163],a[20:23],v[200:203]
s_add_u32 m0, s35, 38016
TR a[208:209],v8,16904
AR v59,a67
MC a[160:163],a[24:27],v[216:219]
s_mov_b32 s41, 57344
TR a[210:211],v8,17160
AR v60,a68
MC a[160:163],a[28:31],v[240:243]
TR a[212:213],v10,16904
AR v61,a69
M a[164:167],a[0:3],v[104:107],0
buffer_load_dwordx4 v13, s[24:27], s40 offen offset:0 lds
MC a[164:167],a[4:7],v[128:131]
s_add_u32 m0, s35, 42240
TR a[214:215],v10,17160
AR v62,a70
MC a[164:167],a[8:11],v[144:147]
s_mov_b32 s40, 86016
TR a[216:217],v8,25352
AR v63,a71
MC a[164:167],a[12:15],v[168:171]
TR a[32:33],v8,8
AR v68,a76
MC a[164:167],a[16:19],v[184:187]
buffer_load_dwordx4 v13, s[24:27], s41 offen offset:0 lds
MC a[164:167],a[20:23],v[208:211]
s_add_u32 m0, s35, 46464
TR a[34:35],v8,264
AR v69,a77
MC a[164:167],a[24:27],v[224:227]
s_mov_b32 s41, 114688
TR a[36:37],v10,8
AR v70,a78
MC a[164:167],a[28:31],v[248:251]
TR a[38:39],v10,264
AR v71,a79
M a[168:171],a[0:3],v[112:115],0
buffer_load_dwordx4 v13, s[24:27], s40 offen offset:0 lds
MC a[168:171],a[4:7],a[144:147]
s_add_u32 m0, s35, 50688
TR a[218:219],v8,25608
AR v64,a72
MC a[168:171],a[8:11],v[152:155]
s_mov_b32 s40, 143360
TR a[220:221],v10,25352
AR v65,a73
MC a[168:171],a[12:15],a[148:151]
LG 5
TR a[222:223],v10,25608
AR v66,a74
MC a[168:171],a[16:19],v[192:195]
buffer_load_dwordx4 v13, s[24:27], s41 offen offset:0 lds
MC a[168:171],a[20:23],a[152:155]
s_add_u32 m0, s35, 54912
TR a[224:225],v9,0
AR v67,a75
MC a[168:171],a[24:27],v[232:235]
s_mov_b32 s41, 172032
TR a[226:227],v9,256
MC a[168:171],a[28:31],a[156:159]
LG 5
TR a[228:229],v11,0
M a[172:175],a[32:35],v[96:99],0
buffer_load_dwordx4 v13, s[24:27], s40 offen offset:0 lds
MC a[172:175],a[36:39],v[120:123]
s_add_u32 m0, s35, 59136
TR a[230:231],v11,256
s_mov_b32 s40, 200704
MC a[172:175],a[200:203],v[136:139]
TR a[0:1],v9,8448
MC a[172:175],a[204:207],v[160:163]
TR a[2:3],v9,8704
MC a[172:175],a[208:211],v[176:179]
buffer_load_dwordx4 v13, s[24:27], s41 offen offset:0 lds
MC a[172:175],a[212:215],v[200:203]
LG 5
TR a[4:5],v11,8448
s_add_u32 m0, s35, 63360
MC a[172:175],a[216:219],v[216:219]
s_mov_b32 s41, 229376
TR a[6:7],v11,8704
MC a[172:175],a[220:223],v[240:243]
TR a[8:9],v9,16896
M a[176:179],a[32:35],v[104:107],0
buffer_load_dwordx4 v13, s[24:27], s40 offen offset:0 lds
MC a[176:179],a[36:39],v[128:131]
s_add_u32 m0, s35, 67584
TR a[10:11],v9,17152
s_mov_b32 s40, 258048
MC a[176:179],a[200:203],v[144:147]
TR a[12:13],v11,16896
MC a[176:179],a[204:207],v[168:171]
TR a[14:15],v11,17152
MC a[176:179],a[208:211],v[184:187]
buffer_load_dwordx4 v13, s[24:27], s41 offen offset:0 lds
MC a[176:179],a[212:215],v[208:211]
s_add_u32 m0, s35, 71808
TR a[16:17],v9,25344
s_mov_b32 s41, 286720
MC a[176:179],a[216:219],v[224:227]
TR a[18:19],v9,25600
MC a[176:179],a[220:223],v[248:251]
TR a[20:21],v11,25344
M a[180:183],a[32:35],v[112:115],0
buffer_load_dwordx4 v13, s[24:27], s40 offen offset:0 lds
MC a[180:183],a[36:39],a[144:147]
LG 5
TR a[22:23],v11,25600
s_add_u32 m0, s35, 76032
MC a[180:183],a[200:203],v[152:155]
s_mov_b32 s40, 315392
TR a[24:25],v9,8
MC a[180:183],a[204:207],a[148:151]
TR a[26:27],v9,264
MC a[180:183],a[208:211],v[192:195]
buffer_load_dwordx4 v13, s[24:27], s41 offen offset:0 lds
MC a[180:183],a[212:215],a[152:155]
s_add_u32 m0, s35, 80256
TR a[28:29],v11,8
s_mov_b32 s41, 344064
MC a[180:183],a[216:219],v[232:235]
TR a[30:31],v11,264
MC a[180:183],a[220:223],a[156:159]
TR a[32:33],v9,8456
M a[184:187],a[224:227],v[96:99],0
buffer_load_dwordx4 v13, s[24:27], s40 offen offset:0 lds
MC a[184:187],a[228:231],v[120:123]
s_add_u32 m0, s35, 84480
TR a[34:35],v9,8712
s_mov_b32 s40, 372736
MC a[184:187],a[0:3],v[136:139]
TR a[36:37],v11,8456
MC a[184:187],a[4:7],v[160:163]
TR a[38:39],v11,8712
MC a[184:187],a[8:11],v[176:179]
LG 6
buffer_load_dwordx4 v13, s[24:27], s41 offen offset:0 lds
MC a[184:187],a[12:15],v[200:203]
s_add_u32 m0, s35, 88704
TR a[200:201],v9,16904
s_mov_b32 s41, 401408
MC a[184:187],a[16:19],v[216:219]
TR a[202:203],v9,17160
MC a[184:187],a[20:23],v[240:243]
TR a[204:205],v11,16904
M a[188:191],a[224:227],v[104:107],0
buffer_load_dwordx4 v13, s[24:27], s40 offen offset:0 lds
MC a[188:191],a[228:231],v[128:131]
s_add_u32 m0, s35, 92928
TR a[206:207],v11,17160
s_mov_b32 s40, 430080
MC a[188:191],a[0:3],v[144:147]
TR a[208:209],v9,25352
MC a[188:191],a[4:7],v[168:171]
TR a[210:211],v9,25608
MC a[188:191],a[8:11],v[184:187]
buffer_load_dwordx4 v13, s[24:27], s41 offen offset:0 lds
MC a[188:191],a[12:15],v[208:211]
s_add_u32 m0, s35, 97152
TR a[212:213],v11,25352
s_mov_b32 s41, 229504
MC a[188:191],a[16:19],v[224:227]
TR a[214:215],v11,25608
MC a[188:191],a[20:23],v[248:251]
M a[192:195],a[24:27],v[96:99],0
LG 5
buffer_load_dwordx4 v13, s[24:27], s40 offen offset:0 lds
MC a[192:195],a[28:31],v[120:123]
s_add_u32 m0, s35, 0
s_mov_b32 s40, 258176
MC a[192:195],a[32:35],v[136:139]
MC a[192:195],a[36:39],v[160:163]
MC a[192:195],a[200:203],v[176:179]
LG 2
MC a[192:195],a[204:207],v[200:203]
MC a[192:195],a[208:211],v[216:219]
s_waitcnt vmcnt(16) lgkmcnt(0)
s_barrier
MC a[192:195],a[212:215],v[240:243]
TR a[216:217],v4,33792
TR a[218:219],v4,34304
M a[196:199],a[24:27],v[104:107],0
TR a[220:221],v6,33792
TR a[222:223],v6,34304
MC a[196:199],a[28:31],v[128:131]
TR a[224:225],v4,33824
buffer_load_dwordx4 v13, s[24:27], s41 offen offset:0 lds
MC a[196:199],a[32:35],v[144:147]
s_add_u32 m0, s35, 4224
TR a[226:227],v4,34336
TR a[228:229],v6,33824
MC a[196:199],a[36:39],v[168:171]
s_mov_b32 s41, 286848
TR a[230:231],v6,34336
TR a[0:1],v5,33792
MC a[196:199],a[200:203],v[184:187]
TR a[2:3],v5,34304
TR a[4:5],v7,33792
MC a[196:199],a[204:207],v[208:211]
TR a[6:7],v7,34304
TR a[8:9],v5,33824
MC a[196:199],a[208:211],v[224:227]
TR a[10:11],v5,34336
TR a[12:13],v7,33824
MC a[196:199],a[212:215],v[248:251]
LG 12
TR a[14:15],v7,34336
TR a[16:17],v4,33920
MC a[60:63],a[48:51],v[76:79]
LG 12
TR a[18:19],v4,34432
buffer_load_dwordx4 v13, s[24:27], s40 offen offset:0 lds
MC a[60:63],a[48:51],v[80:83]
s_add_u32 m0, s35, 8448
TR a[20:21],v6,33920
TR a[22:23],v6,34432
MC a[60:63],a[52:55],v[84:87]
LG 12
TR a[24:25],v4,33952
TR a[26:27],v4,34464
MC a[60:63],a[52:55],v[88:91]
LG 12
TR a[28:29],v6,33952
TR a[30:31],v6,34464
MC a[60:63],a[56:59],v[92:95]
LG 12
TR a[32:33],v5,33920
TR a[34:35],v5,34432
MC a[60:63],a[56:59],a[44:47]
LG 12
TR a[36:37],v7,33920
TR a[38:39],v7,34432
MC v[100:103],a[216:219],v[76:79]
LG 12
TR a[200:201],v5,33952
TR a[202:203],v5,34464
MC v[100:103],a[220:223],v[80:83]
LG 12
TR a[204:205],v7,33952
TR a[206:207],v7,34464
MC v[108:111],a[220:223],v[88:91]
LG 12
TR a[208:209],v4,34048
buffer_load_dwordx4 v13, s[24:27], s41 offen offset:0 lds
MC v[108:111],a[216:219],v[84:87]
s_add_u32 m0, s35, 12672
TR a[210:211],v4,34560
TR a[212:213],v6,34048
AR v18,a60
MC v[116:119],a[216:219],v[92:95]
LG 12
TR a[214:215],v6,34560
AR v19,a61
AR v20,a62
MC v[116:119],a[220:223],a[44:47]
s_mov_b32 s40, 315520
TR a[216:217],v4,34080
TR a[218:219],v4,34592
v_min3_f32 v22, v18, v19, v20
MC v[56:59],a[224:227],v[76:79]
LG 12
TR a[220:221],v6,34080
v_max3_f32 v23, v18, v19, v20
v_cmp_nle_f32 s[48:49], s44, v22
MC v[56:59],a[228:231],v[80:83]
s_or_b64 s[46:47], s[46:47], s[48:49]
v_rcp_f32 v18, v18
v_rcp_f32 v20, v20
MC v[60:63],a[228:231],v[88:91]
s_mov_b32 s41, 344192
v_rcp_f32 v19, v19
v_cmp_nge_f32 s[48:49], s45, v23
MC v[60:63],a[224:227],v[84:87]
s_or_b64 s[46:47], s[46:47], s[48:49]
TR a[222:223],v6,34592
v_mul_f32 v100, v18, v100
v_mul_f32 v116, v20, v116
s_or_b32 s46, s46, s47
MC v[64:67],a[224:227],v[92:95]
LG 7
TR a[224:225],v5,34048
v_mul_f32 v101, v18, v101
v_mul_f32 v102, v18, v102
s_andn2_b32 s46, s46, s43
MC v[64:67],a[228:231],a[44:47]
s_lshl_b32 s44, s38, 13
TR a[226:227],v5,34560
buffer_load_dwordx4 v13, s[24:27], s40 offen offset:0 lds
v_mov_b32 v21, s46
MC v[124:127],a[0:3],v[76:79]
s_add_u32 m0, s35, 16896
TR a[228:229],v7,34048
ds_write_b32 v16, v21 offset:6148
v_mul_f32 v117, v20, v117
MC v[124:127],a[4:7],v[80:83]
s_mov_b32 s40, 372864
TR a[230:231],v7,34560
v_mul_f32 v103, v18, v103
v_mul_f32 v118, v20, v118
MC v[132:135],a[4:7],v[88:91]
s_add_u32 s44, s44, 0
TR a[4:5],v7,34080
CV v100,v100,v101
v_mul_f32 v119, v20, v119
MC v[132:135],a[0:3],v[84:87]
s_lshl_b32 s45, s38, 13
TR a[6:7],v7,34592
CV v101,v102,v103
CV v116,v116,v117
MC v[68:71],a[8:11],v[76:79]
LG 8
TR a[0:1],v5,34080
v_mul_f32 v108, v19, v108
CV v117,v118,v119
MC v[68:71],a[12:15],v[80:83]
s_add_u32 s45, s45, 4096
TR a[2:3],v5,34592
v_mul_f32 v109, v19, v109
v_mul_f32 v64, v20, v64
MC v[72:75],a[12:15],v[88:91]
TR a[12:13],v6,34176
v_mul_f32 v110, v19, v110
v_mul_f32 v65, v20, v65
MC v[72:75],a[8:11],v[84:87]
TR a[14:15],v6,34688
buffer_load_dwordx4 v13, s[24:27], s41 offen offset:0 lds
v_mul_f32 v66, v20, v66
MC v[140:143],a[16:19],v[76:79]
s_add_u32 m0, s35, 21120
TR a[8:9],v4,34176
v_mul_f32 v111, v19, v111
v_mul_f32 v67, v20, v67
MC v[140:143],a[20:23],v[80:83]
s_mov_b32 s41, 401536
TR a[10:11],v4,34688
CV v108,v108,v109
CV v118,v64,v65
MC v[148:151],a[20:23],v[88:91]
CV v109,v110,v111
v_mul_f32 v56, v18, v56
CV v119,v66,v67
MC v[148:151],a[16:19],v[84:87]
LG 6
ds_write_b128 v16, v[116:119] offset:2048
MC v[156:159],a[16:19],v[92:95]
TR a[16:17],v4,34208
v_mul_f32 v57, v18, v57
MC v[156:159],a[20:23],a[44:47]
TR a[18:19],v4,34720
v_mul_f32 v58, v18, v58
MC v[36:39],a[24:27],v[76:79]
TR a[20:21],v6,34208
v_mul_f32 v59, v18, v59
MC v[36:39],a[28:31],v[80:83]
TR a[22:23],v6,34720
buffer_load_dwordx4 v13, s[24:27], s40 offen offset:0 lds
MC v[40:43],a[28:31],v[88:91]
s_add_u32 m0, s35, 25344
CV v102,v56,v57
CV v103,v58,v59
Y_pg19:
s_cbranch_execz Y_wr3
MC v[40:43],a[24:27],v[84:87]
s_mov_b32 s40, 430208
v_mul_f32 v60, v19, v60
v_mul_f32 v61, v19, v61
v_mul_f32 v156, v20, v156
MC v[44:47],a[24:27],v[92:95]
TR a[24:25],v5,34176
v_mul_f32 v62, v19, v62
v_mul_f32 v157, v20, v157
MC v[44:47],a[28:31],a[44:47]
TR a[26:27],v5,34688
v_mul_f32 v63, v19, v63
v_mul_f32 v158, v20, v158
MC v[164:167],a[32:35],v[76:79]
TR a[28:29],v7,34176
CV v110,v60,v61
v_mul_f32 v159, v20, v159
MC v[164:167],a[36:39],v[80:83]
LG 5
TR a[30:31],v7,34688
CV v111,v62,v63
CV v156,v156,v157
MC v[172:175],a[36:39],v[88:91]
TR a[36:37],v7,34208
v_mul_f32 v124, v18, v124
CV v157,v158,v159
MC v[172:175],a[32:35],v[84:87]
TR a[38:39],v7,34720
buffer_load_dwordx4 v13, s[24:27], s41 offen offset:0 lds
v_mul_f32 v44, v20, v44
MC v[48:51],a[200:203],v[76:79]
s_add_u32 m0, s35, 29568
TR a[32:33],v5,34208
v_mul_f32 v125, v18, v125
v_mul_f32 v45, v20, v45
MC v[48:51],a[204:207],v[80:83]
s_mov_b32 s41, 256
TR a[34:35],v5,34720
v_mul_f32 v126, v18, v126
v_mul_f32 v46, v20, v46
MC v[52:55],a[204:207],v[88:91]
v_mul_f32 v127, v18, v127
CV v124,v124,v125
v_mul_f32 v47, v20, v47
MC v[52:55],a[200:203],v[84:87]
CV v125,v126,v127
v_mul_f32 v132, v19, v132
CV v158,v44,v45
MC v[180:183],a[208:211],v[76:79]
v_mul_f32 v133, v19, v133
v_mul_f32 v134, v19, v134
CV v159,v46,v47
MC v[180:183],a[212:215],v[80:83]
ds_write_b128 v16, v[156:159] offset:3072
MC v[188:191],a[212:215],v[88:91]
v_mul_f32 v135, v19, v135
CV v132,v132,v133
MC v[188:191],a[208:211],v[84:87]
CV v133,v134,v135
v_mul_f32 v68, v18, v68
MC v[196:199],a[208:211],v[92:95]
v_mul_f32 v69, v18, v69
v_mul_f32 v70, v18, v70
MC v[196:199],a[212:215],a[44:47]
buffer_load_dwordx4 v13, s[24:27], s40 offen offset:0 lds
MC v[32:35],a[216:219],v[76:79]
s_add_u32 m0, s35, 101376
v_mul_f32 v71, v18, v71
CV v126,v68,v69
MC v[32:35],a[220:223],v[80:83]
s_mov_b32 s40, 28928
CV v127,v70,v71
v_mul_f32 v72, v19, v72
v_mul_f32 v188, v19, v188
MC a[108:111],a[220:223],v[88:91]
v_mul_f32 v73, v19, v73
v_mul_f32 v74, v19, v74
v_mul_f32 v189, v19, v189
MC a[108:111],a[216:219],v[84:87]
v_mul_f32 v75, v19, v75
CV v134,v72,v73
v_mul_f32 v190, v19, v190
MC a[112:115],a[216:219],v[92:95]
CV v135,v74,v75
v_mul_f32 v140, v18, v140
v_mul_f32 v191, v19, v191
MC a[112:115],a[220:223],a[44:47]
v_mul_f32 v141, v18, v141
v_mul_f32 v142, v18, v142
CV v188,v188,v189
MC v[204:207],a[224:227],v[76:79]
v_mul_f32 v143, v18, v143
CV v140,v140,v141
CV v189,v190,v191
MC v[204:207],a[228:231],v[80:83]
CV v141,v142,v143
v_mul_f32 v148, v19, v148
v_mul_f32 v196, v20, v196
MC v[212:215],a[228:231],v[88:91]
s_waitcnt vmcnt(16)
s_barrier
v_mul_f32 v149, v19, v149
MC v[212:215],a[224:227],v[84:87]
TR a[48:49],v8,42248
v_mul_f32 v150, v19, v150
v_mul_f32 v197, v20, v197
MC a[116:119],a[0:3],v[76:79]
TR a[50:51],v8,42504
v_mul_f32 v151, v19, v151
v_mul_f32 v198, v20, v198
MC a[116:119],a[4:7],v[80:83]
TR a[52:53],v10,42248
CV v148,v148,v149
v_mul_f32 v199, v20, v199
MC a[120:123],a[4:7],v[88:91]
LG 3
TR a[4:5],v10,33792
CV v149,v150,v151
CV v196,v196,v197
MC a[120:123],a[0:3],v[84:87]
TR a[6:7],v10,34048
v_mul_f32 v36, v18, v36
CV v197,v198,v199
MC v[220:223],a[8:11],v[76:79]
TR a[0:1],v8,33792
v_mul_f32 v37, v18, v37
AR v24,a108
MC v[220:223],a[12:15],v[80:83]
TR a[2:3],v8,34048
v_mul_f32 v38, v18, v38
AR v25,a109
MC v[228:231],a[12:15],v[88:91]
TR a[54:55],v10,42504
v_mul_f32 v39, v18, v39
AR v26,a110
MC v[228:231],a[8:11],v[84:87]
TR a[56:57],v8,50696
CV v142,v36,v37
AR v27,a111
MC v[236:239],a[8:11],v[92:95]
TR a[8:9],v8,42240
CV v143,v38,v39
v_mul_f32 v24, v19, v24
MC v[236:239],a[12:15],a[44:47]
TR a[10:11],v8,42496
v_mul_f32 v40, v19, v40
v_mul_f32 v25, v19, v25
MC a[124:127],a[16:19],v[76:79]
TR a[12:13],v10,42240
v_mul_f32 v41, v19, v41
v_mul_f32 v26, v19, v26
MC a[124:127],a[20:23],v[80:83]
TR a[14:15],v10,42496
v_mul_f32 v42, v19, v42
v_mul_f32 v27, v19, v27
MC a[128:131],a[20:23],v[88:91]
TR a[58:59],v8,50952
v_mul_f32 v43, v19, v43
CV v190,v24,v25
MC a[128:131],a[16:19],v[84:87]
LG 7
TR a[40:41],v10,50696
CV v150,v40,v41
AR v28,a112
MC a[132:135],a[16:19],v[92:95]
TR a[16:17],v8,50688
CV v151,v42,v43
AR v29,a113
MC a[132:135],a[20:23],a[44:47]
TR a[18:19],v8,50944
v_mul_f32 v164, v18, v164
AR v30,a114
MC v[244:247],a[24:27],v[76:79]
TR a[20:21],v10,50688
buffer_load_dwordx4 v13, s[24:27], s41 offen offset:0 lds
AR v31,a115
MC v[244:247],a[28:31],v[80:83]
s_add_u32 m0, s35, 105600
TR a[22:23],v10,50944
v_mul_f32 v165, v18, v165
v_mul_f32 v28, v20, v28
MC v[252:255],a[28:31],v[88:91]
s_mov_b32 s41, 57600
TR a[28:29],v10,59136
v_mul_f32 v166, v18, v166
v_mul_f32 v29, v20, v29
MC v[252:255],a[24:27],v[84:87]
TR a[24:25],v8,59136
v_mul_f32 v167, v18, v167
v_mul_f32 v30, v20, v30
MC a[136:139],a[32:35],v[76:79]
LG 7
TR a[26:27],v8,59392
CV v164,v164,v165
v_mul_f32 v31, v20, v31
MC a[136:139],a[36:39],v[80:83]
TR a[30:31],v10,59392
CV v165,v166,v167
CV v198,v28,v29
MC a[140:143],a[36:39],v[88:91]
TR a[36:37],v10,33800
v_mul_f32 v172, v19, v172
CV v199,v30,v31
MC a[140:143],a[32:35],v[84:87]
ds_write_b128 v16, v[196:199] offset:4096
CV v191,v26,v27
M v[56:59],a[0:3],v[96:99],0
TR a[32:33],v8,33800
buffer_load_dwordx4 v13, s[24:27], s40 offen offset:0 lds
AR v24,a116
MC v[56:59],a[4:7],v[120:123]
s_add_u32 m0, s35, 109824
TR a[34:35],v8,34056
v_mul_f32 v173, v19, v173
AR v25,a117
MC v[56:59],a[8:11],v[136:139]
s_mov_b32 s40, 86272
TR a[38:39],v10,34056
v_mul_f32 v174, v19, v174
AR v26,a118
MC v[56:59],a[12:15],v[160:163]
LG 7
TR a[42:43],v10,50952
v_mul_f32 v175, v19, v175
AR v27,a119
MC v[56:59],a[16:19],v[176:179]
TR a[64:65],v10,59144
CV v172,v172,v173
v_mul_f32 v24, v18, v24
MC v[56:59],a[20:23],v[200:203]
LG 7
TR a[44:45],v8,59144
CV v173,v174,v175
v_mul_f32 v25, v18, v25
MC v[56:59],a[24:27],v[216:219]
TR a[46:47],v8,59400
v_mul_f32 v48, v18, v48
v_mul_f32 v26, v18, v26
MC v[56:59],a[28:31],v[240:243]
TR a[66:67],v10,59400
v_mul_f32 v49, v18, v49
v_mul_f32 v27, v18, v27
M v[60:63],a[0:3],v[104:107],0
TR a[68:69],v9,33792
buffer_load_dwordx4 v13, s[24:27], s41 offen offset:0 lds
MC v[60:63],a[4:7],v[128:131]
s_add_u32 m0, s35, 114048
TR a[70:71],v9,34048
v_mul_f32 v50, v18, v50
MC v[60:63],a[8:11],v[144:147]
s_mov_b32 s41, 114944
v_mul_f32 v51, v18, v51
CV v166,v48,v49
MC v[60:63],a[12:15],v[168:171]
CV v167,v50,v51
v_mul_f32 v52, v19, v52
MC v[60:63],a[16:19],v[184:187]
v_mul_f32 v53, v19, v53
v_mul_f32 v54, v19, v54
MC v[60:63],a[20:23],v[208:211]
v_mul_f32 v55, v19, v55
CV v174,v52,v53
MC v[60:63],a[24:27],v[224:227]
CV v175,v54,v55
v_mul_f32 v180, v18, v180
MC v[60:63],a[28:31],v[248:251]
v_mul_f32 v181, v18, v181
v_mul_f32 v182, v18, v182
M v[64:67],a[0:3],v[112:115],0
TR a[0:1],v11,33792
v_mul_f32 v183, v18, v183
MC v[64:67],a[4:7],a[144:147]
TR a[2:3],v11,34048
buffer_load_dwordx4 v13, s[24:27], s40 offen offset:0 lds
MC v[64:67],a[8:11],v[152:155]
LG 2
TR a[4:5],v9,42240
CV v180,v180,v181
MC v[64:67],a[12:15],a[148:151]
s_add_u32 m0, s35, 118272
TR a[6:7],v9,42496
CV v181,v182,v183
MC v[64:67],a[16:19],v[192:195]
s_mov_b32 s40, 143616
TR a[8:9],v11,42240
v_mul_f32 v32, v18, v32
MC v[64:67],a[20:23],a[152:155]
TR a[10:11],v11,42496
v_mul_f32 v33, v18, v33
MC v[64:67],a[24:27],v[232:235]
TR a[12:13],v9,50688
v_mul_f32 v34, v18, v34
MC v[64:67],a[28:31],a[156:159]
TR a[14:15],v9,50944
v_mul_f32 v35, v18, v35
M v[68:71],a[32:35],v[96:99],0
TR a[16:17],v11,50688
CV v182,v32,v33
MC v[68:71],a[36:39],v[120:123]
TR a[18:19],v11,50944
buffer_load_dwordx4 v13, s[24:27], s41 offen offset:0 lds
MC v[68:71],a[48:51],v[136:139]
s_add_u32 m0, s35, 122496
TR a[20:21],v9,59136
CV v183,v34,v35
MC v[68:71],a[52:55],v[160:163]
s_mov_b32 s41, 172288
TR a[22:23],v9,59392
v_mul_f32 v204, v18, v204
MC v[68:71],a[56:59],v[176:179]
TR a[24:25],v11,59136
v_mul_f32 v205, v18, v205
MC v[68:71],a[40:43],v[200:203]
TR a[26:27],v11,59392
v_mul_f32 v206, v18, v206
MC v[68:71],a[44:47],v[216:219]
LG 7
TR a[28:29],v9,33800
v_mul_f32 v207, v18, v207
MC v[68:71],a[64:67],v[240:243]
TR a[30:31],v9,34056
CV v204,v204,v205
M v[72:75],a[32:35],v[104:107],0
CV v205,v206,v207
v_mul_f32 v212, v19, v212
MC v[72:75],a[36:39],v[128:131]
v_mul_f32 v213, v19, v213
v_mul_f32 v214, v19, v214
CV v206,v24,v25
MC v[72:75],a[48:51],v[144:147]
buffer_load_dwordx4 v13, s[24:27], s40 offen offset:0 lds
CV v207,v26,v27
MC v[72:75],a[52:55],v[168:171]
s_add_u32 m0, s35, 126720
v_mul_f32 v215, v19, v215
CV v212,v212,v213
AR v24,a124
MC v[72:75],a[56:59],v[184:187]
s_mov_b32 s40, 200960
v_mul_f32 v220, v18, v220
v_mul_f32 v221, v18, v221
AR v25,a125
MC v[72:75],a[40:43],v[208:211]
v_mul_f32 v222, v18, v222
v_mul_f32 v223, v18, v223
AR v26,a126
MC v[72:75],a[44:47],v[224:227]
CV v220,v220,v221
v_mul_f32 v236, v20, v236
AR v27,a127
MC v[72:75],a[64:67],v[248:251]
CV v221,v222,v223
v_mul_f32 v237, v20, v237
v_mul_f32 v24, v18, v24
M v[76:79],a[32:35],v[112:115],0
TR a[32:33],v11,33800
v_mul_f32 v238, v20, v238
v_mul_f32 v25, v18, v25
MC v[76:79],a[36:39],a[144:147]
TR a[34:35],v11,34056
buffer_load_dwordx4 v13, s[24:27], s41 offen offset:0 lds
v_mul_f32 v26, v18, v26
MC v[76:79],a[48:51],v[152:155]
s_add_u32 m0, s35, 130944
TR a[36:37],v9,42248
v_mul_f32 v239, v20, v239
v_mul_f32 v27, v18, v27
MC v[76:79],a[52:55],a[148:151]
s_mov_b32 s41, 229632
TR a[38:39],v9,42504
CV v236,v236,v237
CV v222,v24,v25
MC v[76:79],a[56:59],v[192:195]
TR a[48:49],v11,42248
CV v237,v238,v239
CV v223,v26,v27
MC v[76:79],a[40:43],a[152:155]
LG 5
TR a[50:51],v11,42504
AR v24,a132
AR v25,a133
MC v[76:79],a[44:47],v[232:235]
TR a[52:53],v9,50696
AR v26,a134
AR v27,a135
MC v[76:79],a[64:67],a[156:159]
TR a[54:55],v9,50952
v_mul_f32 v24, v20, v24
v_mul_f32 v25, v20, v25
M v[80:83],a[68:71],v[96:99],0
TR a[56:57],v11,50696
v_mul_f32 v26, v20, v26
v_mul_f32 v27, v20, v27
MC v[80:83],a[0:3],v[120:123]
TR a[58:59],v11,50952
CV v238,v24,v25
CV v239,v26,v27
MC v[80:83],a[4:7],v[136:139]
ds_write_b128 v16, v[236:239] offset:5120
MC v[80:83],a[8:11],v[160:163]
buffer_load_dwordx4 v13, s[24:27], s40 offen offset:0 lds
MC v[80:83],a[12:15],v[176:179]
s_add_u32 m0, s35, 33792
TR a[40:41],v9,59144
CV v213,v214,v215
MC v[80:83],a[16:19],v[200:203]
s_mov_b32 s40, 258304
TR a[42:43],v9,59400
AR v28,a120
MC v[80:83],a[20:23],v[216:219]
TR a[44:45],v11,59144
AR v29,a121
MC v[80:83],a[24:27],v[240:243]
LG 6
TR a[46:47],v11,59400
AR v30,a122
M v[84:87],a[68:71],v[104:107],0
s_waitcnt vmcnt(16) lgkmcnt(4)
s_barrier
AR v31,a123
MC v[84:87],a[0:3],v[128:131]
RD a[240:243],v17,2048
v_mul_f32 v28, v19, v28
MC v[84:87],a[4:7],v[144:147]
RD a[244:247],v17,3072
v_mul_f32 v29, v19, v29
MC v[84:87],a[8:11],v[168:171]
RD a[248:251],v17,4096
v_mul_f32 v30, v19, v30
MC v[84:87],a[12:15],v[184:187]
RD a[252:255],v17,5120
v_mul_f32 v31, v19, v31
MC v[84:87],a[16:19],v[208:211]
CV v214,v28,v29
CV v215,v30,v31
MC v[84:87],a[20:23],v[224:227]
v_mul_f32 v228, v19, v228
v_mul_f32 v229, v19, v229
MC v[84:87],a[24:27],v[248:251]
v_mul_f32 v230, v19, v230
v_mul_f32 v231, v19, v231
M v[88:91],a[28:31],v[96:99],0
CV v228,v228,v229
AR v28,a128
v_add_u32 v8, 67584, v8
MC v[88:91],a[32:35],v[120:123]
TR a[64:65],v8,0
TR a[66:67],v8,256
MC v[88:91],a[36:39],v[136:139]
TR a[0:1],v8,8448
CV v229,v230,v231
v_add_u32 v10, 67584, v10
MC v[88:91],a[48:51],v[160:163]
TR a[68:69],v10,0
TR a[70:71],v10,256
MC v[88:91],a[52:55],v[176:179]
TR a[2:3],v8,8704
AR v29,a129
MC v[88:91],a[56:59],v[200:203]
LG 6
TR a[4:5],v10,8448
AR v30,a130
MC v[88:91],a[40:43],v[216:219]
TR a[6:7],v10,8704
AR v31,a131
MC v[88:91],a[44:47],v[240:243]
TR a[8:9],v8,16896
v_mul_f32 v28, v19, v28
M v[92:95],a[28:31],v[104:107],0
TR a[10:11],v8,17152
v_mul_f32 v29, v19, v29
MC v[92:95],a[32:35],v[128:131]
TR a[12:13],v10,16896
v_mul_f32 v30, v19, v30
MC v[92:95],a[36:39],v[144:147]
TR a[14:15],v10,17152
v_mul_f32 v31, v19, v31
MC v[92:95],a[48:51],v[168:171]
TR a[16:17],v8,25344
CV v230,v28,v29
MC v[92:95],a[52:55],v[184:187]
TR a[18:19],v8,25600
CV v231,v30,v31
MC v[92:95],a[56:59],v[208:211]
LG 7
TR a[20:21],v10,25344
v_mul_f32 v244, v18, v244
MC v[92:95],a[40:43],v[224:227]
TR a[22:23],v10,25600
v_mul_f32 v245, v18, v245
MC v[92:95],a[44:47],v[248:251]
TR a[24:25],v8,8
v_mul_f32 v246, v18, v246
MC v[56:59],a[64:67],v[100:103]
TR a[26:27],v8,264
buffer_load_dwordx4 v13, s[24:27], s41 offen offset:0 lds
MC v[56:59],a[68:71],v[124:127]
s_add_u32 m0, s35, 38016
TR a[28:29],v10,8
v_mul_f32 v247, v18, v247
MC v[56:59],a[0:3],v[140:143]
LG 7
TR a[30:31],v10,264
CV v244,v244,v245
MC v[56:59],a[4:7],v[164:167]
s_mov_b32 s41, 286976
TR a[32:33],v8,8456
CV v245,v246,v247
MC v[56:59],a[8:11],v[180:183]
TR a[34:35],v8,8712
buffer_load_dwordx4 v13, s[24:27], s40 offen offset:0 lds
MC v[56:59],a[12:15],v[204:207]
LG 7
TR a[36:37],v10,8456
v_mul_f32 v252, v19, v252
MC v[56:59],a[16:19],v[220:223]
LG 7
TR a[38:39],v10,8712
v_mul_f32 v253, v19, v253
AR v28,a136
AR v29,a137
AR v30,a138
AR v31,a139
v_mul_f32 v28, v18, v28
v_mul_f32 v29, v18, v29
v_mul_f32 v30, v18, v30
v_mul_f32 v31, v18, v31
CV v246,v28,v29
CV v247,v30,v31
s_nop 1
MC v[56:59],a[20:23],v[244:247]
s_add_u32 m0, s35, 42240
TR a[48:49],v8,16904
v_mul_f32 v254, v19, v254
MC v[60:63],a[64:67],v[108:111]
s_mov_b32 s40, 315648
TR a[50:51],v8,17160
buffer_load_dwordx4 v13, s[24:27], s41 offen offset:0 lds
MC v[60:63],a[68:71],v[132:135]
s_add_u32 m0, s35, 46464
TR a[52:53],v10,16904
v_mul_f32 v255, v19, v255
MC v[60:63],a[0:3],v[148:151]
s_mov_b32 s41, 344320
TR a[54:55],v10,17160
CV v252,v252,v253
MC v[60:63],a[4:7],v[172:175]
TR a[56:57],v8,25352
CV v253,v254,v255
MC v[60:63],a[8:11],v[188:191]
TR a[58:59],v8,25608
buffer_load_dwordx4 v13, s[24:27], s40 offen offset:0 lds
MC v[60:63],a[12:15],v[212:215]
LG 7
TR a[40:41],v10,25352
AR v24,a140
MC v[60:63],a[16:19],v[228:231]
s_add_u32 m0, s35, 50688
TR a[42:43],v10,25608
AR v25,a141
AR v26,a142
AR v27,a143
v_mul_f32 v24, v19, v24
v_mul_f32 v25, v19, v25
v_mul_f32 v26, v19, v26
v_mul_f32 v27, v19, v27
CV v254,v24,v25
CV v255,v26,v27
s_nop 1
MC v[60:63],a[20:23],v[252:255]
s_mov_b32 s40, 372992
v_bfe_u32 v22, v12, 4, 2
v_add_u32 v9, 67584, v9
MC v[64:67],a[64:67],v[116:119]
buffer_load_dwordx4 v13, s[24:27], s41 offen offset:0 lds
MC v[64:67],a[68:71],a[240:243]
s_add_u32 m0, s35, 54912
TR a[44:45],v9,0
v_mul_u32_u24 v22, 7168, v22
MC v[64:67],a[0:3],v[156:159]
s_mov_b32 s41, 401664
TR a[46:47],v9,256
v_add_u32 v22, 141316, v22
MC v[64:67],a[4:7],a[244:247]
ds_read_b32 v22, v22
v_add_u32 v11, 67584, v11
MC v[64:67],a[8:11],v[196:199]
Y_pg20:
s_cbranch_execz Y_wr3
buffer_load_dwordx4 v13, s[24:27], s40 offen offset:0 lds
MC v[64:67],a[12:15],a[248:251]
s_add_u32 m0, s35, 59136
TR a[64:65],v11,0
CV v56,v56,v57
MC v[64:67],a[16:19],v[236:239]
s_mov_b32 s40, 430336
TR a[66:67],v11,256
CV v57,v58,v59
MC v[64:67],a[20:23],a[252:255]
LG 5
TR a[68:69],v9,8448
CV v60,v60,v61
MC v[68:71],a[24:27],v[100:103]
buffer_load_dwordx4 v13, s[24:27], s41 offen offset:0 lds
MC v[68:71],a[28:31],v[124:127]
s_add_u32 m0, s35, 63360
TR a[70:71],v9,8704
CV v61,v62,v63
MC v[68:71],a[32:35],v[140:143]
s_mov_b32 s41, 384
TR a[0:1],v11,8448
CV v64,v64,v65
MC v[68:71],a[36:39],v[164:167]
LG 5
TR a[2:3],v11,8704
v_cmp_ne_u32 vcc, 0, v22
MC v[68:71],a[48:51],v[180:183]
buffer_load_dwordx4 v13, s[24:27], s40 offen offset:0 lds
MC v[68:71],a[52:55],v[204:207]
s_add_u32 m0, s35, 67584
TR a[4:5],v9,16896
CV v65,v66,v67
MC v[68:71],a[56:59],v[220:223]
s_cmp_lg_u64 vcc, 0
s_cbranch_scc1 Y_restart
TR a[6:7],v9,17152
v_subrev_u32 v8, 67584, v8
MC v[68:71],a[40:43],v[244:247]
s_mov_b32 s40, 29056
TR a[8:9],v11,16896
v_subrev_u32 v10, 67584, v10
MC v[72:75],a[24:27],v[108:111]
TR a[10:11],v11,17152
v_mov_b32 v4, 1
MC v[72:75],a[28:31],v[132:135]
TR a[12:13],v9,25344
v_bfe_u32 v30, v12, 4, 6
MC v[72:75],a[32:35],v[148:151]
TR a[14:15],v9,25600
CV v58,v68,v69
MC v[72:75],a[36:39],v[172:175]
TR a[16:17],v11,25344
CV v59,v70,v71
MC v[72:75],a[48:51],v[188:191]
buffer_store_dwordx4 v[56:59], v0, s[28:31], s51 offen sc1
MC v[72:75],a[52:55],v[212:215]
s_mov_b32 s51, 8192
TR a[18:19],v11,25600
v_lshrrev_b32 v31, 4, v30
MC v[72:75],a[56:59],v[228:231]
LG 6
TR a[20:21],v9,8
v_bfe_u32 v32, v30, 2, 2
MC v[72:75],a[40:43],v[252:255]
s_nop 0
TR a[22:23],v9,264
v_mov_b32 v6, 0
MC v[76:79],a[24:27],v[116:119]
buffer_load_dword v21, off, s[96:99], 0 sc1
MC v[76:79],a[28:31],a[240:243]
TR a[24:25],v11,8
v_mov_b32 v28, 0
MC v[76:79],a[32:35],v[156:159]
TR a[26:27],v11,264
CV v62,v72,v73
MC v[76:79],a[36:39],a[244:247]
TR a[28:29],v9,8456
CV v63,v74,v75
MC v[76:79],a[48:51],v[196:199]
TR a[30:31],v9,8712
v_mov_b32 v29, 0
MC v[76:79],a[52:55],a[248:251]
buffer_store_dwordx4 v[60:63], v0, s[28:31], s51 offen sc1
MC v[76:79],a[56:59],v[236:239]
s_mov_b32 s51, 16384
TR a[32:33],v11,8456
v_mov_b32 v24, 0
MC v[76:79],a[40:43],a[252:255]
TR a[34:35],v11,8712
v_mov_b32 v25, 0
MC v[80:83],a[44:47],v[100:103]
LG 6
TR a[36:37],v9,16904
s_nop 0
MC v[80:83],a[64:67],v[124:127]
TR a[38:39],v9,17160
CV v66,v76,v77
MC v[80:83],a[68:71],v[140:143]
TR a[48:49],v11,16904
CV v67,v78,v79
MC v[80:83],a[0:3],v[164:167]
TR a[50:51],v11,17160
MC v[80:83],a[4:7],v[180:183]
TR a[52:53],v9,25352
MC v[80:83],a[8:11],v[204:207]
buffer_store_dwordx4 v[64:67], v0, s[28:31], s51 offen sc1
MC v[80:83],a[12:15],v[220:223]
s_mov_b32 s51, 24576
TR a[54:55],v9,25608
v_subrev_u32 v9, 67584, v9
MC v[80:83],a[16:19],v[244:247]
TR a[56:57],v11,25352
s_nop 0
MC v[84:87],a[44:47],v[108:111]
TR a[58:59],v11,25608
v_subrev_u32 v11, 67584, v11
MC v[84:87],a[64:67],v[132:135]
s_waitcnt vmcnt(20)
s_barrier
MC v[84:87],a[68:71],v[148:151]
LG 5
TR a[40:41],v8,0
CV v80,v80,v81
MC v[84:87],a[0:3],v[172:175]
TR a[42:43],v8,256
CV v81,v82,v83
MC v[84:87],a[4:7],v[188:191]
TR a[44:45],v10,0
MC v[84:87],a[8:11],v[212:215]
TR a[46:47],v10,256
MC v[84:87],a[12:15],v[228:231]
TR a[64:65],v8,8448
MC v[84:87],a[16:19],v[252:255]
TR a[66:67],v8,8704
s_nop 0
MC v[88:91],a[20:23],v[100:103]
TR a[68:69],v10,8448
s_nop 0
MC v[88:91],a[24:27],v[124:127]
TR a[70:71],v10,8704
MC v[88:91],a[28:31],v[140:143]
TR a[0:1],v8,16896
CV v84,v84,v85
MC v[88:91],a[32:35],v[164:167]
LG 7
TR a[2:3],v8,17152
CV v85,v86,v87
MC v[88:91],a[36:39],v[180:183]
TR a[4:5],v10,16896
MC v[88:91],a[48:51],v[204:207]
TR a[6:7],v10,17152
MC v[88:91],a[52:55],v[220:223]
TR a[8:9],v8,25344
MC v[88:91],a[56:59],v[244:247]
TR a[10:11],v8,25600
s_nop 0
MC v[92:95],a[20:23],v[108:111]
TR a[12:13],v10,25344
s_nop 0
MC v[92:95],a[24:27],v[132:135]
TR a[14:15],v10,25600
MC v[92:95],a[28:31],v[148:151]
LG 7
TR a[16:17],v8,8
CV v82,v88,v89
MC v[92:95],a[32:35],v[172:175]
TR a[18:19],v8,264
CV v83,v90,v91
MC v[92:95],a[36:39],v[188:191]
buffer_store_dwordx4 v[80:83], v0, s[28:31], s51 offen sc1
MC v[92:95],a[48:51],v[212:215]
s_mov_b32 s51, 32768
TR a[20:21],v10,8
MC v[92:95],a[52:55],v[228:231]
TR a[22:23],v10,264
MC v[92:95],a[56:59],v[252:255]
TR a[24:25],v8,8456
s_nop 0
MC a[160:163],a[40:43],v[100:103]
TR a[26:27],v8,8712
s_nop 0
MC a[160:163],a[44:47],v[124:127]
TR a[28:29],v10,8456
MC a[160:163],a[64:67],v[140:143]
LG 6
TR a[30:31],v10,8712
CV v86,v92,v93
MC a[160:163],a[68:71],v[164:167]
TR a[32:33],v8,16904
CV v87,v94,v95
MC a[160:163],a[0:3],v[180:183]
buffer_store_dwordx4 v[84:87], v0, s[28:31], s51 offen sc1
MC a[160:163],a[4:7],v[204:207]
s_mov_b32 s51, 40960
TR a[34:35],v8,17160
MC a[160:163],a[8:11],v[220:223]
TR a[36:37],v10,16904
MC a[160:163],a[12:15],v[244:247]
TR a[38:39],v10,17160
s_nop 0
MC a[164:167],a[40:43],v[108:111]
buffer_load_dwordx4 v13, s[24:27], s41 offen offset:0 lds
MC a[164:167],a[44:47],v[132:135]
s_add_u32 m0, s35, 71808
TR a[48:49],v8,25352
s_mov_b32 s41, 57728
MC a[164:167],a[64:67],v[148:151]
TR a[50:51],v8,25608
AR v56,a160
MC a[164:167],a[68:71],v[172:175]
TR a[52:53],v10,25352
AR v57,a161
MC a[164:167],a[0:3],v[188:191]
buffer_load_dwordx4 v13, s[24:27], s40 offen offset:0 lds
MC a[164:167],a[4:7],v[212:215]
LG 5
TR a[54:55],v10,25608
AR v58,a162
MC a[164:167],a[8:11],v[228:231]
s_add_u32 m0, s35, 76032
TR a[56:57],v9,0
AR v59,a163
MC a[164:167],a[12:15],v[252:255]
s_mov_b32 s40, 86400
TR a[58:59],v9,256
CV v56,v56,v57
MC a[168:171],a[40:43],v[116:119]
buffer_load_dwordx4 v13, s[24:27], s41 offen offset:0 lds
MC a[168:171],a[44:47],a[240:243]
s_add_u32 m0, s35, 80256
TR a[40:41],v11,0
CV v57,v58,v59
MC a[168:171],a[64:67],v[156:159]
s_mov_b32 s41, 115072
TR a[42:43],v11,256
AR v60,a164
MC a[168:171],a[68:71],a[244:247]
TR a[44:45],v9,8448
AR v61,a165
MC a[168:171],a[0:3],v[196:199]
buffer_load_dwordx4 v13, s[24:27], s40 offen offset:0 lds
MC a[168:171],a[4:7],a[248:251]
s_add_u32 m0, s35, 84480
TR a[46:47],v9,8704
AR v62,a166
MC a[168:171],a[8:11],v[236:239]
s_mov_b32 s40, 143744
TR a[64:65],v11,8448
AR v63,a167
MC a[168:171],a[12:15],a[252:255]
TR a[66:67],v11,8704
CV v60,v60,v61
MC a[172:175],a[16:19],v[100:103]
buffer_load_dwordx4 v13, s[24:27], s41 offen offset:0 lds
MC a[172:175],a[20:23],v[124:127]
LG 5
TR a[68:69],v9,16896
CV v61,v62,v63
MC a[172:175],a[24:27],v[140:143]
s_add_u32 m0, s35, 88704
TR a[70:71],v9,17152
AR v64,a168
MC a[172:175],a[28:31],v[164:167]
s_mov_b32 s41, 172416
TR a[0:1],v11,16896
AR v65,a169
MC a[172:175],a[32:35],v[180:183]
buffer_load_dwordx4 v13, s[24:27], s40 offen offset:0 lds
MC a[172:175],a[36:39],v[204:207]
s_add_u32 m0, s35, 92928
TR a[2:3],v11,17152
AR v66,a170
MC a[172:175],a[48:51],v[220:223]
s_mov_b32 s40, 201088
TR a[4:5],v9,25344
AR v67,a171
MC a[172:175],a[52:55],v[244:247]
TR a[6:7],v9,25600
CV v64,v64,v65
MC a[176:179],a[16:19],v[108:111]
buffer_load_dwordx4 v13, s[24:27], s41 offen offset:0 lds
MC a[176:179],a[20:23],v[132:135]
s_add_u32 m0, s35, 97152
TR a[8:9],v11,25344
CV v65,v66,v67
MC a[176:179],a[24:27],v[148:151]
s_mov_b32 s41, 229760
TR a[10:11],v11,25600
AR v68,a172
MC a[176:179],a[28:31],v[172:175]
TR a[12:13],v9,8
AR v69,a173
MC a[176:179],a[32:35],v[188:191]
buffer_load_dwordx4 v13, s[24:27], s40 offen offset:0 lds
MC a[176:179],a[36:39],v[212:215]
LG 5
TR a[14:15],v9,264
AR v70,a174
MC a[176:179],a[48:51],v[228:231]
s_add_u32 m0, s35, 0
AR v71,a175
CV v58,v68,v69
MC a[176:179],a[52:55],v[252:255]
s_mov_b32 s40, 258432
CV v59,v70,v71
v_add_u32 v8, 67584, v8
MC a[180:183],a[16:19],v[116:119]
buffer_store_dwordx4 v[56:59], v0, s[28:31], s51 offen sc1
MC a[180:183],a[20:23],a[240:243]
s_mov_b32 s51, 49152
TR a[16:17],v11,8
v_add_u32 v10, 67584, v10
MC a[180:183],a[24:27],v[156:159]
TR a[18:19],v11,264
AR v72,a176
MC a[180:183],a[28:31],a[244:247]
TR a[20:21],v9,8456
AR v73,a177
MC a[180:183],a[32:35],v[196:199]
TR a[22:23],v9,8712
AR v74,a178
MC a[180:183],a[36:39],a[248:251]
TR a[24:25],v11,8456
AR v75,a179
MC a[180:183],a[48:51],v[236:239]
TR a[26:27],v11,8712
CV v62,v72,v73
MC a[180:183],a[52:55],a[252:255]
TR a[28:29],v9,16904
CV v63,v74,v75
MC a[184:187],a[56:59],v[100:103]
buffer_store_dwordx4 v[60:63], v0, s[28:31], s51 offen sc1
MC a[184:187],a[40:43],v[124:127]
s_mov_b32 s51, 57344
TR a[30:31],v9,17160
MC a[184:187],a[44:47],v[140:143]
LG 6
TR a[32:33],v11,16904
AR v76,a180
MC a[184:187],a[64:67],v[164:167]
TR a[34:35],v11,17160
AR v77,a181
MC a[184:187],a[68:71],v[180:183]
TR a[36:37],v9,25352
AR v78,a182
MC a[184:187],a[0:3],v[204:207]
TR a[38:39],v9,25608
AR v79,a183
MC a[184:187],a[4:7],v[220:223]
TR a[48:49],v11,25352
CV v66,v76,v77
MC a[184:187],a[8:11],v[244:247]
TR a[50:51],v11,25608
CV v67,v78,v79
MC a[188:191],a[56:59],v[108:111]
buffer_store_dwordx4 v[64:67], v0, s[28:31], s51 offen sc1
MC a[188:191],a[40:43],v[132:135]
s_waitcnt vmcnt(25)
s_barrier
v_add_u32 v9, 67584, v9
MC a[188:191],a[44:47],v[148:151]
s_mov_b32 s51, 65536
TR a[52:53],v8,33792
AR v80,a184
MC a[188:191],a[64:67],v[172:175]
TR a[54:55],v8,34048
AR v81,a185
MC a[188:191],a[68:71],v[188:191]
LG 5
TR a[56:57],v10,33792
AR v82,a186
MC a[188:191],a[0:3],v[212:215]
s_waitcnt vmcnt(15)
v_readfirstlane_b32 s101, v21
s_nop 1
s_cmp_eq_u32 s101, 1
s_cbranch_scc0 Y_spinR
Y_backR:
TR a[58:59],v10,34048
AR v83,a187
MC a[188:191],a[4:7],v[228:231]
TR a[40:41],v8,42240
CV v80,v80,v81
MC a[188:191],a[8:11],v[252:255]
TR a[42:43],v8,42496
CV v81,v82,v83
MC a[192:195],a[12:15],v[100:103]
TR a[44:45],v10,42240
v_add_u32 v11, 67584, v11
MC a[192:195],a[16:19],v[124:127]
TR a[46:47],v10,42496
v_mov_b32 v21, 0
MC a[192:195],a[20:23],v[140:143]
TR a[64:65],v8,50688
AR v84,a188
MC a[192:195],a[24:27],v[164:167]
TR a[66:67],v8,50944
AR v85,a189
MC a[192:195],a[28:31],v[180:183]
TR a[68:69],v10,50688
AR v86,a190
MC a[192:195],a[32:35],v[204:207]
LG 7
TR a[70:71],v10,50944
AR v87,a191
MC a[192:195],a[36:39],v[220:223]
TR a[0:1],v8,59136
CV v84,v84,v85
MC a[192:195],a[48:51],v[244:247]
TR a[2:3],v8,59392
CV v85,v86,v87
MC a[196:199],a[12:15],v[108:111]
TR a[4:5],v10,59136
s_nop 0
MC a[196:199],a[16:19],v[132:135]
TR a[6:7],v10,59392
MC a[196:199],a[20:23],v[148:151]
TR a[8:9],v8,33800
AR v88,a192
MC a[196:199],a[24:27],v[172:175]
TR a[10:11],v8,34056
AR v89,a193
MC a[196:199],a[28:31],v[188:191]
LG 7
TR a[12:13],v10,33800
AR v90,a194
MC a[196:199],a[32:35],v[212:215]
TR a[14:15],v10,34056
AR v91,a195
MC a[196:199],a[36:39],v[228:231]
TR a[16:17],v8,42248
CV v82,v88,v89
MC a[196:199],a[48:51],v[252:255]
TR a[18:19],v8,42504
CV v83,v90,v91
M v[56:59],a[52:55],v[96:99],0
buffer_store_dwordx4 v[80:83], v0, s[28:31], s51 offen sc1
MC v[56:59],a[56:59],v[120:123]
s_mov_b32 s51, 73728
TR a[20:21],v10,42248
MC v[56:59],a[40:43],v[136:139]
TR a[22:23],v10,42504
AR v92,a196
MC v[56:59],a[44:47],v[160:163]
TR a[24:25],v8,50696
AR v93,a197
MC v[56:59],a[64:67],v[176:179]
LG 6
TR a[26:27],v8,50952
AR v94,a198
MC v[56:59],a[68:71],v[200:203]
TR a[28:29],v10,50696
AR v95,a199
MC v[56:59],a[0:3],v[216:219]
TR a[30:31],v10,50952
CV v86,v92,v93
MC v[56:59],a[4:7],v[240:243]
TR a[32:33],v8,59144
CV v87,v94,v95
M v[60:63],a[52:55],v[104:107],0
buffer_store_dwordx4 v[84:87], v0, s[28:31], s51 offen sc1
MC v[60:63],a[56:59],v[128:131]
s_mov_b32 s51, 81920
TR a[34:35],v8,59400
v_subrev_u32 v8, 67584, v8
MC v[60:63],a[40:43],v[144:147]
TR a[36:37],v10,59144
MC v[60:63],a[44:47],v[168:171]
TR a[38:39],v10,59400
v_subrev_u32 v10, 67584, v10
MC v[60:63],a[64:67],v[184:187]
TR a[48:49],v9,33792
MC v[60:63],a[68:71],v[208:211]
LG 6
TR a[50:51],v9,34048
MC v[60:63],a[0:3],v[224:227]
MC v[60:63],a[4:7],v[248:251]
M v[64:67],a[52:55],v[112:115],0
TR a[52:53],v11,33792
MC v[64:67],a[56:59],a[144:147]
TR a[54:55],v11,34048
MC v[64:67],a[40:43],v[152:155]
TR a[56:57],v9,42240
MC v[64:67],a[44:47],a[148:151]
TR a[58:59],v9,42496
MC v[64:67],a[64:67],v[192:195]
TR a[40:41],v11,42240
MC v[64:67],a[68:71],a[152:155]
TR a[42:43],v11,42496
MC v[64:67],a[0:3],v[232:235]
TR a[44:45],v9,50688
MC v[64:67],a[4:7],a[156:159]
LG 7
TR a[46:47],v9,50944
M v[68:71],a[8:11],v[96:99],0
TR a[64:65],v11,50688
MC v[68:71],a[12:15],v[120:123]
TR a[66:67],v11,50944
MC v[68:71],a[16:19],v[136:139]
TR a[68:69],v9,59136
MC v[68:71],a[20:23],v[160:163]
TR a[70:71],v9,59392
MC v[68:71],a[24:27],v[176:179]
TR a[0:1],v11,59136
MC v[68:71],a[28:31],v[200:203]
TR a[2:3],v11,59392
MC v[68:71],a[32:35],v[216:219]
LG 7
TR a[4:5],v9,33800
MC v[68:71],a[36:39],v[240:243]
TR a[6:7],v9,34056
M v[72:75],a[8:11],v[104:107],0
MC v[72:75],a[12:15],v[128:131]
MC v[72:75],a[16:19],v[144:147]
MC v[72:75],a[20:23],v[168:171]
MC v[72:75],a[24:27],v[184:187]
MC v[72:75],a[28:31],v[208:211]
MC v[72:75],a[32:35],v[224:227]
MC v[72:75],a[36:39],v[248:251]
M v[76:79],a[8:11],v[112:115],0
s_waitcnt vmcnt(2)
buffer_atomic_add v4, v3, s[28:31], s42 offen sc1
MC v[76:79],a[12:15],a[144:147]
TR a[8:9],v11,33800
v_mov_b32 v4, 16
MC v[76:79],a[16:19],v[152:155]
TR a[10:11],v11,34056
MC v[76:79],a[20:23],a[148:151]
TR a[12:13],v9,42248
MC v[76:79],a[24:27],v[192:195]
TR a[14:15],v9,42504
MC v[76:79],a[28:31],a[152:155]
TR a[16:17],v11,42248
MC v[76:79],a[32:35],v[232:235]
LG 5
TR a[18:19],v11,42504
MC v[76:79],a[36:39],a[156:159]
TR a[20:21],v9,50696
M v[80:83],a[48:51],v[96:99],0
Y_pg21:
s_cbranch_execz Y_wr4
TR a[22:23],v9,50952
buffer_load_dwordx4 v13, s[24:27], s41 offen offset:0 lds
MC v[80:83],a[52:55],v[120:123]
s_add_u32 m0, s35, 4224
TR a[24:25],v11,50696
s_mov_b32 s41, 287104
MC v[80:83],a[56:59],v[136:139]
TR a[26:27],v11,50952
MC v[80:83],a[40:43],v[160:163]
TR a[28:29],v9,59144
MC v[80:83],a[44:47],v[176:179]
buffer_load_dwordx4 v13, s[24:27], s40 offen offset:0 lds
MC v[80:83],a[64:67],v[200:203]
s_add_u32 m0, s35, 8448
TR a[30:31],v9,59400
s_mov_b32 s40, 315776
MC v[80:83],a[68:71],v[216:219]
TR a[32:33],v11,59144
v_subrev_u32 v9, 67584, v9
MC v[80:83],a[0:3],v[240:243]
TR a[34:35],v11,59400
v_subrev_u32 v11, 67584, v11
M v[84:87],a[48:51],v[104:107],0
buffer_load_dwordx4 v13, s[24:27], s41 offen offset:0 lds
MC v[84:87],a[52:55],v[128:131]
s_barrier
MC v[84:87],a[56:59],v[144:147]
LG 4
TR a[36:37],v8,33792
s_add_u32 m0, s35, 12672
MC v[84:87],a[40:43],v[168:171]
s_mov_b32 s41, 344448
TR a[38:39],v8,34048
MC v[84:87],a[44:47],v[184:187]
buffer_load_dwordx4 v13, s[24:27], s40 offen offset:0 lds
MC v[84:87],a[64:67],v[208:211]
s_add_u32 m0, s35, 16896
TR a[48:49],v10,33792
s_mov_b32 s40, 373120
MC v[84:87],a[68:71],v[224:227]
TR a[50:51],v10,34048
MC v[84:87],a[0:3],v[248:251]
TR a[52:53],v8,42240
M v[88:91],a[4:7],v[96:99],0
buffer_load_dwordx4 v13, s[24:27], s41 offen offset:0 lds
MC v[88:91],a[8:11],v[120:123]
s_add_u32 m0, s35, 21120
TR a[54:55],v8,42496
s_mov_b32 s41, 401792
MC v[88:91],a[12:15],v[136:139]
TR a[56:57],v10,42240
MC v[88:91],a[16:19],v[160:163]
TR a[58:59],v10,42496
MC v[88:91],a[20:23],v[176:179]
buffer_load_dwordx4 v13, s[24:27], s40 offen offset:0 lds
MC v[88:91],a[24:27],v[200:203]
LG 5
TR a[40:41],v8,50688
s_add_u32 m0, s35, 25344
MC v[88:91],a[28:31],v[216:219]
s_mov_b32 s40, 430464
TR a[42:43],v8,50944
MC v[88:91],a[32:35],v[240:243]
TR a[44:45],v10,50688
M v[92:95],a[4:7],v[104:107],0
buffer_load_dwordx4 v13, s[24:27], s41 offen offset:0 lds
MC v[92:95],a[8:11],v[128:131]
s_add_u32 m0, s35, 29568
TR a[46:47],v10,50944
s_mov_b32 s41, 512
MC v[92:95],a[12:15],v[144:147]
TR a[64:65],v8,59136
MC v[92:95],a[16:19],v[168:171]
TR a[66:67],v8,59392
MC v[92:95],a[20:23],v[184:187]
buffer_load_dwordx4 v13, s[24:27], s40 offen offset:0 lds
MC v[92:95],a[24:27],v[208:211]
s_add_u32 m0, s35, 101376
TR a[68:69],v10,59136
s_mov_b32 s40, 29184
MC v[92:95],a[28:31],v[224:227]
TR a[70:71],v10,59392
MC v[92:95],a[32:35],v[248:251]
TR a[0:1],v8,33800
MC v[56:59],a[36:39],v[100:103]
LG 6
buffer_load_dwordx4 v13, s[24:27], s41 offen offset:0 lds
MC v[56:59],a[48:51],v[124:127]
s_add_u32 m0, s35, 105600
TR a[2:3],v8,34056
s_mov_b32 s41, 57856
MC v[56:59],a[52:55],v[140:143]
TR a[4:5],v10,33800
MC v[56:59],a[56:59],v[164:167]
TR a[6:7],v10,34056
MC v[56:59],a[40:43],v[180:183]
LG 6
buffer_load_dwordx4 v13, s[24:27], s40 offen offset:0 lds
MC v[56:59],a[44:47],v[204:207]
s_add_u32 m0, s35, 109824
TR a[8:9],v8,42248
s_mov_b32 s40, 86528
MC v[56:59],a[64:67],v[220:223]
LG 5
TR a[10:11],v8,42504
MC v[56:59],a[68:71],v[244:247]
TR a[12:13],v10,42248
s_nop 0
MC v[60:63],a[36:39],v[108:111]
buffer_load_dwordx4 v13, s[24:27], s41 offen offset:0 lds
MC v[60:63],a[48:51],v[132:135]
s_add_u32 m0, s35, 114048
TR a[14:15],v10,42504
s_mov_b32 s41, 115200
MC v[60:63],a[52:55],v[148:151]
TR a[16:17],v8,50696
CV v56,v56,v57
MC v[60:63],a[56:59],v[172:175]
TR a[18:19],v8,50952
CV v57,v58,v59
MC v[60:63],a[40:43],v[188:191]
buffer_load_dwordx4 v13, s[24:27], s40 offen offset:0 lds
MC v[60:63],a[44:47],v[212:215]
s_add_u32 m0, s35, 118272
TR a[20:21],v10,50696
s_mov_b32 s40, 143872
MC v[60:63],a[64:67],v[228:231]
TR a[22:23],v10,50952
MC v[60:63],a[68:71],v[252:255]
TR a[24:25],v8,59144
s_nop 0
MC v[64:67],a[36:39],v[116:119]
buffer_load_dwordx4 v13, s[24:27], s41 offen offset:0 lds
MC v[64:67],a[48:51],a[240:243]
s_add_u32 m0, s35, 122496
TR a[26:27],v8,59400
s_mov_b32 s41, 172544
MC v[64:67],a[52:55],v[156:159]
LG 5
TR a[28:29],v10,59144
CV v60,v60,v61
MC v[64:67],a[56:59],a[244:247]
TR a[30:31],v10,59400
CV v61,v62,v63
MC v[64:67],a[40:43],v[196:199]
buffer_load_dwordx4 v13, s[24:27], s40 offen offset:0 lds
MC v[64:67],a[44:47],a[248:251]
s_add_u32 m0, s35, 126720
TR a[32:33],v9,33792
v_add_u32 v8, 67584, v8
MC v[64:67],a[64:67],v[236:239]
s_mov_b32 s40, 201216
TR a[34:35],v9,34048
v_add_u32 v10, 67584, v10
MC v[64:67],a[68:71],a[252:255]
TR a[36:37],v11,33792
s_nop 0
MC v[68:71],a[0:3],v[100:103]
buffer_load_dwordx4 v13, s[24:27], s41 offen offset:0 lds
MC v[68:71],a[4:7],v[124:127]
s_add_u32 m0, s35, 130944
TR a[38:39],v11,34048
s_mov_b32 s41, 229888
MC v[68:71],a[8:11],v[140:143]
TR a[48:49],v9,42240
CV v64,v64,v65
MC v[68:71],a[12:15],v[164:167]
LG 5
TR a[50:51],v9,42496
CV v65,v66,v67
MC v[68:71],a[16:19],v[180:183]
buffer_load_dwordx4 v13, s[24:27], s40 offen offset:0 lds
MC v[68:71],a[20:23],v[204:207]
s_add_u32 m0, s35, 33792
TR a[52:53],v11,42240
s_mov_b32 s40, 258560
MC v[68:71],a[24:27],v[220:223]
TR a[54:55],v11,42496
MC v[68:71],a[28:31],v[244:247]
TR a[56:57],v9,50688
s_nop 0
MC v[72:75],a[0:3],v[108:111]
TR a[58:59],v9,50944
s_nop 0
MC v[72:75],a[4:7],v[132:135]
TR a[40:41],v11,50688
MC v[72:75],a[8:11],v[148:151]
TR a[42:43],v11,50944
CV v58,v68,v69
MC v[72:75],a[12:15],v[172:175]
TR a[44:45],v9,59136
CV v59,v70,v71
MC v[72:75],a[16:19],v[188:191]
TR a[46:47],v9,59392
MC v[72:75],a[20:23],v[212:215]
LG 7
TR a[64:65],v11,59136
MC v[72:75],a[24:27],v[228:231]
buffer_store_dwordx4 v[56:59], v0, s[28:31], s51 offen sc1
MC v[72:75],a[28:31],v[252:255]
s_mov_b32 s51, 90112
TR a[66:67],v11,59392
s_nop 0
MC v[76:79],a[0:3],v[116:119]
TR a[68:69],v9,33800
s_nop 0
MC v[76:79],a[4:7],a[240:243]
TR a[70:71],v9,34056
CV v62,v72,v73
MC v[76:79],a[8:11],v[156:159]
TR a[0:1],v11,33800
CV v63,v74,v75
MC v[76:79],a[12:15],a[244:247]
TR a[2:3],v11,34056
MC v[76:79],a[16:19],v[196:199]
TR a[4:5],v9,42248
MC v[76:79],a[20:23],a[248:251]
LG 6
TR a[6:7],v9,42504
MC v[76:79],a[24:27],v[236:239]
buffer_store_dwordx4 v[60:63], v0, s[28:31], s51 offen sc1
MC v[76:79],a[28:31],a[252:255]
s_mov_b32 s51, 98304
TR a[8:9],v11,42248
s_nop 0
MC v[80:83],a[32:35],v[100:103]
TR a[10:11],v11,42504
s_nop 0
MC v[80:83],a[36:39],v[124:127]
TR a[12:13],v9,50696
CV v66,v76,v77
MC v[80:83],a[48:51],v[140:143]
TR a[14:15],v9,50952
CV v67,v78,v79
MC v[80:83],a[52:55],v[164:167]
TR a[16:17],v11,50696
MC v[80:83],a[56:59],v[180:183]
TR a[18:19],v11,50952
MC v[80:83],a[40:43],v[204:207]
TR a[20:21],v9,59144
MC v[80:83],a[44:47],v[220:223]
LG 7
buffer_store_dwordx4 v[64:67], v0, s[28:31], s51 offen sc1
MC v[80:83],a[64:67],v[244:247]
s_mov_b32 s51, 106496
TR a[22:23],v9,59400
v_add_u32 v9, 67584, v9
MC v[84:87],a[32:35],v[108:111]
TR a[24:25],v11,59144
s_nop 0
MC v[84:87],a[36:39],v[132:135]
TR a[26:27],v11,59400
CV v80,v80,v81
MC v[84:87],a[48:51],v[148:151]
s_barrier
CV v81,v82,v83
v_add_u32 v11, 67584, v11
MC v[84:87],a[52:55],v[172:175]
TR a[28:29],v8,0
MC v[84:87],a[56:59],v[188:191]
TR a[30:31],v8,256
MC v[84:87],a[40:43],v[212:215]
TR a[32:33],v10,0
MC v[84:87],a[44:47],v[228:231]
TR a[34:35],v10,256
MC v[84:87],a[64:67],v[252:255]
LG 6
TR a[36:37],v8,8448
s_nop 0
MC v[88:91],a[68:71],v[100:103]
TR a[38:39],v8,8704
s_nop 0
MC v[88:91],a[0:3],v[124:127]
TR a[48:49],v10,8448
CV v84,v84,v85
MC v[88:91],a[4:7],v[140:143]
TR a[50:51],v10,8704
CV v85,v86,v87
MC v[88:91],a[8:11],v[164:167]
TR a[52:53],v8,16896
MC v[88:91],a[12:15],v[180:183]
TR a[54:55],v8,17152
MC v[88:91],a[16:19],v[204:207]
TR a[56:57],v10,16896
MC v[88:91],a[20:23],v[220:223]
LG 7
TR a[58:59],v10,17152
MC v[88:91],a[24:27],v[244:247]
TR a[40:41],v8,25344
s_nop 0
MC v[92:95],a[68:71],v[108:111]
TR a[42:43],v8,25600
s_nop 0
MC v[92:95],a[0:3],v[132:135]
TR a[44:45],v10,25344
MC v[92:95],a[4:7],v[148:151]
TR a[46:47],v10,25600
CV v82,v88,v89
MC v[92:95],a[8:11],v[172:175]
TR a[64:65],v8,8
CV v83,v90,v91
MC v[92:95],a[12:15],v[188:191]
buffer_store_dwordx4 v[80:83], v0, s[28:31], s51 offen sc1
MC v[92:95],a[16:19],v[212:215]
s_mov_b32 s51, 114688
TR a[66:67],v8,264
MC v[92:95],a[20:23],v[228:231]
LG 6
TR a[68:69],v10,8
MC v[92:95],a[24:27],v[252:255]
TR a[70:71],v10,264
s_nop 0
M v[56:59],a[28:31],v[96:99],0
TR a[0:1],v8,8456
s_nop 0
MC v[56:59],a[32:35],v[120:123]
TR a[2:3],v8,8712
MC v[56:59],a[36:39],v[136:139]
TR a[4:5],v10,8456
CV v86,v92,v93
MC v[56:59],a[48:51],v[160:163]
TR a[6:7],v10,8712
CV v87,v94,v95
MC v[56:59],a[52:55],v[176:179]
buffer_store_dwordx4 v[84:87], v0, s[28:31], s51 offen sc1
MC v[56:59],a[56:59],v[200:203]
LG 6
TR a[8:9],v8,16904
s_mov_b32 s51, 122880
MC v[56:59],a[40:43],v[216:219]
TR a[10:11],v8,17160
MC v[56:59],a[44:47],v[240:243]
TR a[12:13],v10,16904
M v[60:63],a[28:31],v[104:107],0
TR a[14:15],v10,17160
MC v[60:63],a[32:35],v[128:131]
TR a[16:17],v8,25352
MC v[60:63],a[36:39],v[144:147]
TR a[18:19],v8,25608
v_subrev_u32 v8, 67584, v8
MC v[60:63],a[48:51],v[168:171]
TR a[20:21],v10,25352
MC v[60:63],a[52:55],v[184:187]
TR a[22:23],v10,25608
v_subrev_u32 v10, 67584, v10
MC v[60:63],a[56:59],v[208:211]
LG 7
TR a[24:25],v9,0
MC v[60:63],a[40:43],v[224:227]
TR a[26:27],v9,256
MC v[60:63],a[44:47],v[248:251]
M v[64:67],a[28:31],v[112:115],0
TR a[28:29],v11,0
MC v[64:67],a[32:35],a[144:147]
TR a[30:31],v11,256
MC v[64:67],a[36:39],v[152:155]
TR a[32:33],v9,8448
MC v[64:67],a[48:51],a[148:151]
TR a[34:35],v9,8704
MC v[64:67],a[52:55],v[192:195]
TR a[36:37],v11,8448
MC v[64:67],a[56:59],a[152:155]
LG 6
TR a[38:39],v11,8704
MC v[64:67],a[40:43],v[232:235]
TR a[48:49],v9,16896
MC v[64:67],a[44:47],a[156:159]
TR a[50:51],v9,17152
M v[68:71],a[64:67],v[96:99],0
TR a[52:53],v11,16896
MC v[68:71],a[68:71],v[120:123]
TR a[54:55],v11,17152
MC v[68:71],a[0:3],v[136:139]
TR a[56:57],v9,25344
MC v[68:71],a[4:7],v[160:163]
TR a[58:59],v9,25600
MC v[68:71],a[8:11],v[176:179]
TR a[40:41],v11,25344
MC v[68:71],a[12:15],v[200:203]
LG 7
TR a[42:43],v11,25600
MC v[68:71],a[16:19],v[216:219]
TR a[44:45],v9,8
MC v[68:71],a[20:23],v[240:243]
TR a[46:47],v9,264
M v[72:75],a[64:67],v[104:107],0
MC v[72:75],a[68:71],v[128:131]
MC v[72:75],a[0:3],v[144:147]
MC v[72:75],a[4:7],v[168:171]
MC v[72:75],a[8:11],v[184:187]
MC v[72:75],a[12:15],v[208:211]
MC v[72:75],a[16:19],v[224:227]
MC v[72:75],a[20:23],v[248:251]
M v[76:79],a[64:67],v[112:115],0
TR a[64:65],v11,8
MC v[76:79],a[68:71],a[144:147]
TR a[66:67],v11,264
MC v[76:79],a[0:3],v[152:155]
TR a[68:69],v9,8456
MC v[76:79],a[4:7],a[148:151]
TR a[70:71],v9,8712
MC v[76:79],a[8:11],v[192:195]
LG 4
TR a[0:1],v11,8456
MC v[76:79],a[12:15],a[152:155]
TR a[2:3],v11,8712
MC v[76:79],a[16:19],v[232:235]
TR a[4:5],v9,16904
MC v[76:79],a[20:23],a[156:159]
TR a[6:7],v9,17160
M v[80:83],a[24:27],v[96:99],0
buffer_load_dwordx4 v13, s[24:27], s41 offen offset:0 lds
MC v[80:83],a[28:31],v[120:123]
s_add_u32 m0, s35, 38016
TR a[8:9],v11,16904
s_mov_b32 s41, 287232
MC v[80:83],a[32:35],v[136:139]
TR a[10:11],v11,17160
MC v[80:83],a[36:39],v[160:163]
TR a[12:13],v9,25352
MC v[80:83],a[48:51],v[176:179]
buffer_load_dwordx4 v13, s[24:27], s40 offen offset:0 lds
MC v[80:83],a[52:55],v[200:203]
s_add_u32 m0, s35, 42240
TR a[14:15],v9,25608
s_mov_b32 s40, 315904
MC v[80:83],a[56:59],v[216:219]
TR a[16:17],v11,25352
v_subrev_u32 v9, 67584, v9
MC v[80:83],a[40:43],v[240:243]
TR a[18:19],v11,25608
v_subrev_u32 v11, 67584, v11
M v[84:87],a[24:27],v[104:107],0
s_waitcnt vmcnt(2)
buffer_atomic_add v4, v3, s[28:31], s42 offen sc1
MC v[84:87],a[28:31],v[128:131]
s_barrier
MC v[84:87],a[32:35],v[144:147]
LG 4
TR a[20:21],v8,0
s_nop 0
MC v[84:87],a[36:39],v[168:171]
TR a[22:23],v8,256
v_mov_b32 v4, 256
MC v[84:87],a[48:51],v[184:187]
buffer_atomic_add v21, v3, s[28:31], s42 offen sc0 sc1
MC v[84:87],a[52:55],v[208:211]
TR a[24:25],v10,0
MC v[84:87],a[56:59],v[224:227]
TR a[26:27],v10,256
MC v[84:87],a[40:43],v[248:251]
TR a[28:29],v8,8448
M v[88:91],a[44:47],v[96:99],0
buffer_load_dwordx4 v13, s[24:27], s41 offen offset:0 lds
MC v[88:91],a[64:67],v[120:123]
s_add_u32 m0, s35, 46464
TR a[30:31],v8,8704
s_mov_b32 s41, 344576
MC v[88:91],a[68:71],v[136:139]
TR a[32:33],v10,8448
MC v[88:91],a[0:3],v[160:163]
TR a[34:35],v10,8704
MC v[88:91],a[4:7],v[176:179]
buffer_load_dwordx4 v13, s[24:27], s40 offen offset:0 lds
MC v[88:91],a[8:11],v[200:203]
LG 5
TR a[36:37],v8,16896
s_add_u32 m0, s35, 50688
MC v[88:91],a[12:15],v[216:219]
s_mov_b32 s40, 373248
TR a[38:39],v8,17152
MC v[88:91],a[16:19],v[240:243]
TR a[48:49],v10,16896
M v[92:95],a[44:47],v[104:107],0
buffer_load_dwordx4 v13, s[24:27], s41 offen offset:0 lds
MC v[92:95],a[64:67],v[128:131]
s_add_u32 m0, s35, 54912
TR a[50:51],v10,17152
s_mov_b32 s41, 401920
MC v[92:95],a[68:71],v[144:147]
TR a[52:53],v8,25344
MC v[92:95],a[0:3],v[168:171]
TR a[54:55],v8,25600
MC v[92:95],a[4:7],v[184:187]
buffer_load_dwordx4 v13, s[24:27], s40 offen offset:0 lds
MC v[92:95],a[8:11],v[208:211]
s_add_u32 m0, s35, 59136
TR a[56:57],v10,25344
s_mov_b32 s40, 430592
MC v[92:95],a[12:15],v[224:227]
TR a[58:59],v10,25600
MC v[92:95],a[16:19],v[248:251]
TR a[40:41],v8,8
MC v[56:59],a[20:23],v[100:103]
LG 6
buffer_load_dwordx4 v13, s[24:27], s41 offen offset:0 lds
MC v[56:59],a[24:27],v[124:127]
s_add_u32 m0, s35, 63360
TR a[42:43],v8,264
s_mov_b32 s41, 640
MC v[56:59],a[28:31],v[140:143]
TR a[44:45],v10,8
MC v[56:59],a[32:35],v[164:167]
TR a[46:47],v10,264
MC v[56:59],a[36:39],v[180:183]
LG 6
buffer_load_dwordx4 v13, s[24:27], s40 offen offset:0 lds
MC v[56:59],a[48:51],v[204:207]
s_add_u32 m0, s35, 67584
TR a[64:65],v8,8456
s_mov_b32 s40, 29312
MC v[56:59],a[52:55],v[220:223]
LG 5
TR a[66:67],v8,8712
MC v[56:59],a[56:59],v[244:247]
TR a[68:69],v10,8456
s_nop 0
MC v[60:63],a[20:23],v[108:111]
buffer_load_dwordx4 v13, s[24:27], s41 offen offset:0 lds
MC v[60:63],a[24:27],v[132:135]
s_add_u32 m0, s35, 71808
TR a[70:71],v10,8712
s_mov_b32 s41, 57984
MC v[60:63],a[28:31],v[148:151]
TR a[0:1],v8,16904
CV v56,v56,v57
MC v[60:63],a[32:35],v[172:175]
TR a[2:3],v8,17160
CV v57,v58,v59
MC v[60:63],a[36:39],v[188:191]
buffer_load_dwordx4 v13, s[24:27], s40 offen offset:0 lds
MC v[60:63],a[48:51],v[212:215]
s_add_u32 m0, s35, 76032
TR a[4:5],v10,16904
s_mov_b32 s40, 86656
MC v[60:63],a[52:55],v[228:231]
Y_pg22:
s_cbranch_execz Y_wr4
TR a[6:7],v10,17160
MC v[60:63],a[56:59],v[252:255]
TR a[8:9],v8,25352
s_nop 0
MC v[64:67],a[20:23],v[116:119]
buffer_load_dwordx4 v13, s[24:27], s41 offen offset:0 lds
MC v[64:67],a[24:27],a[240:243]
s_add_u32 m0, s35, 80256
TR a[10:11],v8,25608
s_mov_b32 s41, 115328
MC v[64:67],a[28:31],v[156:159]
LG 5
TR a[12:13],v10,25352
CV v60,v60,v61
MC v[64:67],a[32:35],a[244:247]
TR a[14:15],v10,25608
CV v61,v62,v63
MC v[64:67],a[36:39],v[196:199]
buffer_load_dwordx4 v13, s[24:27], s40 offen offset:0 lds
MC v[64:67],a[48:51],a[248:251]
s_add_u32 m0, s35, 84480
TR a[16:17],v9,0
v_add_u32 v8, 67584, v8
MC v[64:67],a[52:55],v[236:239]
s_mov_b32 s40, 144000
TR a[18:19],v9,256
v_add_u32 v10, 67584, v10
MC v[64:67],a[56:59],a[252:255]
TR a[20:21],v11,0
s_nop 0
MC v[68:71],a[40:43],v[100:103]
buffer_load_dwordx4 v13, s[24:27], s41 offen offset:0 lds
MC v[68:71],a[44:47],v[124:127]
s_add_u32 m0, s35, 88704
TR a[22:23],v11,256
s_mov_b32 s41, 172672
MC v[68:71],a[64:67],v[140:143]
TR a[24:25],v9,8448
CV v64,v64,v65
MC v[68:71],a[68:71],v[164:167]
LG 5
TR a[26:27],v9,8704
CV v65,v66,v67
MC v[68:71],a[0:3],v[180:183]
buffer_load_dwordx4 v13, s[24:27], s40 offen offset:0 lds
MC v[68:71],a[4:7],v[204:207]
s_add_u32 m0, s35, 92928
TR a[28:29],v11,8448
s_mov_b32 s40, 201344
MC v[68:71],a[8:11],v[220:223]
TR a[30:31],v11,8704
MC v[68:71],a[12:15],v[244:247]
s_waitcnt vmcnt(12)
v_readfirstlane_b32 s101, v21
s_nop 1
s_bitcmp1_b32 s101, 3
s_cbranch_scc0 Y_spinA0
Y_backA0:
TR a[32:33],v9,16896
v_mov_b32 v21, 0
MC v[72:75],a[40:43],v[108:111]
buffer_load_dwordx4 v13, s[24:27], s41 offen offset:0 lds
MC v[72:75],a[44:47],v[132:135]
s_add_u32 m0, s35, 97152
TR a[34:35],v9,17152
CV v58,v68,v69
MC v[72:75],a[64:67],v[148:151]
s_mov_b32 s41, 230016
TR a[36:37],v11,16896
CV v59,v70,v71
MC v[72:75],a[68:71],v[172:175]
TR a[38:39],v11,17152
MC v[72:75],a[0:3],v[188:191]
TR a[48:49],v9,25344
buffer_load_dwordx4 v13, s[24:27], s40 offen offset:0 lds
MC v[72:75],a[4:7],v[212:215]
s_add_u32 m0, s35, 0
TR a[50:51],v9,25600
s_mov_b32 s40, 258688
MC v[72:75],a[8:11],v[228:231]
LG 6
TR a[52:53],v11,25344
MC v[72:75],a[12:15],v[252:255]
TR a[54:55],v11,25600
s_nop 0
MC v[76:79],a[40:43],v[116:119]
buffer_load_dwordx4 a[72:75], v1, s[28:31], s44 offen offset:0 sc1
MC v[76:79],a[44:47],a[240:243]
TR a[56:57],v9,8
s_nop 0
MC v[76:79],a[64:67],v[156:159]
TR a[58:59],v9,264
CV v62,v72,v73
MC v[76:79],a[68:71],a[244:247]
TR a[40:41],v11,8
CV v63,v74,v75
MC v[76:79],a[0:3],v[196:199]
buffer_store_dwordx4 v[56:59], v0, s[28:31], s51 offen sc1
MC v[76:79],a[4:7],a[248:251]
s_mov_b32 s51, 131072
TR a[42:43],v11,264
MC v[76:79],a[8:11],v[236:239]
TR a[44:45],v9,8456
MC v[76:79],a[12:15],a[252:255]
TR a[46:47],v9,8712
s_nop 0
MC v[80:83],a[16:19],v[100:103]
buffer_load_dwordx4 a[76:79], v1, s[28:31], s44 offen offset:1024 sc1
MC v[80:83],a[20:23],v[124:127]
LG 5
TR a[64:65],v11,8456
MC v[80:83],a[24:27],v[140:143]
TR a[66:67],v11,8712
CV v66,v76,v77
MC v[80:83],a[28:31],v[164:167]
TR a[68:69],v9,16904
CV v67,v78,v79
MC v[80:83],a[32:35],v[180:183]
buffer_store_dwordx4 v[60:63], v0, s[28:31], s51 offen sc1
MC v[80:83],a[36:39],v[204:207]
s_mov_b32 s51, 139264
TR a[70:71],v9,17160
MC v[80:83],a[48:51],v[220:223]
TR a[0:1],v11,16904
MC v[80:83],a[52:55],v[244:247]
TR a[2:3],v11,17160
s_nop 0
MC v[84:87],a[16:19],v[108:111]
buffer_store_dwordx4 v[64:67], v0, s[28:31], s51 offen sc1
MC v[84:87],a[20:23],v[132:135]
s_mov_b32 s51, 147456
TR a[4:5],v9,25352
MC v[84:87],a[24:27],v[148:151]
TR a[6:7],v9,25608
CV v80,v80,v81
MC v[84:87],a[28:31],v[172:175]
TR a[8:9],v11,25352
CV v81,v82,v83
MC v[84:87],a[32:35],v[188:191]
buffer_load_dwordx4 a[80:83], v1, s[28:31], s44 offen offset:2048 sc1
MC v[84:87],a[36:39],v[212:215]
LG 5
TR a[10:11],v11,25608
v_add_u32 v9, 67584, v9
MC v[84:87],a[48:51],v[228:231]
s_barrier
v_add_u32 v11, 67584, v11
MC v[84:87],a[52:55],v[252:255]
TR a[12:13],v8,33792
s_nop 0
MC v[88:91],a[56:59],v[100:103]
TR a[14:15],v8,34048
s_nop 0
MC v[88:91],a[40:43],v[124:127]
TR a[16:17],v10,33792
MC v[88:91],a[44:47],v[140:143]
TR a[18:19],v10,34048
CV v84,v84,v85
MC v[88:91],a[64:67],v[164:167]
TR a[20:21],v8,42240
CV v85,v86,v87
MC v[88:91],a[68:71],v[180:183]
LG 6
TR a[22:23],v8,42496
MC v[88:91],a[0:3],v[204:207]
TR a[24:25],v10,42240
buffer_load_dwordx4 a[84:87], v1, s[28:31], s44 offen offset:3072 sc1
MC v[88:91],a[4:7],v[220:223]
LG 7
TR a[26:27],v10,42496
s_lshl_b32 s44, s38, 13
MC v[88:91],a[8:11],v[244:247]
s_add_u32 s44, s44, 65536
TR a[28:29],v8,50688
s_cmp_ge_u32 s38, 7
s_cselect_b32 s44, 0x40000000, s44
MC v[92:95],a[56:59],v[108:111]
TR a[30:31],v8,50944
s_nop 0
MC v[92:95],a[40:43],v[132:135]
TR a[32:33],v10,50688
CV v82,v88,v89
MC v[92:95],a[44:47],v[148:151]
TR a[34:35],v10,50944
CV v83,v90,v91
MC v[92:95],a[64:67],v[172:175]
TR a[36:37],v8,59136
MC v[92:95],a[68:71],v[188:191]
TR a[38:39],v8,59392
MC v[92:95],a[0:3],v[212:215]
LG 7
TR a[48:49],v10,59136
MC v[92:95],a[4:7],v[228:231]
TR a[50:51],v10,59392
MC v[92:95],a[8:11],v[252:255]
TR a[52:53],v8,33800
s_nop 0
M v[56:59],a[12:15],v[96:99],0
buffer_load_dwordx4 a[88:91], v1, s[28:31], s45 offen offset:0 sc1
MC v[56:59],a[16:19],v[120:123]
TR a[54:55],v8,34056
s_nop 0
MC v[56:59],a[20:23],v[136:139]
LG 6
TR a[56:57],v10,33800
CV v86,v92,v93
MC v[56:59],a[24:27],v[160:163]
TR a[58:59],v10,34056
CV v87,v94,v95
MC v[56:59],a[28:31],v[176:179]
buffer_store_dwordx4 v[80:83], v0, s[28:31], s51 offen sc1
MC v[56:59],a[32:35],v[200:203]
LG 5
TR a[40:41],v8,42248
s_mov_b32 s51, 155648
MC v[56:59],a[36:39],v[216:219]
LG 5
TR a[42:43],v8,42504
MC v[56:59],a[48:51],v[240:243]
TR a[44:45],v10,42248
M v[60:63],a[12:15],v[104:107],0
buffer_store_dwordx4 v[84:87], v0, s[28:31], s51 offen sc1
MC v[60:63],a[16:19],v[128:131]
s_mov_b32 s51, 163840
TR a[46:47],v10,42504
MC v[60:63],a[20:23],v[144:147]
TR a[64:65],v8,50696
MC v[60:63],a[24:27],v[168:171]
TR a[66:67],v8,50952
MC v[60:63],a[28:31],v[184:187]
buffer_load_dwordx4 a[92:95], v1, s[28:31], s45 offen offset:1024 sc1
MC v[60:63],a[32:35],v[208:211]
TR a[68:69],v10,50696
MC v[60:63],a[36:39],v[224:227]
TR a[70:71],v10,50952
MC v[60:63],a[48:51],v[248:251]
TR a[0:1],v8,59144
M v[64:67],a[12:15],v[112:115],0
TR a[2:3],v8,59400
v_subrev_u32 v8, 67584, v8
MC v[64:67],a[16:19],a[144:147]
LG 6
TR a[4:5],v10,59144
MC v[64:67],a[20:23],v[152:155]
TR a[6:7],v10,59400
v_subrev_u32 v10, 67584, v10
MC v[64:67],a[24:27],a[148:151]
TR a[8:9],v9,33792
MC v[64:67],a[28:31],v[192:195]
TR a[10:11],v9,34048
MC v[64:67],a[32:35],a[152:155]
TR a[12:13],v11,33792
MC v[64:67],a[36:39],v[232:235]
buffer_load_dwordx4 a[128:131], v1, s[28:31], s45 offen offset:2048 sc1
MC v[64:67],a[48:51],a[156:159]
TR a[14:15],v11,34048
M v[68:71],a[52:55],v[96:99],0
TR a[16:17],v9,42240
MC v[68:71],a[56:59],v[120:123]
TR a[18:19],v9,42496
MC v[68:71],a[40:43],v[136:139]
LG 6
TR a[20:21],v11,42240
MC v[68:71],a[44:47],v[160:163]
TR a[22:23],v11,42496
MC v[68:71],a[64:67],v[176:179]
TR a[24:25],v9,50688
MC v[68:71],a[68:71],v[200:203]
TR a[26:27],v9,50944
MC v[68:71],a[0:3],v[216:219]
s_nop 0
TR a[28:29],v11,50688
MC v[68:71],a[4:7],v[240:243]
TR a[30:31],v11,50944
M v[72:75],a[52:55],v[104:107],0
buffer_atomic_add v21, v3, s[28:31], s42 offen sc0 sc1
MC v[72:75],a[56:59],v[128:131]
TR a[32:33],v9,59136
MC v[72:75],a[40:43],v[144:147]
TR a[34:35],v9,59392
MC v[72:75],a[44:47],v[168:171]
LG 6
TR a[36:37],v11,59136
MC v[72:75],a[64:67],v[184:187]
buffer_load_dwordx4 a[132:135], v1, s[28:31], s45 offen offset:3072 sc1
MC v[72:75],a[68:71],v[208:211]
s_lshl_b32 s45, s38, 13
TR a[38:39],v11,59392
s_add_u32 s45, s45, 69632
MC v[72:75],a[0:3],v[224:227]
s_cmp_ge_u32 s38, 7
s_cselect_b32 s45, 0x40000000, s45
TR a[48:49],v9,33800
MC v[72:75],a[4:7],v[248:251]
TR a[50:51],v9,34056
M v[76:79],a[52:55],v[112:115],0
TR a[52:53],v11,33800
MC v[76:79],a[56:59],a[144:147]
TR a[54:55],v11,34056
MC v[76:79],a[40:43],v[152:155]
TR a[56:57],v9,42248
MC v[76:79],a[44:47],a[148:151]
TR a[58:59],v9,42504
MC v[76:79],a[64:67],v[192:195]
LG 7
TR a[40:41],v11,42248
MC v[76:79],a[68:71],a[152:155]
TR a[42:43],v11,42504
MC v[76:79],a[0:3],v[232:235]
TR a[44:45],v9,50696
MC v[76:79],a[4:7],a[156:159]
TR a[46:47],v9,50952
M v[80:83],a[8:11],v[96:99],0
TR a[64:65],v11,50696
buffer_load_dwordx4 v13, s[24:27], s41 offen offset:0 lds
MC v[80:83],a[12:15],v[120:123]
s_add_u32 m0, s35, 4224
TR a[66:67],v11,50952
s_mov_b32 s41, 287360
MC v[80:83],a[16:19],v[136:139]
TR a[68:69],v9,59144
MC v[80:83],a[20:23],v[160:163]
LG 7
TR a[70:71],v9,59400
v_subrev_u32 v9, 67584, v9
MC v[80:83],a[24:27],v[176:179]
buffer_load_dwordx4 v13, s[24:27], s40 offen offset:0 lds
MC v[80:83],a[28:31],v[200:203]
s_add_u32 m0, s35, 8448
TR a[0:1],v11,59144
s_mov_b32 s40, 316032
MC v[80:83],a[32:35],v[216:219]
TR a[2:3],v11,59400
v_subrev_u32 v11, 67584, v11
MC v[80:83],a[36:39],v[240:243]
s_waitcnt vmcnt(24)
s_barrier
M v[84:87],a[8:11],v[104:107],0
buffer_load_dwordx4 v13, s[24:27], s41 offen offset:0 lds
MC v[84:87],a[12:15],v[128:131]
s_add_u32 m0, s35, 12672
TR a[4:5],v8,33792
s_mov_b32 s41, 344704
MC v[84:87],a[16:19],v[144:147]
TR a[6:7],v8,34048
MC v[84:87],a[20:23],v[168:171]
TR a[8:9],v10,33792
MC v[84:87],a[24:27],v[184:187]
buffer_load_dwordx4 v13, s[24:27], s40 offen offset:0 lds
MC v[84:87],a[28:31],v[208:211]
s_add_u32 m0, s35, 16896
TR a[10:11],v10,34048
s_mov_b32 s40, 373376
MC v[84:87],a[32:35],v[224:227]
LG 4
TR a[12:13],v8,42240
MC v[84:87],a[36:39],v[248:251]
TR a[14:15],v8,42496
M v[88:91],a[48:51],v[96:99],0
buffer_load_dwordx4 v13, s[24:27], s41 offen offset:0 lds
MC v[88:91],a[52:55],v[120:123]
s_add_u32 m0, s35, 21120
TR a[16:17],v10,42240
s_mov_b32 s41, 402048
MC v[88:91],a[56:59],v[136:139]
TR a[18:19],v10,42496
MC v[88:91],a[40:43],v[160:163]
TR a[20:21],v8,50688
MC v[88:91],a[44:47],v[176:179]
buffer_load_dwordx4 v13, s[24:27], s40 offen offset:0 lds
MC v[88:91],a[64:67],v[200:203]
s_add_u32 m0, s35, 25344
TR a[22:23],v8,50944
s_mov_b32 s40, 430720
MC v[88:91],a[68:71],v[216:219]
TR a[24:25],v10,50688
MC v[88:91],a[0:3],v[240:243]
TR a[26:27],v10,50944
M v[92:95],a[48:51],v[104:107],0
buffer_load_dwordx4 v13, s[24:27], s41 offen offset:0 lds
MC v[92:95],a[52:55],v[128:131]
s_add_u32 m0, s35, 29568
TR a[28:29],v8,59136
s_mov_b32 s41, 768
MC v[92:95],a[56:59],v[144:147]
TR a[30:31],v8,59392
MC v[92:95],a[40:43],v[168:171]
LG 5
TR a[32:33],v10,59136
MC v[92:95],a[44:47],v[184:187]
buffer_load_dwordx4 v13, s[24:27], s40 offen offset:0 lds
MC v[92:95],a[64:67],v[208:211]
s_add_u32 m0, s35, 101376
TR a[34:35],v10,59392
s_mov_b32 s40, 29440
MC v[92:95],a[68:71],v[224:227]
TR a[36:37],v8,33800
MC v[92:95],a[0:3],v[248:251]
TR a[38:39],v8,34056
MC v[56:59],a[4:7],v[100:103]
buffer_load_dwordx4 v13, s[24:27], s41 offen offset:0 lds
MC v[56:59],a[8:11],v[124:127]
s_add_u32 m0, s35, 105600
TR a[48:49],v10,33800
s_mov_b32 s41, 58112
MC v[56:59],a[12:15],v[140:143]
TR a[50:51],v10,34056
MC v[56:59],a[16:19],v[164:167]
LG 5
TR a[52:53],v8,42248
MC v[56:59],a[20:23],v[180:183]
buffer_load_dwordx4 v13, s[24:27], s40 offen offset:0 lds
MC v[56:59],a[24:27],v[204:207]
s_add_u32 m0, s35, 109824
TR a[54:55],v8,42504
s_mov_b32 s40, 86784
MC v[56:59],a[28:31],v[220:223]
LG 5
TR a[56:57],v10,42248
MC v[56:59],a[32:35],v[244:247]
TR a[58:59],v10,42504
s_nop 0
MC v[60:63],a[4:7],v[108:111]
buffer_load_dwordx4 v13, s[24:27], s41 offen offset:0 lds
MC v[60:63],a[8:11],v[132:135]
s_add_u32 m0, s35, 114048
TR a[40:41],v8,50696
s_mov_b32 s41, 115456
MC v[60:63],a[12:15],v[148:151]
TR a[42:43],v8,50952
CV v56,v56,v57
MC v[60:63],a[16:19],v[172:175]
TR a[44:45],v10,50696
CV v57,v58,v59
MC v[60:63],a[20:23],v[188:191]
buffer_load_dwordx4 v13, s[24:27], s40 offen offset:0 lds
MC v[60:63],a[24:27],v[212:215]
s_add_u32 m0, s35, 118272
TR a[46:47],v10,50952
s_mov_b32 s40, 144128
MC v[60:63],a[28:31],v[228:231]
TR a[64:65],v8,59144
MC v[60:63],a[32:35],v[252:255]
TR a[66:67],v8,59400
v_add_u32 v8, 67584, v8
MC v[64:67],a[4:7],v[116:119]
buffer_load_dwordx4 v13, s[24:27], s41 offen offset:0 lds
MC v[64:67],a[8:11],a[240:243]
s_add_u32 m0, s35, 122496
TR a[68:69],v10,59144
s_mov_b32 s41, 172800
MC v[64:67],a[12:15],v[156:159]
LG 5
TR a[70:71],v10,59400
CV v60,v60,v61
MC v[64:67],a[16:19],a[244:247]
TR a[0:1],v9,33792
CV v61,v62,v63
MC v[64:67],a[20:23],v[196:199]
buffer_load_dwordx4 v13, s[24:27], s40 offen offset:0 lds
MC v[64:67],a[24:27],a[248:251]
s_add_u32 m0, s35, 126720
TR a[2:3],v9,34048
v_add_u32 v10, 67584, v10
MC v[64:67],a[28:31],v[236:239]
s_mov_b32 s40, 201472
TR a[4:5],v11,33792
MC v[64:67],a[32:35],a[252:255]
TR a[6:7],v11,34048
s_nop 0
MC v[68:71],a[36:39],v[100:103]
buffer_load_dwordx4 v13, s[24:27], s41 offen offset:0 lds
MC v[68:71],a[48:51],v[124:127]
s_add_u32 m0, s35, 130944
TR a[8:9],v9,42240
s_mov_b32 s41, 230144
MC v[68:71],a[52:55],v[140:143]
TR a[10:11],v9,42496
CV v64,v64,v65
MC v[68:71],a[56:59],v[164:167]
s_waitcnt vmcnt(16)
v_readfirstlane_b32 s101, v21
s_nop 1
s_bitcmp1_b32 s101, 7
s_cbranch_scc0 Y_spinA1
Y_backA1:
TR a[12:13],v11,42240
CV v65,v66,v67
MC v[68:71],a[40:43],v[180:183]
LG 6
buffer_load_dwordx4 v13, s[24:27], s40 offen offset:0 lds
MC v[68:71],a[44:47],v[204:207]
s_add_u32 m0, s35, 33792
TR a[14:15],v11,42496
v_mov_b32 v21, 0
MC v[68:71],a[64:67],v[220:223]
s_mov_b32 s40, 258816
TR a[16:17],v9,50688
v_cmp_eq_u32 vcc, v31, v32
MC v[68:71],a[68:71],v[244:247]
TR a[18:19],v9,50944
v_and_b32 v31, 1, v30
MC v[72:75],a[36:39],v[108:111]
TR a[20:21],v11,50688
v_mov_b32 v32, 0x3f80
MC v[72:75],a[48:51],v[132:135]
buffer_load_dwordx4 a[96:99], v1, s[28:31], s44 offen offset:0 sc1
MC v[72:75],a[52:55],v[148:151]
TR a[22:23],v11,50944
CV v58,v68,v69
MC v[72:75],a[56:59],v[172:175]
TR a[24:25],v9,59136
CV v59,v70,v71
MC v[72:75],a[40:43],v[188:191]
TR a[26:27],v9,59392
v_lshlrev_b32 v31, 4, v31
MC v[72:75],a[44:47],v[212:215]
TR a[28:29],v11,59136
v_and_b32 v30, 2, v30
MC v[72:75],a[64:67],v[228:231]
LG 6
TR a[30:31],v11,59392
v_lshlrev_b32 v31, v31, v32
MC v[72:75],a[68:71],v[252:255]
TR a[32:33],v9,33800
v_cndmask_b32 v31, 0, v31, vcc
MC v[76:79],a[36:39],v[116:119]
buffer_store_dwordx4 v[56:59], v0, s[28:31], s51 offen sc1
MC v[76:79],a[48:51],a[240:243]
s_mov_b32 s51, 172032
TR a[34:35],v9,34056
v_cmp_eq_u32 vcc, 0, v30
MC v[76:79],a[52:55],v[156:159]
TR a[36:37],v11,33800
CV v62,v72,v73
MC v[76:79],a[56:59],a[244:247]
TR a[38:39],v11,34056
CV v63,v74,v75
MC v[76:79],a[40:43],v[196:199]
buffer_load_dwordx4 a[100:103], v1, s[28:31], s44 offen offset:1024 sc1
MC v[76:79],a[44:47],a[248:251]
TR a[48:49],v9,42248
v_cndmask_b32 v26, 0, v31, vcc
MC v[76:79],a[64:67],v[236:239]
TR a[50:51],v9,42504
v_sub_u32 v27, v31, v26
MC v[76:79],a[68:71],a[252:255]
Y_pg23:
s_cbranch_execz Y_wr4
TR a[52:53],v11,42248
s_nop 0
MC v[80:83],a[0:3],v[100:103]
LG 6
TR a[54:55],v11,42504
s_nop 0
MC v[80:83],a[4:7],v[124:127]
TR a[56:57],v9,50696
CV v66,v76,v77
MC v[80:83],a[8:11],v[140:143]
buffer_store_dwordx4 v[60:63], v0, s[28:31], s51 offen sc1
MC v[80:83],a[12:15],v[164:167]
s_mov_b32 s51, 180224
TR a[58:59],v9,50952
CV v67,v78,v79
MC v[80:83],a[16:19],v[180:183]
TR a[40:41],v11,50696
MC v[80:83],a[20:23],v[204:207]
TR a[42:43],v11,50952
MC v[80:83],a[24:27],v[220:223]
TR a[44:45],v9,59144
MC v[80:83],a[28:31],v[244:247]
buffer_load_dwordx4 a[104:107], v1, s[28:31], s44 offen offset:2048 sc1
MC v[84:87],a[0:3],v[108:111]
TR a[46:47],v9,59400
v_add_u32 v9, 67584, v9
MC v[84:87],a[4:7],v[132:135]
TR a[64:65],v11,59144
s_nop 0
MC v[84:87],a[8:11],v[148:151]
LG 6
TR a[66:67],v11,59400
CV v80,v80,v81
MC v[84:87],a[12:15],v[172:175]
buffer_store_dwordx4 v[64:67], v0, s[28:31], s51 offen sc1
MC v[84:87],a[16:19],v[188:191]
s_barrier
CV v81,v82,v83
v_add_u32 v11, 67584, v11
MC v[84:87],a[20:23],v[212:215]
s_mov_b32 s51, 188416
TR a[68:69],v8,0
MC v[84:87],a[24:27],v[228:231]
TR a[70:71],v8,256
MC v[84:87],a[28:31],v[252:255]
TR a[0:1],v10,0
s_nop 0
MC v[88:91],a[32:35],v[100:103]
TR a[2:3],v10,256
s_nop 0
MC v[88:91],a[36:39],v[124:127]
TR a[4:5],v8,8448
MC v[88:91],a[48:51],v[140:143]
buffer_load_dwordx4 a[108:111], v1, s[28:31], s44 offen offset:3072 sc1
MC v[88:91],a[52:55],v[164:167]
LG 5
TR a[6:7],v8,8704
CV v84,v84,v85
MC v[88:91],a[56:59],v[180:183]
s_lshl_b32 s44, s38, 13
TR a[8:9],v10,8448
CV v85,v86,v87
MC v[88:91],a[40:43],v[204:207]
s_add_u32 s44, s44, 122880
TR a[10:11],v10,8704
MC v[88:91],a[44:47],v[220:223]
TR a[12:13],v8,16896
MC v[88:91],a[64:67],v[244:247]
TR a[14:15],v8,17152
s_nop 0
MC v[92:95],a[32:35],v[108:111]
TR a[16:17],v10,16896
s_nop 0
MC v[92:95],a[36:39],v[132:135]
TR a[18:19],v10,17152
MC v[92:95],a[48:51],v[148:151]
TR a[20:21],v8,25344
CV v82,v88,v89
MC v[92:95],a[52:55],v[172:175]
TR a[22:23],v8,25600
CV v83,v90,v91
MC v[92:95],a[56:59],v[188:191]
LG 7
TR a[24:25],v10,25344
MC v[92:95],a[40:43],v[212:215]
buffer_load_dwordx4 a[112:115], v1, s[28:31], s45 offen offset:0 sc1
MC v[92:95],a[44:47],v[228:231]
TR a[26:27],v10,25600
MC v[92:95],a[64:67],v[252:255]
TR a[28:29],v8,8
s_nop 0
M v[56:59],a[68:71],v[96:99],0
TR a[30:31],v8,264
s_nop 0
MC v[56:59],a[0:3],v[120:123]
buffer_store_dwordx4 v[80:83], v0, s[28:31], s51 offen sc1
MC v[56:59],a[4:7],v[136:139]
LG 5
TR a[32:33],v10,8
CV v86,v92,v93
MC v[56:59],a[8:11],v[160:163]
s_mov_b32 s51, 196608
TR a[34:35],v10,264
CV v87,v94,v95
MC v[56:59],a[12:15],v[176:179]
TR a[36:37],v8,8456
MC v[56:59],a[16:19],v[200:203]
LG 6
TR a[38:39],v8,8712
MC v[56:59],a[20:23],v[216:219]
LG 6
TR a[48:49],v10,8456
MC v[56:59],a[24:27],v[240:243]
TR a[50:51],v10,8712
M v[60:63],a[68:71],v[104:107],0
buffer_load_dwordx4 a[116:119], v1, s[28:31], s45 offen offset:1024 sc1
MC v[60:63],a[0:3],v[128:131]
TR a[52:53],v8,16904
MC v[60:63],a[4:7],v[144:147]
TR a[54:55],v8,17160
MC v[60:63],a[8:11],v[168:171]
TR a[56:57],v10,16904
MC v[60:63],a[12:15],v[184:187]
buffer_store_dwordx4 v[84:87], v0, s[28:31], s51 offen sc1
MC v[60:63],a[16:19],v[208:211]
s_mov_b32 s51, 204800
TR a[58:59],v10,17160
MC v[60:63],a[20:23],v[224:227]
TR a[40:41],v8,25352
MC v[60:63],a[24:27],v[248:251]
TR a[42:43],v8,25608
v_subrev_u32 v8, 67584, v8
M v[64:67],a[68:71],v[112:115],0
LG 6
TR a[44:45],v10,25352
MC v[64:67],a[0:3],a[144:147]
TR a[46:47],v10,25608
v_subrev_u32 v10, 67584, v10
MC v[64:67],a[4:7],v[152:155]
TR a[64:65],v9,0
MC v[64:67],a[8:11],a[148:151]
buffer_load_dwordx4 a[120:123], v1, s[28:31], s45 offen offset:2048 sc1
MC v[64:67],a[12:15],v[192:195]
TR a[66:67],v9,256
MC v[64:67],a[16:19],a[152:155]
TR a[68:69],v11,0
MC v[64:67],a[20:23],v[232:235]
TR a[70:71],v11,256
MC v[64:67],a[24:27],a[156:159]
TR a[0:1],v9,8448
M v[68:71],a[28:31],v[96:99],0
s_waitcnt vmcnt(6)
buffer_atomic_add v4, v3, s[28:31], s42 offen sc1
MC v[68:71],a[32:35],v[120:123]
TR a[2:3],v9,8704
v_mov_b32 v4, 4096
MC v[68:71],a[36:39],v[136:139]
LG 5
TR a[4:5],v11,8448
MC v[68:71],a[48:51],v[160:163]
TR a[6:7],v11,8704
MC v[68:71],a[52:55],v[176:179]
TR a[8:9],v9,16896
MC v[68:71],a[56:59],v[200:203]
TR a[10:11],v9,17152
MC v[68:71],a[40:43],v[216:219]
buffer_load_dwordx4 a[124:127], v1, s[28:31], s45 offen offset:3072 sc1
MC v[68:71],a[44:47],v[240:243]
s_lshl_b32 s45, s38, 13
TR a[12:13],v11,16896
s_add_u32 s45, s45, 126976
M v[72:75],a[28:31],v[104:107],0
TR a[14:15],v11,17152
MC v[72:75],a[32:35],v[128:131]
TR a[16:17],v9,25344
MC v[72:75],a[36:39],v[144:147]
TR a[18:19],v9,25600
MC v[72:75],a[48:51],v[168:171]
TR a[20:21],v11,25344
MC v[72:75],a[52:55],v[184:187]
LG 6
TR a[22:23],v11,25600
MC v[72:75],a[56:59],v[208:211]
TR a[24:25],v9,8
MC v[72:75],a[40:43],v[224:227]
TR a[26:27],v9,264
MC v[72:75],a[44:47],v[248:251]
M v[76:79],a[28:31],v[112:115],0
TR a[28:29],v11,8
MC v[76:79],a[32:35],a[144:147]
TR a[30:31],v11,264
MC v[76:79],a[36:39],v[152:155]
TR a[32:33],v9,8456
MC v[76:79],a[48:51],a[148:151]
TR a[34:35],v9,8712
MC v[76:79],a[52:55],v[192:195]
TR a[36:37],v11,8456
MC v[76:79],a[56:59],a[152:155]
LG 6
TR a[38:39],v11,8712
MC v[76:79],a[40:43],v[232:235]
TR a[48:49],v9,16904
MC v[76:79],a[44:47],a[156:159]
TR a[50:51],v9,17160
M v[80:83],a[64:67],v[96:99],0
buffer_load_dwordx4 v13, s[24:27], s41 offen offset:0 lds
MC v[80:83],a[68:71],v[120:123]
s_add_u32 m0, s35, 38016
TR a[52:53],v11,16904
s_mov_b32 s41, 287488
MC v[80:83],a[0:3],v[136:139]
TR a[54:55],v11,17160
MC v[80:83],a[4:7],v[160:163]
TR a[56:57],v9,25352
MC v[80:83],a[8:11],v[176:179]
buffer_load_dwordx4 v13, s[24:27], s40 offen offset:0 lds
MC v[80:83],a[12:15],v[200:203]
s_add_u32 m0, s35, 42240
TR a[58:59],v9,25608
s_mov_b32 s40, 316160
MC v[80:83],a[16:19],v[216:219]
TR a[40:41],v11,25352
v_subrev_u32 v9, 67584, v9
MC v[80:83],a[20:23],v[240:243]
LG 5
TR a[42:43],v11,25608
v_subrev_u32 v11, 67584, v11
M v[84:87],a[64:67],v[104:107],0
buffer_load_dwordx4 v13, s[24:27], s41 offen offset:0 lds
MC v[84:87],a[68:71],v[128:131]
s_barrier
MC v[84:87],a[0:3],v[144:147]
s_add_u32 m0, s35, 46464
TR a[44:45],v8,0
s_mov_b32 s41, 344832
MC v[84:87],a[4:7],v[168:171]
TR a[46:47],v8,256
MC v[84:87],a[8:11],v[184:187]
buffer_load_dwordx4 v13, s[24:27], s40 offen offset:0 lds
MC v[84:87],a[12:15],v[208:211]
s_add_u32 m0, s35, 50688
TR a[64:65],v10,0
s_mov_b32 s40, 373504
MC v[84:87],a[16:19],v[224:227]
TR a[66:67],v10,256
MC v[84:87],a[20:23],v[248:251]
TR a[68:69],v8,8448
M v[88:91],a[24:27],v[96:99],0
buffer_load_dwordx4 v13, s[24:27], s41 offen offset:0 lds
MC v[88:91],a[28:31],v[120:123]
s_add_u32 m0, s35, 54912
TR a[70:71],v8,8704
s_mov_b32 s41, 402176
MC v[88:91],a[32:35],v[136:139]
TR a[0:1],v10,8448
MC v[88:91],a[36:39],v[160:163]
TR a[2:3],v10,8704
MC v[88:91],a[48:51],v[176:179]
LG 6
buffer_load_dwordx4 v13, s[24:27], s40 offen offset:0 lds
MC v[88:91],a[52:55],v[200:203]
s_add_u32 m0, s35, 59136
TR a[4:5],v8,16896
s_mov_b32 s40, 430848
MC v[88:91],a[56:59],v[216:219]
TR a[6:7],v8,17152
MC v[88:91],a[40:43],v[240:243]
TR a[8:9],v10,16896
M v[92:95],a[24:27],v[104:107],0
buffer_load_dwordx4 v13, s[24:27], s41 offen offset:0 lds
MC v[92:95],a[28:31],v[128:131]
s_add_u32 m0, s35, 63360
TR a[10:11],v10,17152
MC v[92:95],a[32:35],v[144:147]
TR a[12:13],v8,25344
MC v[92:95],a[36:39],v[168:171]
TR a[14:15],v8,25600
MC v[92:95],a[48:51],v[184:187]
buffer_load_dwordx4 v13, s[24:27], s40 offen offset:0 lds
MC v[92:95],a[52:55],v[208:211]
TR a[16:17],v10,25344
MC v[92:95],a[56:59],v[224:227]
TR a[18:19],v10,25600
MC v[92:95],a[40:43],v[248:251]
LG 5
TR a[20:21],v8,8
MC v[56:59],a[44:47],v[100:103]
TR a[22:23],v8,264
MC v[56:59],a[64:67],v[124:127]
TR a[24:25],v10,8
MC v[56:59],a[68:71],v[140:143]
TR a[26:27],v10,264
MC v[56:59],a[0:3],v[164:167]
TR a[28:29],v8,8456
MC v[56:59],a[4:7],v[180:183]
LG 7
TR a[30:31],v8,8712
MC v[56:59],a[8:11],v[204:207]
TR a[32:33],v10,8456
MC v[56:59],a[12:15],v[220:223]
LG 7
TR a[34:35],v10,8712
MC v[56:59],a[16:19],v[244:247]
TR a[36:37],v8,16904
s_nop 0
MC v[60:63],a[44:47],v[108:111]
TR a[38:39],v8,17160
s_nop 0
MC v[60:63],a[64:67],v[132:135]
TR a[48:49],v10,16904
MC v[60:63],a[68:71],v[148:151]
TR a[50:51],v10,17160
CV v56,v56,v57
MC v[60:63],a[0:3],v[172:175]
TR a[52:53],v8,25352
CV v57,v58,v59
MC v[60:63],a[4:7],v[188:191]
TR a[54:55],v8,25608
v_add_u32 v8, 67584, v8
MC v[60:63],a[8:11],v[212:215]
LG 7
TR a[56:57],v10,25352
MC v[60:63],a[12:15],v[228:231]
s_nop 0
TR a[58:59],v10,25608
v_add_u32 v10, 67584, v10
MC v[60:63],a[16:19],v[252:255]
TR a[40:41],v9,0
s_nop 0
MC v[64:67],a[44:47],v[116:119]
buffer_atomic_add v21, v3, s[28:31], s42 offen sc0 sc1
MC v[64:67],a[64:67],a[240:243]
TR a[42:43],v9,256
s_nop 0
MC v[64:67],a[68:71],v[156:159]
TR a[44:45],v11,0
CV v60,v60,v61
MC v[64:67],a[0:3],a[244:247]
TR a[46:47],v11,256
CV v61,v62,v63
MC v[64:67],a[4:7],v[196:199]
TR a[64:65],v9,8448
MC v[64:67],a[8:11],a[248:251]
LG 6
TR a[66:67],v9,8704
MC v[64:67],a[12:15],v[236:239]
TR a[68:69],v11,8448
MC v[64:67],a[16:19],a[252:255]
TR a[70:71],v11,8704
s_nop 0
MC v[68:71],a[20:23],v[100:103]
TR a[0:1],v9,16896
s_nop 0
MC v[68:71],a[24:27],v[124:127]
TR a[2:3],v9,17152
MC v[68:71],a[28:31],v[140:143]
TR a[4:5],v11,16896
CV v64,v64,v65
MC v[68:71],a[32:35],v[164:167]
TR a[6:7],v11,17152
CV v65,v66,v67
MC v[68:71],a[36:39],v[180:183]
TR a[8:9],v9,25344
MC v[68:71],a[48:51],v[204:207]
LG 7
TR a[10:11],v9,25600
MC v[68:71],a[52:55],v[220:223]
TR a[12:13],v11,25344
MC v[68:71],a[56:59],v[244:247]
TR a[14:15],v11,25600
s_nop 0
MC v[72:75],a[20:23],v[108:111]
TR a[16:17],v9,8
s_nop 0
MC v[72:75],a[24:27],v[132:135]
TR a[18:19],v9,264
MC v[72:75],a[28:31],v[148:151]
CV v58,v68,v69
CV v59,v70,v71
MC v[72:75],a[32:35],v[172:175]
buffer_store_dwordx4 v[56:59], v0, s[28:31], s51 offen sc1
MC v[72:75],a[36:39],v[188:191]
s_mov_b32 s51, 212992
MC v[72:75],a[48:51],v[212:215]
MC v[72:75],a[52:55],v[228:231]
MC v[72:75],a[56:59],v[252:255]
s_nop 2
MC v[76:79],a[20:23],v[116:119]
TR a[20:21],v11,8
s_nop 0
MC v[76:79],a[24:27],a[240:243]
TR a[22:23],v11,264
CV v62,v72,v73
MC v[76:79],a[28:31],v[156:159]
LG 2
TR a[24:25],v9,8456
CV v63,v74,v75
MC v[76:79],a[32:35],a[244:247]
TR a[26:27],v9,8712
MC v[76:79],a[36:39],v[196:199]
TR a[28:29],v11,8456
MC v[76:79],a[48:51],a[248:251]
buffer_store_dwordx4 v[60:63], v0, s[28:31], s51 offen sc1
MC v[76:79],a[52:55],v[236:239]
s_mov_b32 s51, 221184
TR a[30:31],v11,8712
MC v[76:79],a[56:59],a[252:255]
TR a[32:33],v9,16904
s_nop 0
MC v[80:83],a[40:43],v[100:103]
TR a[34:35],v9,17160
s_nop 0
MC v[80:83],a[44:47],v[124:127]
TR a[36:37],v11,16904
MC v[80:83],a[64:67],v[140:143]
TR a[38:39],v11,17160
CV v66,v76,v77
MC v[80:83],a[68:71],v[164:167]
TR a[48:49],v9,25352
CV v67,v78,v79
MC v[80:83],a[0:3],v[180:183]
TR a[50:51],v9,25608
v_add_u32 v9, 67584, v9
MC v[80:83],a[4:7],v[204:207]
buffer_store_dwordx4 v[64:67], v0, s[28:31], s51 offen sc1
MC v[80:83],a[8:11],v[220:223]
s_mov_b32 s51, 229376
TR a[52:53],v11,25352
MC v[80:83],a[12:15],v[244:247]
TR a[54:55],v11,25608
v_add_u32 v11, 67584, v11
MC v[84:87],a[40:43],v[108:111]
s_waitcnt vmcnt(4)
s_barrier
MC v[84:87],a[44:47],v[132:135]
LG 5
TR a[56:57],v8,33792
CV v80,v80,v81
MC v[84:87],a[64:67],v[148:151]
TR a[58:59],v8,34048
CV v81,v82,v83
MC v[84:87],a[68:71],v[172:175]
TR a[40:41],v10,33792
MC v[84:87],a[0:3],v[188:191]
TR a[42:43],v10,34048
MC v[84:87],a[4:7],v[212:215]
TR a[44:45],v8,42240
MC v[84:87],a[8:11],v[228:231]
TR a[46:47],v8,42496
MC v[84:87],a[12:15],v[252:255]
TR a[64:65],v10,42240
s_nop 0
MC v[88:91],a[16:19],v[100:103]
TR a[66:67],v10,42496
s_nop 0
MC v[88:91],a[20:23],v[124:127]
TR a[68:69],v8,50688
MC v[88:91],a[24:27],v[140:143]
LG 7
TR a[70:71],v8,50944
CV v84,v84,v85
MC v[88:91],a[28:31],v[164:167]
s_waitcnt vmcnt(3)
v_readfirstlane_b32 s101, v21
s_nop 1
s_bitcmp1_b32 s101, 11
s_cbranch_scc0 Y_spinA2
Y_backA2:
TR a[0:1],v10,50688
CV v85,v86,v87
MC v[88:91],a[32:35],v[180:183]
buffer_load_dwordx4 a[208:211], v1, s[28:31], s44 offen offset:0 sc1
MC v[88:91],a[36:39],v[204:207]
TR a[2:3],v10,50944
v_mov_b32 v21, 65536
MC v[88:91],a[48:51],v[220:223]
TR a[4:5],v8,59136
MC v[88:91],a[52:55],v[244:247]
TR a[6:7],v8,59392
s_nop 0
MC v[92:95],a[16:19],v[108:111]
TR a[8:9],v10,59136
s_nop 0
MC v[92:95],a[20:23],v[132:135]
TR a[10:11],v10,59392
MC v[92:95],a[24:27],v[148:151]
LG 6
TR a[12:13],v8,33800
CV v82,v88,v89
MC v[92:95],a[28:31],v[172:175]
TR a[14:15],v8,34056
CV v83,v90,v91
MC v[92:95],a[32:35],v[188:191]
buffer_store_dwordx4 v[80:83], v0, s[28:31], s51 offen sc1
MC v[92:95],a[36:39],v[212:215]
s_mov_b32 s51, 237568
TR a[16:17],v10,33800
MC v[92:95],a[48:51],v[228:231]
TR a[18:19],v10,34056
MC v[92:95],a[52:55],v[252:255]
TR a[20:21],v8,42248
s_nop 0
M v[56:59],a[56:59],v[96:99],0
buffer_load_dwordx4 a[212:215], v1, s[28:31], s44 offen offset:1024 sc1
MC v[56:59],a[40:43],v[120:123]
TR a[22:23],v8,42504
s_nop 0
MC v[56:59],a[44:47],v[136:139]
TR a[24:25],v10,42248
CV v86,v92,v93
MC v[56:59],a[64:67],v[160:163]
TR a[26:27],v10,42504
CV v87,v94,v95
MC v[56:59],a[68:71],v[176:179]
LG 6
buffer_store_dwordx4 v[84:87], v0, s[28:31], s51 offen sc1
MC v[56:59],a[0:3],v[200:203]
s_mov_b32 s51, 245760
TR a[28:29],v8,50696
MC v[56:59],a[4:7],v[216:219]
TR a[30:31],v8,50952
MC v[56:59],a[8:11],v[240:243]
TR a[32:33],v10,50696
M v[60:63],a[56:59],v[104:107],0
TR a[34:35],v10,50952
MC v[60:63],a[40:43],v[128:131]
TR a[36:37],v8,59144
MC v[60:63],a[44:47],v[144:147]
TR a[38:39],v8,59400
v_subrev_u32 v8, 67584, v8
MC v[60:63],a[64:67],v[168:171]
TR a[48:49],v10,59144
MC v[60:63],a[68:71],v[184:187]
buffer_load_dwordx4 a[216:219], v1, s[28:31], s44 offen offset:2048 sc1
MC v[60:63],a[0:3],v[208:211]
TR a[50:51],v10,59400
v_subrev_u32 v10, 67584, v10
MC v[60:63],a[4:7],v[224:227]
LG 6
TR a[52:53],v8,33792
MC v[60:63],a[8:11],v[248:251]
TR a[54:55],v8,34048
M v[64:67],a[56:59],v[112:115],0
Y_pg24:
s_cbranch_execz Y_wr4
TR a[56:57],v10,33792
MC v[64:67],a[40:43],a[144:147]
TR a[58:59],v10,34048
MC v[64:67],a[44:47],v[152:155]
TR a[40:41],v8,42240
MC v[64:67],a[64:67],a[148:151]
TR a[42:43],v8,42496
MC v[64:67],a[68:71],v[192:195]
TR a[44:45],v10,42240
MC v[64:67],a[0:3],a[152:155]
TR a[46:47],v10,42496
MC v[64:67],a[4:7],v[232:235]
LG 7
TR a[64:65],v8,50688
MC v[64:67],a[8:11],a[156:159]
TR a[66:67],v8,50944
M v[68:71],a[12:15],v[96:99],0
buffer_load_dwordx4 a[220:223], v1, s[28:31], s44 offen offset:3072 sc1
MC v[68:71],a[16:19],v[120:123]
s_lshl_b32 s44, s38, 13
TR a[68:69],v10,50688
s_add_u32 s44, s44, 188416
MC v[68:71],a[20:23],v[136:139]
s_cmp_ge_u32 s38, 7
s_cselect_b32 s44, 0x40000000, s44
TR a[70:71],v10,50944
MC v[68:71],a[24:27],v[160:163]
TR a[0:1],v8,59136
MC v[68:71],a[28:31],v[176:179]
TR a[2:3],v8,59392
MC v[68:71],a[32:35],v[200:203]
TR a[4:5],v10,59136
MC v[68:71],a[36:39],v[216:219]
LG 6
TR a[6:7],v10,59392
MC v[68:71],a[48:51],v[240:243]
TR a[8:9],v8,33800
M v[72:75],a[12:15],v[104:107],0
TR a[10:11],v8,34056
MC v[72:75],a[16:19],v[128:131]
MC v[72:75],a[20:23],v[144:147]
MC v[72:75],a[24:27],v[168:171]
MC v[72:75],a[28:31],v[184:187]
buffer_load_dwordx4 a[224:227], v1, s[28:31], s45 offen offset:0 sc1
MC v[72:75],a[32:35],v[208:211]
MC v[72:75],a[36:39],v[224:227]
MC v[72:75],a[48:51],v[248:251]
M v[76:79],a[12:15],v[112:115],0
TR a[12:13],v10,33800
MC v[76:79],a[16:19],a[144:147]
TR a[14:15],v10,34056
MC v[76:79],a[20:23],v[152:155]
TR a[16:17],v8,42248
MC v[76:79],a[24:27],a[148:151]
TR a[18:19],v8,42504
MC v[76:79],a[28:31],v[192:195]
TR a[20:21],v10,42248
MC v[76:79],a[32:35],a[152:155]
LG 5
TR a[22:23],v10,42504
MC v[76:79],a[36:39],v[232:235]
TR a[24:25],v8,50696
MC v[76:79],a[48:51],a[156:159]
TR a[26:27],v8,50952
MC v[56:59],a[52:55],v[100:103]
buffer_load_dwordx4 a[228:231], v1, s[28:31], s45 offen offset:1024 sc1
MC v[56:59],a[56:59],v[124:127]
TR a[28:29],v10,50696
MC v[56:59],a[40:43],v[140:143]
TR a[30:31],v10,50952
MC v[56:59],a[44:47],v[164:167]
TR a[32:33],v8,59144
MC v[56:59],a[64:67],v[180:183]
TR a[34:35],v8,59400
MC v[56:59],a[68:71],v[204:207]
TR a[36:37],v10,59144
MC v[56:59],a[0:3],v[220:223]
TR a[38:39],v10,59400
MC v[56:59],a[4:7],v[244:247]
LG 6
TR a[48:49],v9,33792
s_nop 0
MC v[60:63],a[52:55],v[108:111]
TR a[50:51],v9,34048
s_nop 0
MC v[60:63],a[56:59],v[132:135]
MC v[60:63],a[40:43],v[148:151]
CV v56,v56,v57
CV v57,v58,v59
MC v[60:63],a[44:47],v[172:175]
MC v[60:63],a[64:67],v[188:191]
buffer_load_dwordx4 a[232:235], v1, s[28:31], s45 offen offset:2048 sc1
MC v[60:63],a[68:71],v[212:215]
MC v[60:63],a[0:3],v[228:231]
MC v[60:63],a[4:7],v[252:255]
s_nop 2
MC v[64:67],a[52:55],v[116:119]
TR a[52:53],v11,33792
s_nop 0
MC v[64:67],a[56:59],a[240:243]
TR a[54:55],v11,34048
CV v60,v60,v61
MC v[64:67],a[40:43],v[156:159]
TR a[56:57],v9,42240
CV v61,v62,v63
MC v[64:67],a[44:47],a[244:247]
TR a[58:59],v9,42496
MC v[64:67],a[64:67],v[196:199]
s_waitcnt vmcnt(5)
buffer_atomic_add v4, v3, s[28:31], s42 offen sc1
MC v[64:67],a[68:71],a[248:251]
TR a[40:41],v11,42240
MC v[64:67],a[0:3],v[236:239]
TR a[42:43],v11,42496
MC v[64:67],a[4:7],a[252:255]
LG 6
TR a[44:45],v9,50688
s_nop 0
MC v[68:71],a[8:11],v[100:103]
buffer_load_dwordx4 a[236:239], v1, s[28:31], s45 offen offset:3072 sc1
MC v[68:71],a[12:15],v[124:127]
s_lshl_b32 s45, s38, 13
TR a[46:47],v9,50944
CV v64,v64,v65
MC v[68:71],a[16:19],v[140:143]
s_add_u32 s45, s45, 192512
TR a[64:65],v11,50688
CV v65,v66,v67
MC v[68:71],a[20:23],v[164:167]
s_cmp_ge_u32 s38, 7
s_cselect_b32 s45, 0x40000000, s45
TR a[66:67],v11,50944
MC v[68:71],a[24:27],v[180:183]
TR a[68:69],v9,59136
MC v[68:71],a[28:31],v[204:207]
TR a[70:71],v9,59392
MC v[68:71],a[32:35],v[220:223]
TR a[0:1],v11,59136
MC v[68:71],a[36:39],v[244:247]
TR a[2:3],v11,59392
s_nop 0
MC v[72:75],a[8:11],v[108:111]
LG 7
TR a[4:5],v9,33800
s_nop 0
MC v[72:75],a[12:15],v[132:135]
TR a[6:7],v9,34056
CV v58,v68,v69
MC v[72:75],a[16:19],v[148:151]
CV v59,v70,v71
MC v[72:75],a[20:23],v[172:175]
buffer_store_dwordx4 v[56:59], v0, s[28:31], s51 offen sc1
MC v[72:75],a[24:27],v[188:191]
s_mov_b32 s51, 253952
MC v[72:75],a[28:31],v[212:215]
MC v[72:75],a[32:35],v[228:231]
MC v[72:75],a[36:39],v[252:255]
s_nop 2
MC v[76:79],a[8:11],v[116:119]
TR a[8:9],v11,33800
s_nop 0
MC v[76:79],a[12:15],a[240:243]
TR a[10:11],v11,34056
CV v62,v72,v73
MC v[76:79],a[16:19],v[156:159]
TR a[12:13],v9,42248
CV v63,v74,v75
MC v[76:79],a[20:23],a[244:247]
buffer_store_dwordx4 v[60:63], v0, s[28:31], s51 offen sc1
MC v[76:79],a[24:27],v[196:199]
s_mov_b32 s51, 262144
TR a[14:15],v9,42504
MC v[76:79],a[28:31],a[248:251]
TR a[16:17],v11,42248
MC v[76:79],a[32:35],v[236:239]
LG 5
TR a[18:19],v11,42504
MC v[76:79],a[36:39],a[252:255]
TR a[20:21],v9,50696
s_nop 0
M v[80:83],a[48:51],v[96:99],0
TR a[22:23],v9,50952
s_nop 0
MC v[80:83],a[52:55],v[120:123]
TR a[24:25],v11,50696
MC v[80:83],a[56:59],v[136:139]
TR a[26:27],v11,50952
CV v66,v76,v77
MC v[80:83],a[40:43],v[160:163]
TR a[28:29],v9,59144
CV v67,v78,v79
MC v[80:83],a[44:47],v[176:179]
buffer_store_dwordx4 v[64:67], v0, s[28:31], s51 offen sc1
MC v[80:83],a[64:67],v[200:203]
s_mov_b32 s51, 270336
TR a[30:31],v9,59400
v_subrev_u32 v9, 67584, v9
MC v[80:83],a[68:71],v[216:219]
TR a[32:33],v11,59144
MC v[80:83],a[0:3],v[240:243]
TR a[34:35],v11,59400
v_subrev_u32 v11, 67584, v11
M v[84:87],a[48:51],v[104:107],0
LG 6
TR a[36:37],v9,33792
MC v[84:87],a[52:55],v[128:131]
TR a[38:39],v9,34048
MC v[84:87],a[56:59],v[144:147]
TR a[48:49],v11,33792
MC v[84:87],a[40:43],v[168:171]
TR a[50:51],v11,34048
MC v[84:87],a[44:47],v[184:187]
TR a[52:53],v9,42240
MC v[84:87],a[64:67],v[208:211]
TR a[54:55],v9,42496
MC v[84:87],a[68:71],v[224:227]
TR a[56:57],v11,42240
MC v[84:87],a[0:3],v[248:251]
TR a[58:59],v11,42496
M v[88:91],a[4:7],v[96:99],0
LG 7
TR a[40:41],v9,50688
MC v[88:91],a[8:11],v[120:123]
TR a[42:43],v9,50944
MC v[88:91],a[12:15],v[136:139]
TR a[44:45],v11,50688
MC v[88:91],a[16:19],v[160:163]
TR a[46:47],v11,50944
MC v[88:91],a[20:23],v[176:179]
TR a[64:65],v9,59136
MC v[88:91],a[24:27],v[200:203]
TR a[66:67],v9,59392
MC v[88:91],a[28:31],v[216:219]
TR a[68:69],v11,59136
MC v[88:91],a[32:35],v[240:243]
LG 7
TR a[70:71],v11,59392
M v[92:95],a[4:7],v[104:107],0
TR a[0:1],v9,33800
MC v[92:95],a[8:11],v[128:131]
TR a[2:3],v9,34056
MC v[92:95],a[12:15],v[144:147]
TR a[4:5],v11,33800
MC v[92:95],a[16:19],v[168:171]
TR a[6:7],v11,34056
MC v[92:95],a[20:23],v[184:187]
TR a[8:9],v9,42248
MC v[92:95],a[24:27],v[208:211]
TR a[10:11],v9,42504
MC v[92:95],a[28:31],v[224:227]
LG 7
TR a[12:13],v11,42248
MC v[92:95],a[32:35],v[248:251]
TR a[14:15],v11,42504
MC v[80:83],a[36:39],v[100:103]
TR a[16:17],v9,50696
MC v[80:83],a[48:51],v[124:127]
TR a[18:19],v9,50952
MC v[80:83],a[52:55],v[140:143]
TR a[20:21],v11,50696
MC v[80:83],a[56:59],v[164:167]
TR a[22:23],v11,50952
MC v[80:83],a[40:43],v[180:183]
TR a[24:25],v9,59144
MC v[80:83],a[44:47],v[204:207]
LG 7
TR a[26:27],v9,59400
MC v[80:83],a[64:67],v[220:223]
TR a[28:29],v11,59144
MC v[80:83],a[68:71],v[244:247]
TR a[30:31],v11,59400
s_nop 0
MC v[84:87],a[36:39],v[108:111]
s_nop 2
MC v[84:87],a[48:51],v[132:135]
MC v[84:87],a[52:55],v[148:151]
CV v80,v80,v81
CV v81,v82,v83
MC v[84:87],a[56:59],v[172:175]
MC v[84:87],a[40:43],v[188:191]
MC v[84:87],a[44:47],v[212:215]
MC v[84:87],a[64:67],v[228:231]
MC v[84:87],a[68:71],v[252:255]
s_nop 2
MC v[88:91],a[0:3],v[100:103]
s_nop 2
MC v[88:91],a[4:7],v[124:127]
CV v84,v84,v85
CV v85,v86,v87
MC v[88:91],a[8:11],v[140:143]
LG 0
s_nop 0
MC v[88:91],a[12:15],v[164:167]
MC v[88:91],a[16:19],v[180:183]
buffer_atomic_add v6, v3, s[28:31], s42 offen sc0 sc1
MC v[88:91],a[20:23],v[204:207]
MC v[88:91],a[24:27],v[220:223]
MC v[88:91],a[28:31],v[244:247]
s_nop 2
MC v[92:95],a[0:3],v[108:111]
s_nop 2
MC v[92:95],a[4:7],v[132:135]
CV v82,v88,v89
CV v83,v90,v91
MC v[92:95],a[8:11],v[148:151]
buffer_store_dwordx4 v[80:83], v0, s[28:31], s51 offen sc1
MC v[92:95],a[12:15],v[172:175]
s_mov_b32 s51, 278528
MC v[92:95],a[16:19],v[188:191]
MC v[92:95],a[20:23],v[212:215]
MC v[92:95],a[24:27],v[228:231]
MC v[92:95],a[28:31],v[252:255]
s_nop 2
M v[212:215],v[26:29],a[72:75],0
s_nop 2
M v[220:223],v[24:27],a[72:75],0
CV v86,v92,v93
CV v87,v94,v95
MC v[212:215],v[26:29],a[76:79]
buffer_store_dwordx4 v[84:87], v0, s[28:31], s51 offen sc1
MC v[220:223],v[24:27],a[76:79]
MC v[212:215],v[26:29],a[80:83]
MC v[220:223],v[24:27],a[80:83]
MC v[212:215],v[26:29],a[84:87]
MC v[220:223],v[24:27],a[84:87]
MC v[212:215],v[26:29],a[88:91]
MC v[220:223],v[24:27],a[88:91]
MC v[212:215],v[26:29],a[92:95]
MC v[220:223],v[24:27],a[92:95]
MC v[212:215],v[26:29],a[128:131]
MC v[220:223],v[24:27],a[128:131]
MC v[212:215],v[26:29],a[132:135]
s_nop 2
MC v[220:223],v[24:27],a[132:135]
s_nop 2
M v[228:231],v[26:29],a[96:99],0
CV v212,v212,v213
CV v213,v214,v215
M v[236:239],v[24:27],a[96:99],0
MC v[228:231],v[26:29],a[100:103]
CV v214,v220,v221
CV v215,v222,v223
MC v[236:239],v[24:27],a[100:103]
buffer_store_dwordx4 v[212:215], v2, s[4:7], s56 offen nt
MC v[228:231],v[26:29],a[104:107]
MC v[236:239],v[24:27],a[104:107]
MC v[228:231],v[26:29],a[108:111]
s_nop 0
MC v[236:239],v[24:27],a[108:111]
MC v[228:231],v[26:29],a[112:115]
s_waitcnt vmcnt(1)
buffer_atomic_add v21, v3, s[28:31], s42 offen sc0 sc1
MC v[236:239],v[24:27],a[112:115]
v_readfirstlane_b32 s101, v6
s_nop 1
s_bitcmp1_b32 s101, 15
s_cbranch_scc0 Y_spinA3
Y_backA3:
MC v[228:231],v[26:29],a[116:119]
MC v[236:239],v[24:27],a[116:119]
MC v[228:231],v[26:29],a[120:123]
buffer_load_dwordx4 a[176:179], v1, s[28:31], s44 offen offset:0 sc1
MC v[236:239],v[24:27],a[120:123]
MC v[228:231],v[26:29],a[124:127]
s_nop 2
MC v[236:239],v[24:27],a[124:127]
s_nop 2
buffer_load_dwordx4 a[180:183], v1, s[28:31], s44 offen offset:1024 sc1
buffer_load_dwordx4 a[184:187], v1, s[28:31], s44 offen offset:2048 sc1
buffer_load_dwordx4 a[188:191], v1, s[28:31], s44 offen offset:3072 sc1
buffer_load_dwordx4 a[192:195], v1, s[28:31], s45 offen offset:0 sc1
buffer_load_dwordx4 a[196:199], v1, s[28:31], s45 offen offset:1024 sc1
buffer_load_dwordx4 a[200:203], v1, s[28:31], s45 offen offset:2048 sc1
buffer_load_dwordx4 a[204:207], v1, s[28:31], s45 offen offset:3072 sc1
s_nop 0
M v[164:167],v[26:29],a[208:211],0
s_lshl_b32 s44, s38, 13
CV v228,v228,v229
s_add_u32 s44, s44, 245760
s_cmp_ge_u32 s38, 5
s_cselect_b32 s44, 0x40000000, s44
M v[172:175],v[24:27],a[208:211],0
s_lshl_b32 s45, s38, 13
CV v229,v230,v231
s_add_u32 s45, s45, 249856
s_cmp_ge_u32 s38, 5
s_cselect_b32 s45, 0x40000000, s45
MC v[164:167],v[26:29],a[212:215]
CV v230,v236,v237
CV v231,v238,v239
MC v[172:175],v[24:27],a[212:215]
buffer_store_dwordx4 v[228:231], v2, s[4:7], s57 offen nt
MC v[164:167],v[26:29],a[216:219]
MC v[172:175],v[24:27],a[216:219]
MC v[164:167],v[26:29],a[220:223]
MC v[172:175],v[24:27],a[220:223]
MC v[164:167],v[26:29],a[224:227]
MC v[172:175],v[24:27],a[224:227]
MC v[164:167],v[26:29],a[228:231]
MC v[172:175],v[24:27],a[228:231]
MC v[164:167],v[26:29],a[232:235]
MC v[172:175],v[24:27],a[232:235]
MC v[164:167],v[26:29],a[236:239]
s_nop 2
MC v[172:175],v[24:27],a[236:239]
s_waitcnt vmcnt(9)
v_readfirstlane_b32 s101, v21
s_nop 1
s_add_u32 s101, s101, 65536
s_bitcmp1_b32 s101, 19
s_cbranch_scc0 Y_spinB
Y_backB:
s_nop 1
buffer_load_dwordx4 v[100:103], v1, s[28:31], s44 offen offset:0 sc1
buffer_load_dwordx4 v[108:111], v1, s[28:31], s44 offen offset:1024 sc1
buffer_load_dwordx4 v[116:119], v1, s[28:31], s44 offen offset:2048 sc1
buffer_load_dwordx4 v[124:127], v1, s[28:31], s44 offen offset:3072 sc1
buffer_load_dwordx4 v[132:135], v1, s[28:31], s45 offen offset:0 sc1
buffer_load_dwordx4 v[140:143], v1, s[28:31], s45 offen offset:1024 sc1
buffer_load_dwordx4 v[148:151], v1, s[28:31], s45 offen offset:2048 sc1
buffer_load_dwordx4 v[156:159], v1, s[28:31], s45 offen offset:3072 sc1
s_nop 0
s_waitcnt vmcnt(16)
M v[180:183],v[26:29],a[176:179],0
CV v164,v164,v165
CV v165,v166,v167
M v[188:191],v[24:27],a[176:179],0
s_waitcnt vmcnt(15)
CV v166,v172,v173
CV v167,v174,v175
MC v[180:183],v[26:29],a[180:183]
MC v[188:191],v[24:27],a[180:183]
s_waitcnt vmcnt(14)
buffer_store_dwordx4 v[164:167], v2, s[4:7], s58 offen nt
MC v[180:183],v[26:29],a[184:187]
MC v[188:191],v[24:27],a[184:187]
s_waitcnt vmcnt(14)
MC v[180:183],v[26:29],a[188:191]
MC v[188:191],v[24:27],a[188:191]
s_waitcnt vmcnt(13)
MC v[180:183],v[26:29],a[192:195]
MC v[188:191],v[24:27],a[192:195]
s_waitcnt vmcnt(12)
MC v[180:183],v[26:29],a[196:199]
MC v[188:191],v[24:27],a[196:199]
s_waitcnt vmcnt(11)
MC v[180:183],v[26:29],a[200:203]
MC v[188:191],v[24:27],a[200:203]
s_waitcnt vmcnt(10)
MC v[180:183],v[26:29],a[204:207]
s_nop 2
MC v[188:191],v[24:27],a[204:207]
s_waitcnt vmcnt(8)
s_nop 1
M v[196:199],v[26:29],v[100:103],0
CV v180,v180,v181
CV v181,v182,v183
M v[204:207],v[24:27],v[100:103],0
s_waitcnt vmcnt(7)
CV v182,v188,v189
CV v183,v190,v191
MC v[196:199],v[26:29],v[108:111]
buffer_store_dwordx4 v[180:183], v2, s[4:7], s59 offen nt
MC v[204:207],v[24:27],v[108:111]
s_waitcnt vmcnt(7)
MC v[196:199],v[26:29],v[116:119]
MC v[204:207],v[24:27],v[116:119]
s_waitcnt vmcnt(6)
MC v[196:199],v[26:29],v[124:127]
MC v[204:207],v[24:27],v[124:127]
s_waitcnt vmcnt(5)
MC v[196:199],v[26:29],v[132:135]
MC v[204:207],v[24:27],v[132:135]
s_waitcnt vmcnt(4)
MC v[196:199],v[26:29],v[140:143]
MC v[204:207],v[24:27],v[140:143]
s_waitcnt vmcnt(3)
MC v[196:199],v[26:29],v[148:151]
MC v[204:207],v[24:27],v[148:151]
s_waitcnt vmcnt(2)
MC v[196:199],v[26:29],v[156:159]
s_nop 2
MC v[204:207],v[24:27],v[156:159]
s_nop 3
CV v196,v196,v197
CV v197,v198,v199
s_nop 1
CV v198,v204,v205
CV v199,v206,v207
buffer_store_dwordx4 v[196:199], v2, s[4:7], s60 offen nt
Y_end:
s_endpgm
Y_spinB:
s_mov_b32 s53, 0x200000
Y_spinloopB:
v_mov_b32 v21, 0
buffer_atomic_add v21, v3, s[28:31], s42 offen sc0 sc1
s_waitcnt vmcnt(0)
v_readfirstlane_b32 s101, v21
s_nop 1
s_bitcmp1_b32 s101, 19
s_cbranch_scc1 Y_backB
s_sub_u32 s53, s53, 1
s_cmp_lg_u32 s53, 0
s_cbranch_scc1 Y_spinloopB
s_branch Y_backB
Y_spinA3:
s_mov_b32 s53, 0x200000
Y_spinloopA3:
v_mov_b32 v6, 0
buffer_atomic_add v6, v3, s[28:31], s42 offen sc0 sc1
s_waitcnt vmcnt(0)
v_readfirstlane_b32 s101, v6
s_nop 1
s_bitcmp1_b32 s101, 15
s_cbranch_scc1 Y_backA3
s_sub_u32 s53, s53, 1
s_cmp_lg_u32 s53, 0
s_cbranch_scc1 Y_spinloopA3
s_branch Y_backA3
Y_spinA2:
s_mov_b32 s53, 0x200000
Y_spinloopA2:
v_mov_b32 v21, 0
buffer_atomic_add v21, v3, s[28:31], s42 offen sc0 sc1
s_waitcnt vmcnt(0)
v_readfirstlane_b32 s101, v21
s_nop 1
s_bitcmp1_b32 s101, 11
s_cbranch_scc1 Y_backA2
s_sub_u32 s53, s53, 1
s_cmp_lg_u32 s53, 0
s_cbranch_scc1 Y_spinloopA2
s_branch Y_backA2
Y_spinA1:
s_mov_b32 s53, 0x200000
Y_spinloopA1:
v_mov_b32 v21, 0
buffer_atomic_add v21, v3, s[28:31], s42 offen sc0 sc1
s_waitcnt vmcnt(0)
v_readfirstlane_b32 s101, v21
s_nop 1
s_bitcmp1_b32 s101, 7
s_cbranch_scc1 Y_backA1
s_sub_u32 s53, s53, 1
s_cmp_lg_u32 s53, 0
s_cbranch_scc1 Y_spinloopA1
s_branch Y_backA1
Y_spinA0:
s_mov_b32 s53, 0x200000
Y_spinloopA0:
v_mov_b32 v21, 0
buffer_atomic_add v21, v3, s[28:31], s42 offen sc0 sc1
s_waitcnt vmcnt(0)
v_readfirstlane_b32 s101, v21
s_nop 1
s_bitcmp1_b32 s101, 3
s_cbranch_scc1 Y_backA0
s_sub_u32 s53, s53, 1
s_cmp_lg_u32 s53, 0
s_cbranch_scc1 Y_spinloopA0
s_branch Y_backA0
Y_spinR:
s_mov_b32 s53, 0x200000
Y_spinloopR:
buffer_load_dword v21, off, s[96:99], 0 sc1
s_waitcnt vmcnt(0)
v_readfirstlane_b32 s101, v21
s_nop 1
s_cmp_eq_u32 s101, 1
s_cbranch_scc1 Y_backR
s_sub_u32 s53, s53, 1
s_cmp_lg_u32 s53, 0
s_cbranch_scc1 Y_spinloopR
s_branch Y_backR
Y_restart:
s_waitcnt vmcnt(0) lgkmcnt(0)
s_barrier
s_mov_b32 s43, -1
v_bfe_u32 v21, v12, 4, 6
v_lshrrev_b32 v22, 3, v21
v_mul_u32_u24 v14, 896, v22
v_lshrrev_b32 v22, 4, v21
v_and_b32 v23, 7, v21
v_xor_b32 v22, v22, v23
v_lshl_add_u32 v14, v22, 4, v14
v_bfe_u32 v13, v21, 5, 1
v_lshlrev_b32 v13, 4, v13
v_bfe_u32 v23, v21, 4, 1
v_lshl_add_u32 v13, v23, 2, v13
v_bfe_u32 v23, v21, 3, 1
v_add_u32 v13, v13, v23
s_lshr_b32 s101, s32, 1
s_lshl_b32 s101, s101, 3
s_lshl_b32 s50, s33, 1
s_add_u32 s101, s101, s50
v_add_u32 v13, s101, v13
v_lshlrev_b32 v13, 13, v13
v_and_b32 v23, 7, v21
v_lshl_add_u32 v13, v23, 4, v13
s_branch E_start
Y_hook0:
v_bfe_u32 v30, v12, 4, 6
v_and_b32 v28, 15, v30
v_lshlrev_b32 v28, 9, v28
v_and_b32 v30, 48, v30
v_add_u32 v28, v28, v30
s_lshl_b32 s53, s33, 6
v_add_u32 v28, s53, v28
v_xor_b32 v29, 64, v28
v_mov_b32 v20, 0xff800000
v_mov_b32 v18, 0xff800000
v_mov_b32 v19, 0xff800000
s_mov_b32 s53, 0
Y_hookloop0:
buffer_load_dwordx4 v[96:99], v28, s[12:15], s53 offen offset:0
buffer_load_dwordx4 v[100:103], v29, s[12:15], s53 offen offset:0
buffer_load_dwordx4 v[104:107], v28, s[12:15], s53 offen offset:128
buffer_load_dwordx4 v[108:111], v29, s[12:15], s53 offen offset:128
buffer_load_dwordx4 v[112:115], v28, s[12:15], s53 offen offset:256
buffer_load_dwordx4 v[116:119], v29, s[12:15], s53 offen offset:256
buffer_load_dwordx4 v[120:123], v28, s[12:15], s53 offen offset:384
buffer_load_dwordx4 v[124:127], v29, s[12:15], s53 offen offset:384
s_waitcnt vmcnt(0)
M v[36:39],v[96:99],a[64:67],0
MC v[36:39],v[100:103],a[68:71]
MC v[36:39],v[104:107],a[72:75]
MC v[36:39],v[108:111],a[76:79]
MC v[36:39],v[112:115],a[80:83]
MC v[36:39],v[116:119],a[84:87]
MC v[36:39],v[120:123],a[88:91]
MC v[36:39],v[124:127],a[92:95]
M v[40:43],v[96:99],a[96:99],0
MC v[40:43],v[100:103],a[100:103]
MC v[40:43],v[104:107],a[104:107]
MC v[40:43],v[108:111],a[108:111]
MC v[40:43],v[112:115],a[112:115]
MC v[40:43],v[116:119],a[116:119]
MC v[40:43],v[120:123],a[120:123]
MC v[40:43],v[124:127],a[124:127]
M v[44:47],v[96:99],a[128:131],0
MC v[44:47],v[100:103],a[132:135]
MC v[44:47],v[104:107],a[136:139]
MC v[44:47],v[108:111],a[140:143]
MC v[44:47],v[112:115],a[144:147]
MC v[44:47],v[116:119],a[148:151]
MC v[44:47],v[120:123],a[152:155]
MC v[44:47],v[124:127],a[156:159]
s_nop 7
s_nop 1
v_max3_f32 v20, v20, v36, v37
v_max3_f32 v20, v20, v38, v39
v_max3_f32 v18, v18, v40, v41
v_max3_f32 v18, v18, v42, v43
v_max3_f32 v19, v19, v44, v45
v_max3_f32 v19, v19, v46, v47
s_add_u32 s53, s53, 8192
s_cmp_lt_u32 s53, 262144
s_cbranch_scc1 Y_hookloop0
v_mov_b32 v30, v20
s_nop 1
v_permlane32_swap_b32 v20, v30
s_nop 1
v_max_f32 v20, v20, v30
v_mov_b32 v30, v20
s_nop 1
v_permlane16_swap_b32 v20, v30
s_nop 1
v_max_f32 v20, v20, v30
v_sub_f32 v32, 0, v20
v_sub_f32 v33, 0, v20
v_sub_f32 v34, 0, v20
v_sub_f32 v35, 0, v20
v_mov_b32 v30, v18
s_nop 1
v_permlane32_swap_b32 v18, v30
s_nop 1
v_max_f32 v18, v18, v30
v_mov_b32 v30, v18
s_nop 1
v_permlane16_swap_b32 v18, v30
s_nop 1
v_max_f32 v18, v18, v30
v_sub_f32 v24, 0, v18
v_sub_f32 v25, 0, v18
v_sub_f32 v26, 0, v18
v_sub_f32 v27, 0, v18
v_mov_b32 v30, v19
s_nop 1
v_permlane32_swap_b32 v19, v30
s_nop 1
v_max_f32 v19, v19, v30
v_mov_b32 v30, v19
s_nop 1
v_permlane16_swap_b32 v19, v30
s_nop 1
v_max_f32 v19, v19, v30
v_sub_f32 v28, 0, v19
v_sub_f32 v29, 0, v19
v_sub_f32 v30, 0, v19
v_sub_f32 v31, 0, v19
s_nop 2
s_branch Y_ret0
Y_hook1:
v_bfe_u32 v30, v12, 4, 6
v_and_b32 v28, 15, v30
v_lshlrev_b32 v28, 9, v28
v_and_b32 v30, 48, v30
v_add_u32 v28, v28, v30
s_lshl_b32 s53, s33, 6
v_add_u32 v28, s53, v28
v_xor_b32 v29, 64, v28
v_mov_b32 v20, 0xff800000
v_mov_b32 v18, 0xff800000
v_mov_b32 v19, 0xff800000
s_mov_b32 s53, 262144
Y_hookloop1:
buffer_load_dwordx4 a[64:67], v28, s[12:15], s53 offen offset:0
buffer_load_dwordx4 a[68:71], v29, s[12:15], s53 offen offset:0
buffer_load_dwordx4 a[72:75], v28, s[12:15], s53 offen offset:128
buffer_load_dwordx4 a[76:79], v29, s[12:15], s53 offen offset:128
buffer_load_dwordx4 a[80:83], v28, s[12:15], s53 offen offset:256
buffer_load_dwordx4 a[84:87], v29, s[12:15], s53 offen offset:256
buffer_load_dwordx4 a[88:91], v28, s[12:15], s53 offen offset:384
buffer_load_dwordx4 a[92:95], v29, s[12:15], s53 offen offset:384
s_waitcnt vmcnt(0)
M v[36:39],a[64:67],a[160:163],0
MC v[36:39],a[68:71],a[164:167]
MC v[36:39],a[72:75],a[168:171]
MC v[36:39],a[76:79],a[172:175]
MC v[36:39],a[80:83],a[176:179]
MC v[36:39],a[84:87],a[180:183]
MC v[36:39],a[88:91],a[184:187]
MC v[36:39],a[92:95],a[188:191]
M v[40:43],a[64:67],a[192:195],0
MC v[40:43],a[68:71],a[196:199]
MC v[40:43],a[72:75],a[200:203]
MC v[40:43],a[76:79],a[204:207]
MC v[40:43],a[80:83],a[208:211]
MC v[40:43],a[84:87],a[212:215]
MC v[40:43],a[88:91],a[216:219]
MC v[40:43],a[92:95],a[220:223]
M v[44:47],a[64:67],a[224:227],0
MC v[44:47],a[68:71],a[228:231]
MC v[44:47],a[72:75],a[232:235]
MC v[44:47],a[76:79],a[236:239]
MC v[44:47],a[80:83],a[240:243]
MC v[44:47],a[84:87],a[244:247]
MC v[44:47],a[88:91],a[248:251]
MC v[44:47],a[92:95],a[252:255]
s_nop 7
s_nop 1
v_max3_f32 v20, v20, v36, v37
v_max3_f32 v20, v20, v38, v39
v_max3_f32 v18, v18, v40, v41
v_max3_f32 v18, v18, v42, v43
v_max3_f32 v19, v19, v44, v45
v_max3_f32 v19, v19, v46, v47
s_add_u32 s53, s53, 8192
s_cmp_lt_u32 s53, 524288
s_cbranch_scc1 Y_hookloop1
v_mov_b32 v30, v20
s_nop 1
v_permlane32_swap_b32 v20, v30
s_nop 1
v_max_f32 v20, v20, v30
v_mov_b32 v30, v20
s_nop 1
v_permlane16_swap_b32 v20, v30
s_nop 1
v_max_f32 v20, v20, v30
v_sub_f32 v32, 0, v20
v_sub_f32 v33, 0, v20
v_sub_f32 v34, 0, v20
v_sub_f32 v35, 0, v20
v_mov_b32 v30, v18
s_nop 1
v_permlane32_swap_b32 v18, v30
s_nop 1
v_max_f32 v18, v18, v30
v_mov_b32 v30, v18
s_nop 1
v_permlane16_swap_b32 v18, v30
s_nop 1
v_max_f32 v18, v18, v30
v_sub_f32 v24, 0, v18
v_sub_f32 v25, 0, v18
v_sub_f32 v26, 0, v18
v_sub_f32 v27, 0, v18
v_mov_b32 v30, v19
s_nop 1
v_permlane32_swap_b32 v19, v30
s_nop 1
v_max_f32 v19, v19, v30
v_mov_b32 v30, v19
s_nop 1
v_permlane16_swap_b32 v19, v30
s_nop 1
v_max_f32 v19, v19, v30
v_sub_f32 v28, 0, v19
v_sub_f32 v29, 0, v19
v_sub_f32 v30, 0, v19
v_sub_f32 v31, 0, v19
s_nop 2
s_branch Y_ret1
.fill 8192, 4, 0xBF810000
.section .rodata,"a"
.p2align 6
.amdhsa_kernel concat_heads__mha_block_cached__gqa_block_cached__near_ridge_kernel
  .amdhsa_next_free_vgpr 512
  .amdhsa_next_free_sgpr 102
  .amdhsa_accum_offset 256
  .amdhsa_group_segment_fixed_size 0
  .amdhsa_kernarg_size 104
  .amdhsa_user_sgpr_count 2
  .amdhsa_user_sgpr_kernarg_segment_ptr 1
  .amdhsa_system_sgpr_workgroup_id_x 1
  .amdhsa_float_denorm_mode_32 3
.end_amdhsa_kernel
```
